```python
import torch

def _softmax(x, axis=-1):
    return torch.softmax(x, dim=axis)
def _gelu(x):
    return torch.nn.functional.gelu(x, approximate="tanh")
def _silu(x):
    return torch.nn.functional.silu(x)
def _sigmoid(x):
    return torch.sigmoid(x)
def _layernorm(x, axis=-1, eps=1e-5):
    m = x.mean(dim=axis, keepdim=True)
    v = x.var(dim=axis, keepdim=True, unbiased=False)
    return (x - m) / torch.sqrt(v + eps)
def _scatter_add(tgt, idx, src, axis=0):
    return tgt.clone().index_add_(axis, idx, src)
def _segment_sum(src, seg, n):
    out = torch.zeros((n,) + src.shape[1:], dtype=src.dtype)
    return out.index_add_(0, seg, src)
def _pad(x, pw):
    flat = tuple(v for pair in reversed(pw) for v in pair)
    return torch.nn.functional.pad(x, flat)

kernel_name = 'parallel_sum__grouped_kv_mqa__glu_gated_reglu__prompt'

def setup_inputs():

    _w = (lambda a: (lambda t: t.to(torch.bfloat16) if t.is_floating_point() else t)(torch.as_tensor(a)))
    def _A_setup():
        B, S, D, H = 1, 2048, 512, 32
        Dh = D // H
        return {
            "x": _w((lambda *s: torch.randn(*s, dtype=torch.bfloat16) * 0.05)(B, S, D)),
            "wq": _w((lambda *s: torch.randn(*s, dtype=torch.bfloat16) * 0.05)(D, H * Dh)),
            "wk": _w((lambda *s: torch.randn(*s, dtype=torch.bfloat16) * 0.05)(D, Dh)),
            "wv": _w((lambda *s: torch.randn(*s, dtype=torch.bfloat16) * 0.05)(D, Dh)),
            "wo": _w((lambda *s: torch.randn(*s, dtype=torch.bfloat16) * 0.05)(H * Dh, D)),
        }
    _A_in = _A_setup()

    def _B_setup():
        B, S, D, F = 1, 2048, 512, 1792
        return {
            "x": _w((lambda *s: torch.randn(*s, dtype=torch.bfloat16) * 0.05)(B, S, D)),
            "W_gate": _w((lambda *s: torch.randn(*s, dtype=torch.bfloat16) * 0.4)(D, F) * (2.0 / D) ** 0.5),
            "W_up": _w((lambda *s: torch.randn(*s, dtype=torch.bfloat16) * 0.4)(D, F) * (2.0 / D) ** 0.5),
            "W_down": _w((lambda *s: torch.randn(*s, dtype=torch.bfloat16) * 0.4)(F, D) * (1.0 / F) ** 0.5),
        }
    _B_in = _B_setup()

    return {
        "A_x": _A_in["x"],
        "A_wq": _A_in["wq"],
        "A_wk": _A_in["wk"],
        "A_wv": _A_in["wv"],
        "A_wo": _A_in["wo"],
        "B_x": _B_in["x"],
        "B_W_gate": _B_in["W_gate"],
        "B_W_up": _B_in["W_up"],
        "B_W_down": _B_in["W_down"],
    }

def reference(A_x, A_wq, A_wk, A_wv, A_wo, B_x, B_W_gate, B_W_up, B_W_down):
    def _A_ref(x, wq, wk, wv, wo):
        B, S, D = x.shape
        H = 32
        Dh = D // H
        q = (lambda x, *d: x.permute(*d))((x @ wq).reshape(B, S, H, Dh), 0, 2, 1, 3)
        k = x @ wk
        v = x @ wv
        scores = torch.einsum("bhqd,bkd->bhqk", q, k) * (Dh ** -0.5)
        p = _softmax(scores, axis=-1)
        o = torch.einsum("bhqk,bkd->bhqd", p, v)
        return (lambda x, *d: x.permute(*d))(o, 0, 2, 1, 3).reshape(B, S, H * Dh) @ wo

    def _B_ref(x, W_gate, W_up, W_down):
        gate = torch.einsum("bsd,df->bsf", x, W_gate)
        up = torch.einsum("bsd,df->bsf", x, W_up)
        gate = gate * (lambda x, dt: x.to(dt))(gate > 0, gate.dtype)
        h = gate * up
        return torch.einsum("bsf,fd->bsd", h, W_down)

    x = A_x
    xn = _layernorm(x, axis=-1)
    return x + _A_ref(xn, A_wq, A_wk, A_wv, A_wo) + _B_ref(xn, B_W_gate, B_W_up, B_W_down)
```

```asm
; @launch grid=(256,1,1) block=(512,1,1) lds=157440
.amdgcn_target "amdgcn-amd-amdhsa--gfx950"
.text
.globl parallel_sum__grouped_kv_mqa__glu_gated_reglu__prompt_kernel
.p2align 8
.type parallel_sum__grouped_kv_mqa__glu_gated_reglu__prompt_kernel,@function
parallel_sum__grouped_kv_mqa__glu_gated_reglu__prompt_kernel:
  s_cmp_ge_u32 s2, 256
  s_cbranch_scc1 kend
  s_load_dwordx2 s[8:9], s[0:1], 0
  s_load_dwordx2 s[16:17], s[0:1], 16
  s_load_dwordx2 s[20:21], s[0:1], 24
  s_load_dwordx2 s[12:13], s[0:1], 8
  s_load_dwordx2 s[32:33], s[0:1], 88
  s_load_dwordx2 s[24:25], s[0:1], 48
  s_load_dwordx2 s[28:29], s[0:1], 56
  s_load_dwordx2 s[36:37], s[0:1], 64
  s_load_dwordx2 s[40:41], s[0:1], 32
  s_load_dwordx2 s[44:45], s[0:1], 72
  v_lshrrev_b32 v20, 6, v0
  v_and_b32 v0, 63, v0
  s_and_b32 s57, s2, 7
  s_lshr_b32 s58, s2, 3
  v_readfirstlane_b32 s52, v20
  v_lshlrev_b32 v1, 4, v0
  s_lshr_b32 s53, s57, 1
  s_lshl_b32 s53, s53, 2
  s_and_b32 s59, s58, 3
  s_add_u32 s53, s53, s59
  s_and_b32 s54, s57, 1
  s_lshl_b32 s54, s54, 3
  s_lshr_b32 s60, s58, 2
  s_add_u32 s54, s54, s60
  s_lshl_b32 s59, s59, 1
  s_add_u32 s7, s60, s59
  s_and_b32 s7, s7, 7
  s_and_b32 s63, s52, 3
  v_mov_b32 v2, 157184
  v_mov_b32 v3, 1
  s_cmp_lt_u32 s52, 4
  s_cbranch_scc1 role_g
role_a:
  s_setprio 3
  s_lshl_b32 s57, s53, 7
  s_lshr_b32 s58, s54, 1
  s_lshl_b32 s58, s58, 4
  s_add_u32 s57, s57, s58
  s_and_b32 s58, s54, 1
  s_lshl_b32 s58, s58, 2
  s_add_u32 s57, s57, s58
  s_add_u32 s4, s57, s63
  s_lshl_b32 s60, s4, 10
  v_lshrrev_b32 v21, 1, v1
  v_xor_b32 v21, v21, v1
  v_and_b32 v21, 128, v21
  v_lshl_or_b32 v21, v21, 1, v21
  v_xor_b32 v21, v1, v21
  v_add_u32 v20, 8192, v1
  s_lshl_b32 s59, s63, 12
  s_add_u32 m0, s59, 16384
  s_add_u32 s58, s59, 32768
  s_waitcnt lgkmcnt(0)
  s_and_b32 s9, s9, 0xffff
  s_mov_b32 s10, 2097152
  s_mov_b32 s11, 0x20000
  buffer_load_dwordx4 v[176:179], v1, s[8:11], s60 offen
  buffer_load_dwordx4 v[192:195], v20, s[8:11], s60 offen
  s_and_b32 s17, s17, 0xffff
  s_mov_b32 s18, 16384
  s_mov_b32 s19, 0x20000
  buffer_load_dwordx4 v21, s[16:19], s59 offen offset:0 lds
  buffer_load_dwordx4 v21, s[16:19], s59 offen offset:1024 lds
  buffer_load_dwordx4 v21, s[16:19], s59 offen offset:2048 lds
  buffer_load_dwordx4 v21, s[16:19], s59 offen offset:3072 lds
  s_and_b32 s21, s21, 0xffff
  s_mov_b32 s22, 16384
  s_mov_b32 s23, 0x20000
  s_mov_b32 m0, s58
  s_and_b32 s33, s33, 0xffff
  s_mov_b32 s34, 33554432
  s_mov_b32 s35, 0x20000
  buffer_load_dwordx4 v21, s[20:23], s59 offen offset:0 lds
  buffer_load_dwordx4 v21, s[20:23], s59 offen offset:1024 lds
  buffer_load_dwordx4 v21, s[20:23], s59 offen offset:2048 lds
  buffer_load_dwordx4 v21, s[20:23], s59 offen offset:3072 lds
  s_load_dword s61, s[32:33], 0x14000
  s_getpc_b64 s[78:79]
pca:
  s_lshr_b32 s75, s2, 3
  s_lshl_b32 s75, s75, 2
  s_add_u32 s75, s75, s63
  s_mul_i32 s75, s75, 448
  s_min_u32 s75, s75, kend-parallel_sum__grouped_kv_mqa__glu_gated_reglu__prompt_kernel-448
  s_sub_u32 s78, s78, pca-parallel_sum__grouped_kv_mqa__glu_gated_reglu__prompt_kernel
  s_subb_u32 s79, s79, 0
  s_add_u32 s78, s78, s75
  s_addc_u32 s79, s79, 0
  s_load_dword s3, s[78:79], 0
  s_load_dword s3, s[78:79], 64
  s_load_dword s3, s[78:79], 128
  s_load_dword s3, s[78:79], 192
  s_load_dword s3, s[78:79], 256
  s_load_dword s3, s[78:79], 320
  s_load_dword s3, s[78:79], 384
  s_barrier
  s_and_b32 s25, s25, 0xffff
  s_mov_b32 s26, 1835008
  s_mov_b32 s27, 0x20000
  s_and_b32 s29, s29, 0xffff
  s_mov_b32 s30, 1835008
  s_mov_b32 s31, 0x20000
  s_and_b32 s57, s2, 7
  s_lshr_b32 s58, s2, 3
  s_lshr_b32 s55, s57, 1
  s_lshl_b32 s55, s55, 3
  s_and_b32 s59, s58, 7
  s_add_u32 s55, s55, s59
  s_and_b32 s56, s57, 1
  s_lshl_b32 s56, s56, 2
  s_lshr_b32 s59, s58, 3
  s_add_u32 s56, s56, s59
  s_mov_b32 s64, 0xffff0000
  s_mov_b32 s65, 0x3f803f80
  s_mov_b32 s79, 0xffff
  s_lshl_b32 s5, s53, 2
  s_lshr_b32 s58, s54, 2
  s_add_u32 s5, s5, s58
  v_lshrrev_b32 v22, 1, v0
  v_and_b32 v22, 7, v22
  v_xor_b32 v22, s63, v22
  v_lshlrev_b32 v22, 4, v22
  v_lshl_add_u32 v22, v0, 7, v22
  v_add_u32 v22, 147456, v22
  v_xor_b32 v23, 64, v22
  s_lshl_b32 s57, s4, 4
  s_add_u32 s57, s57, 98304
  s_add_u32 s58, s57, 128
  s_waitcnt vmcnt(8)
  v_mov_b32 v180, 0
  v_mov_b32 v196, 0
  v_mov_b32 v181, 0
  v_mov_b32 v197, 0
  v_mov_b32 v182, 0
  v_mov_b32 v198, 0
  v_mov_b32 v183, 0
  v_mov_b32 v199, 0
  v_dot2_f32_bf16 v180, v176, s65, v180
  v_dot2_f32_bf16 v196, v192, s65, v196
  v_dot2_f32_bf16 v182, v176, v176, v182
  v_dot2_f32_bf16 v198, v192, v192, v198
  v_dot2_f32_bf16 v181, v177, s65, v181
  v_dot2_f32_bf16 v197, v193, s65, v197
  v_dot2_f32_bf16 v183, v177, v177, v183
  v_dot2_f32_bf16 v199, v193, v193, v199
  v_dot2_f32_bf16 v180, v178, s65, v180
  v_dot2_f32_bf16 v196, v194, s65, v196
  v_dot2_f32_bf16 v182, v178, v178, v182
  v_dot2_f32_bf16 v198, v194, v194, v198
  v_dot2_f32_bf16 v181, v179, s65, v181
  v_dot2_f32_bf16 v197, v195, s65, v197
  v_dot2_f32_bf16 v183, v179, v179, v183
  v_dot2_f32_bf16 v199, v195, v195, v199
  s_nop 1
  v_add_f32 v180, v180, v181
  v_add_f32 v196, v196, v197
  v_add_f32 v182, v182, v183
  v_add_f32 v198, v198, v199
  s_nop 0
  v_permlane32_swap_b32 v180, v182
  v_permlane32_swap_b32 v196, v198
  v_add_f32 v180, v180, v182
  v_add_f32 v196, v196, v198
  v_mov_b32 v184, v180
  v_mov_b32 v200, v196
  s_nop 0
  v_permlane16_swap_b32 v180, v184
  v_permlane16_swap_b32 v196, v200
  v_add_f32 v180, v180, v184
  v_add_f32 v196, v196, v200
  s_nop 0
  v_add_f32_dpp v180, v180, v180 row_ror:8 row_mask:0xf bank_mask:0xf
  v_add_f32_dpp v196, v196, v196 row_ror:8 row_mask:0xf bank_mask:0xf
  s_nop 0
  v_add_f32_dpp v180, v180, v180 row_ror:4 row_mask:0xf bank_mask:0xf
  v_add_f32_dpp v196, v196, v196 row_ror:4 row_mask:0xf bank_mask:0xf
  s_nop 0
  v_add_f32_dpp v180, v180, v180 row_ror:2 row_mask:0xf bank_mask:0xf
  v_add_f32_dpp v196, v196, v196 row_ror:2 row_mask:0xf bank_mask:0xf
  s_nop 0
  v_add_f32_dpp v180, v180, v180 row_ror:1 row_mask:0xf bank_mask:0xf
  v_add_f32_dpp v196, v196, v196 row_ror:1 row_mask:0xf bank_mask:0xf
  s_nop 0
  v_mov_b32 v182, v180
  v_mov_b32 v198, v196
  s_nop 0
  v_permlane32_swap_b32 v180, v182
  v_permlane32_swap_b32 v196, v198
  v_mul_f32 v180, 0x3b000000, v180
  v_mul_f32 v196, 0x3b000000, v196
  v_mul_f32 v182, 0x3b000000, v182
  v_mul_f32 v198, 0x3b000000, v198
  v_fma_f32 v182, -v180, v180, v182
  v_fma_f32 v198, -v196, v196, v198
  v_max_f32 v182, 0, v182
  v_max_f32 v198, 0, v198
  v_add_f32 v182, 0x3727c5ac, v182
  v_add_f32 v198, 0x3727c5ac, v198
  v_rsq_f32 v190, v182
  v_rsq_f32 v206, v198
  v_sub_f32 v188, 0, v180
  v_sub_f32 v204, 0, v196
  v_mul_f32 v185, v188, v190
  v_mul_f32 v201, v204, v206
  v_lshlrev_b32 v180, 16, v176
  v_lshlrev_b32 v196, 16, v192
  v_and_b32 v181, s64, v176
  v_and_b32 v197, s64, v192
  v_fma_f32 v180, v180, v190, v185
  v_fma_f32 v196, v196, v206, v201
  v_fma_f32 v181, v181, v190, v185
  v_fma_f32 v197, v197, v206, v201
  v_cvt_pk_bf16_f32 v176, v180, v181
  v_cvt_pk_bf16_f32 v192, v196, v197
  v_lshlrev_b32 v182, 16, v177
  v_lshlrev_b32 v198, 16, v193
  v_and_b32 v183, s64, v177
  v_and_b32 v199, s64, v193
  v_fma_f32 v182, v182, v190, v185
  v_fma_f32 v198, v198, v206, v201
  v_fma_f32 v183, v183, v190, v185
  v_fma_f32 v199, v199, v206, v201
  v_cvt_pk_bf16_f32 v177, v182, v183
  v_cvt_pk_bf16_f32 v193, v198, v199
  v_lshlrev_b32 v180, 16, v178
  v_lshlrev_b32 v196, 16, v194
  v_and_b32 v181, s64, v178
  v_and_b32 v197, s64, v194
  v_fma_f32 v180, v180, v190, v185
  v_fma_f32 v196, v196, v206, v201
  v_fma_f32 v181, v181, v190, v185
  v_fma_f32 v197, v197, v206, v201
  v_cvt_pk_bf16_f32 v178, v180, v181
  v_cvt_pk_bf16_f32 v194, v196, v197
  v_lshlrev_b32 v182, 16, v179
  v_lshlrev_b32 v198, 16, v195
  v_and_b32 v183, s64, v179
  v_and_b32 v199, s64, v195
  v_fma_f32 v182, v182, v190, v185
  v_fma_f32 v198, v198, v206, v201
  v_fma_f32 v183, v183, v190, v185
  v_fma_f32 v199, v199, v206, v201
  v_cvt_pk_bf16_f32 v179, v182, v183
  v_cvt_pk_bf16_f32 v195, v198, v199
  ds_write_b128 v22, v[176:179]
  ds_write_b128 v23, v[192:195]
  s_waitcnt lgkmcnt(0)
  s_mul_i32 s61, s61, 1664525
  s_add_u32 s61, s61, 1013904223
  v_mov_b32 v4, s61
  v_mov_b32 v189, s61
  v_mov_b32 v191, s61
  v_mov_b32 v205, s61
  v_mov_b32 v207, s61
  ds_write_b32 v2, v4 offset:112
  s_waitcnt vmcnt(0)
  s_mov_b64 exec, 1
  ds_add_u32 v2, v3 offset:96
  s_mov_b64 exec, -1
  s_mov_b64 exec, 1
  buffer_store_dwordx4 v[188:191], off, s[32:35], s57 sc1
  buffer_store_dwordx4 v[204:207], off, s[32:35], s58 sc1
  s_mov_b64 exec, -1
  s_cmp_lt_u32 s52, 6
  s_cbranch_scc1 a_kv
  s_setprio 0
  s_cmp_eq_u32 s52, 7
  s_cbranch_scc1 a_pw
  s_lshr_b32 s57, s53, 2
  s_lshr_b32 s58, s54, 3
  s_lshl_b32 s57, s57, 5
  s_lshr_b32 s59, s2, 3
  s_add_u32 s57, s57, s59
  s_and_b32 s73, s57, 3
  s_lshr_b32 s57, s57, 2
  s_mul_i32 s59, s58, 14
  s_add_u32 s59, s59, s57
  s_add_u32 s72, s59, 14
  s_sub_u32 s60, s59, 14
  s_cmp_lt_u32 s57, 14
  s_cselect_b32 s72, s59, s72
  s_cselect_b32 s59, s59, s60
  s_cselect_b32 s48, s24, s28
  s_cselect_b32 s49, s25, s29
  s_mov_b32 s50, 1835008
  s_mov_b32 s51, 0x20000
  s_mov_b32 s77, s57
  s_cmp_ge_u32 s57, 28
  s_cbranch_scc1 a_poll
  ds_read_b32 v24, v2 offset:0
  s_waitcnt lgkmcnt(0)
  v_cmp_gt_u32 vcc, 4, v24
  s_cbranch_vccnz acs_spin
acs_ok:
  v_lshrrev_b32 v24, 3, v0
  s_lshl_b32 s57, s73, 7
  v_add_u32 v24, s57, v24
  v_mul_u32_u24 v24, 3584, v24
  s_lshl_b32 s59, s59, 7
  v_and_b32 v25, 7, v0
  v_lshl_add_u32 v24, v25, 4, v24
  v_add_u32 v24, s59, v24
  s_mov_b32 s57, 0
  buffer_load_dwordx4 v[100:103], v24, s[48:51], s57 offen
  s_mov_b32 s57, 28672
  buffer_load_dwordx4 v[104:107], v24, s[48:51], s57 offen
  s_mov_b32 s57, 57344
  buffer_load_dwordx4 v[108:111], v24, s[48:51], s57 offen
  s_mov_b32 s57, 86016
  buffer_load_dwordx4 v[112:115], v24, s[48:51], s57 offen
  s_mov_b32 s57, 114688
  buffer_load_dwordx4 v[116:119], v24, s[48:51], s57 offen
  s_mov_b32 s57, 143360
  buffer_load_dwordx4 v[120:123], v24, s[48:51], s57 offen
  s_mov_b32 s57, 172032
  buffer_load_dwordx4 v[124:127], v24, s[48:51], s57 offen
  s_mov_b32 s57, 200704
  buffer_load_dwordx4 v[128:131], v24, s[48:51], s57 offen
  s_mov_b32 s57, 229376
  buffer_load_dwordx4 v[132:135], v24, s[48:51], s57 offen
  s_mov_b32 s57, 258048
  buffer_load_dwordx4 v[136:139], v24, s[48:51], s57 offen
  s_mov_b32 s57, 286720
  buffer_load_dwordx4 v[140:143], v24, s[48:51], s57 offen
  s_mov_b32 s57, 315392
  buffer_load_dwordx4 v[144:147], v24, s[48:51], s57 offen
  s_mov_b32 s57, 344064
  buffer_load_dwordx4 v[148:151], v24, s[48:51], s57 offen
  s_mov_b32 s57, 372736
  buffer_load_dwordx4 v[152:155], v24, s[48:51], s57 offen
  s_mov_b32 s57, 401408
  buffer_load_dwordx4 v[156:159], v24, s[48:51], s57 offen
  s_mov_b32 s57, 430080
  buffer_load_dwordx4 v[160:163], v24, s[48:51], s57 offen
  s_mov_b32 s57, 0x3f80
  s_mov_b32 s58, 0x3f800000
  s_waitcnt vmcnt(12)
  v_dot2_f32_bf16 v164, v100, s57, 0
  v_dot2_f32_bf16 v165, v100, s58, 0
  v_dot2_f32_bf16 v166, v101, s57, 0
  v_dot2_f32_bf16 v167, v101, s58, 0
  v_dot2_f32_bf16 v168, v102, s57, 0
  v_dot2_f32_bf16 v169, v102, s58, 0
  v_dot2_f32_bf16 v170, v103, s57, 0
  v_dot2_f32_bf16 v171, v103, s58, 0
  v_dot2_f32_bf16 v164, v104, s57, v164
  v_dot2_f32_bf16 v165, v104, s58, v165
  v_dot2_f32_bf16 v166, v105, s57, v166
  v_dot2_f32_bf16 v167, v105, s58, v167
  v_dot2_f32_bf16 v168, v106, s57, v168
  v_dot2_f32_bf16 v169, v106, s58, v169
  v_dot2_f32_bf16 v170, v107, s57, v170
  v_dot2_f32_bf16 v171, v107, s58, v171
  v_dot2_f32_bf16 v164, v108, s57, v164
  v_dot2_f32_bf16 v165, v108, s58, v165
  v_dot2_f32_bf16 v166, v109, s57, v166
  v_dot2_f32_bf16 v167, v109, s58, v167
  v_dot2_f32_bf16 v168, v110, s57, v168
  v_dot2_f32_bf16 v169, v110, s58, v169
  v_dot2_f32_bf16 v170, v111, s57, v170
  v_dot2_f32_bf16 v171, v111, s58, v171
  v_dot2_f32_bf16 v164, v112, s57, v164
  v_dot2_f32_bf16 v165, v112, s58, v165
  v_dot2_f32_bf16 v166, v113, s57, v166
  v_dot2_f32_bf16 v167, v113, s58, v167
  v_dot2_f32_bf16 v168, v114, s57, v168
  v_dot2_f32_bf16 v169, v114, s58, v169
  v_dot2_f32_bf16 v170, v115, s57, v170
  v_dot2_f32_bf16 v171, v115, s58, v171
  s_waitcnt vmcnt(8)
  v_dot2_f32_bf16 v164, v116, s57, v164
  v_dot2_f32_bf16 v165, v116, s58, v165
  v_dot2_f32_bf16 v166, v117, s57, v166
  v_dot2_f32_bf16 v167, v117, s58, v167
  v_dot2_f32_bf16 v168, v118, s57, v168
  v_dot2_f32_bf16 v169, v118, s58, v169
  v_dot2_f32_bf16 v170, v119, s57, v170
  v_dot2_f32_bf16 v171, v119, s58, v171
  v_dot2_f32_bf16 v164, v120, s57, v164
  v_dot2_f32_bf16 v165, v120, s58, v165
  v_dot2_f32_bf16 v166, v121, s57, v166
  v_dot2_f32_bf16 v167, v121, s58, v167
  v_dot2_f32_bf16 v168, v122, s57, v168
  v_dot2_f32_bf16 v169, v122, s58, v169
  v_dot2_f32_bf16 v170, v123, s57, v170
  v_dot2_f32_bf16 v171, v123, s58, v171
  v_dot2_f32_bf16 v164, v124, s57, v164
  v_dot2_f32_bf16 v165, v124, s58, v165
  v_dot2_f32_bf16 v166, v125, s57, v166
  v_dot2_f32_bf16 v167, v125, s58, v167
  v_dot2_f32_bf16 v168, v126, s57, v168
  v_dot2_f32_bf16 v169, v126, s58, v169
  v_dot2_f32_bf16 v170, v127, s57, v170
  v_dot2_f32_bf16 v171, v127, s58, v171
  v_dot2_f32_bf16 v164, v128, s57, v164
  v_dot2_f32_bf16 v165, v128, s58, v165
  v_dot2_f32_bf16 v166, v129, s57, v166
  v_dot2_f32_bf16 v167, v129, s58, v167
  v_dot2_f32_bf16 v168, v130, s57, v168
  v_dot2_f32_bf16 v169, v130, s58, v169
  v_dot2_f32_bf16 v170, v131, s57, v170
  v_dot2_f32_bf16 v171, v131, s58, v171
  s_waitcnt vmcnt(4)
  v_dot2_f32_bf16 v164, v132, s57, v164
  v_dot2_f32_bf16 v165, v132, s58, v165
  v_dot2_f32_bf16 v166, v133, s57, v166
  v_dot2_f32_bf16 v167, v133, s58, v167
  v_dot2_f32_bf16 v168, v134, s57, v168
  v_dot2_f32_bf16 v169, v134, s58, v169
  v_dot2_f32_bf16 v170, v135, s57, v170
  v_dot2_f32_bf16 v171, v135, s58, v171
  v_dot2_f32_bf16 v164, v136, s57, v164
  v_dot2_f32_bf16 v165, v136, s58, v165
  v_dot2_f32_bf16 v166, v137, s57, v166
  v_dot2_f32_bf16 v167, v137, s58, v167
  v_dot2_f32_bf16 v168, v138, s57, v168
  v_dot2_f32_bf16 v169, v138, s58, v169
  v_dot2_f32_bf16 v170, v139, s57, v170
  v_dot2_f32_bf16 v171, v139, s58, v171
  v_dot2_f32_bf16 v164, v140, s57, v164
  v_dot2_f32_bf16 v165, v140, s58, v165
  v_dot2_f32_bf16 v166, v141, s57, v166
  v_dot2_f32_bf16 v167, v141, s58, v167
  v_dot2_f32_bf16 v168, v142, s57, v168
  v_dot2_f32_bf16 v169, v142, s58, v169
  v_dot2_f32_bf16 v170, v143, s57, v170
  v_dot2_f32_bf16 v171, v143, s58, v171
  v_dot2_f32_bf16 v164, v144, s57, v164
  v_dot2_f32_bf16 v165, v144, s58, v165
  v_dot2_f32_bf16 v166, v145, s57, v166
  v_dot2_f32_bf16 v167, v145, s58, v167
  v_dot2_f32_bf16 v168, v146, s57, v168
  v_dot2_f32_bf16 v169, v146, s58, v169
  v_dot2_f32_bf16 v170, v147, s57, v170
  v_dot2_f32_bf16 v171, v147, s58, v171
  s_waitcnt vmcnt(0)
  v_dot2_f32_bf16 v164, v148, s57, v164
  v_dot2_f32_bf16 v165, v148, s58, v165
  v_dot2_f32_bf16 v166, v149, s57, v166
  v_dot2_f32_bf16 v167, v149, s58, v167
  v_dot2_f32_bf16 v168, v150, s57, v168
  v_dot2_f32_bf16 v169, v150, s58, v169
  v_dot2_f32_bf16 v170, v151, s57, v170
  v_dot2_f32_bf16 v171, v151, s58, v171
  v_dot2_f32_bf16 v164, v152, s57, v164
  v_dot2_f32_bf16 v165, v152, s58, v165
  v_dot2_f32_bf16 v166, v153, s57, v166
  v_dot2_f32_bf16 v167, v153, s58, v167
  v_dot2_f32_bf16 v168, v154, s57, v168
  v_dot2_f32_bf16 v169, v154, s58, v169
  v_dot2_f32_bf16 v170, v155, s57, v170
  v_dot2_f32_bf16 v171, v155, s58, v171
  v_dot2_f32_bf16 v164, v156, s57, v164
  v_dot2_f32_bf16 v165, v156, s58, v165
  v_dot2_f32_bf16 v166, v157, s57, v166
  v_dot2_f32_bf16 v167, v157, s58, v167
  v_dot2_f32_bf16 v168, v158, s57, v168
  v_dot2_f32_bf16 v169, v158, s58, v169
  v_dot2_f32_bf16 v170, v159, s57, v170
  v_dot2_f32_bf16 v171, v159, s58, v171
  v_dot2_f32_bf16 v164, v160, s57, v164
  v_dot2_f32_bf16 v165, v160, s58, v165
  v_dot2_f32_bf16 v166, v161, s57, v166
  v_dot2_f32_bf16 v167, v161, s58, v167
  v_dot2_f32_bf16 v168, v162, s57, v168
  v_dot2_f32_bf16 v169, v162, s58, v169
  v_dot2_f32_bf16 v170, v163, s57, v170
  v_dot2_f32_bf16 v171, v163, s58, v171
  s_nop 2
  v_permlane16_swap_b32 v164, v165
  v_permlane16_swap_b32 v166, v167
  v_permlane16_swap_b32 v168, v169
  v_permlane16_swap_b32 v170, v171
  s_nop 0
  v_add_f32 v168, v168, v169
  v_add_f32 v170, v170, v171
  v_add_f32 v164, v164, v165
  v_add_f32 v166, v166, v167
  s_nop 0
  v_permlane32_swap_b32 v168, v170
  v_permlane32_swap_b32 v164, v166
  s_nop 0
  v_add_f32 v168, v168, v170
  v_add_f32 v164, v164, v166
  s_nop 1
  v_add_f32_dpp v168, v168, v168 row_ror:8 row_mask:0xf bank_mask:0xf
  v_add_f32_dpp v164, v164, v164 row_ror:8 row_mask:0xf bank_mask:0xf
  v_and_b32 v24, 7, v0
  v_lshlrev_b32 v24, 3, v24
  v_lshrrev_b32 v25, 5, v0
  v_lshl_add_u32 v24, v25, 1, v24
  v_lshrrev_b32 v25, 4, v0
  v_and_b32 v25, 1, v25
  v_add_u32 v24, v24, v25
  v_lshlrev_b32 v24, 5, v24
  v_mov_b32 v165, s61
  v_mov_b32 v169, s61
  s_lshl_b32 s57, s73, 3
  s_lshl_b32 s58, s72, 11
  s_add_u32 s57, s57, s58
  s_add_u32 s57, s57, 131072
  s_mov_b32 exec_lo, 0x00ff00ff
  s_mov_b32 exec_hi, 0x00ff00ff
  buffer_store_dwordx2 v[164:165], v24, s[32:35], s57 offen sc1
  buffer_store_dwordx2 v[168:169], v24, s[32:35], s57 offen offset:128 sc1
  s_mov_b64 exec, -1
  s_branch a_poll
a_pw:
  s_branch a_poll
a_kv:
  ds_read_b32 v24, v2 offset:96
  s_waitcnt lgkmcnt(0)
  v_cmp_gt_u32 vcc, 4, v24
  s_cbranch_vccnz axn_spin
axn_ok:
  s_cmp_eq_u32 s52, 5
  s_cbranch_scc1 a_vw
  v_and_b32 v140, 15, v0
  v_lshrrev_b32 v141, 4, v0
  v_and_b32 v142, 1, v141
  v_lshrrev_b32 v143, 1, v141
  v_lshl_add_u32 v142, v143, 2, v142
  v_lshlrev_b32 v142, 7, v142
  v_lshrrev_b32 v144, 2, v140
  v_lshl_add_u32 v142, v144, 5, v142
  v_and_b32 v144, 3, v0
  v_lshl_add_u32 v142, v144, 3, v142
  v_add_u32 v142, 16384, v142
  v_and_b32 v144, 7, v0
  v_xor_b32 v144, v144, v143
  v_lshlrev_b32 v144, 4, v144
  v_lshl_add_u32 v144, v141, 7, v144
  v_add_u32 v144, 147456, v144
  v_xor_b32 v145, 32, v144
  v_xor_b32 v146, 64, v144
  v_xor_b32 v147, 96, v144
  ds_read_b64_tr_b16 v[8:9], v142 offset:0
  ds_read_b64_tr_b16 v[10:11], v142 offset:256
  ds_read_b128 v[72:75], v144 offset:0
  ds_read_b64_tr_b16 v[12:13], v142 offset:1024
  ds_read_b64_tr_b16 v[14:15], v142 offset:1280
  ds_read_b128 v[76:79], v145 offset:512
  ds_read_b64_tr_b16 v[16:17], v142 offset:2048
  ds_read_b64_tr_b16 v[18:19], v142 offset:2304
  ds_read_b128 v[80:83], v146 offset:1024
  ds_read_b64_tr_b16 v[20:21], v142 offset:3072
  ds_read_b64_tr_b16 v[22:23], v142 offset:3328
  ds_read_b128 v[84:87], v147 offset:1536
  ds_read_b64_tr_b16 v[24:25], v142 offset:4096
  ds_read_b64_tr_b16 v[26:27], v142 offset:4352
  ds_read_b128 v[88:91], v144 offset:2048
  v_and_b32 v148, 1, v141
  v_lshlrev_b32 v148, 9, v148
  v_lshl_add_u32 v148, v143, 3, v148
  v_and_b32 v149, 7, v0
  v_lshl_add_u32 v148, v149, 4, v148
  s_lshl_b32 s57, s5, 10
  s_and_b32 s58, s54, 3
  s_lshl_b32 s58, s58, 7
  s_add_u32 s57, s57, s58
  s_add_u32 s57, s57, 262144
  s_waitcnt lgkmcnt(12)
  v_mfma_f32_16x16x32_bf16 v[136:139], v[8:11], v[72:75], 0
  ds_read_b64_tr_b16 v[28:29], v142 offset:5120
  ds_read_b64_tr_b16 v[30:31], v142 offset:5376
  ds_read_b128 v[92:95], v145 offset:2560
  s_waitcnt lgkmcnt(12)
  v_mfma_f32_16x16x32_bf16 v[136:139], v[12:15], v[76:79], v[136:139]
  ds_read_b64_tr_b16 v[32:33], v142 offset:6144
  ds_read_b64_tr_b16 v[34:35], v142 offset:6400
  ds_read_b128 v[96:99], v146 offset:3072
  s_waitcnt lgkmcnt(12)
  v_mfma_f32_16x16x32_bf16 v[136:139], v[16:19], v[80:83], v[136:139]
  ds_read_b64_tr_b16 v[36:37], v142 offset:7168
  ds_read_b64_tr_b16 v[38:39], v142 offset:7424
  ds_read_b128 v[100:103], v147 offset:3584
  s_waitcnt lgkmcnt(12)
  v_mfma_f32_16x16x32_bf16 v[136:139], v[20:23], v[84:87], v[136:139]
  ds_read_b64_tr_b16 v[40:41], v142 offset:8192
  ds_read_b64_tr_b16 v[42:43], v142 offset:8448
  ds_read_b128 v[104:107], v144 offset:4096
  s_waitcnt lgkmcnt(12)
  v_mfma_f32_16x16x32_bf16 v[136:139], v[24:27], v[88:91], v[136:139]
  ds_read_b64_tr_b16 v[44:45], v142 offset:9216
  ds_read_b64_tr_b16 v[46:47], v142 offset:9472
  ds_read_b128 v[108:111], v145 offset:4608
  s_waitcnt lgkmcnt(12)
  v_mfma_f32_16x16x32_bf16 v[136:139], v[28:31], v[92:95], v[136:139]
  ds_read_b64_tr_b16 v[48:49], v142 offset:10240
  ds_read_b64_tr_b16 v[50:51], v142 offset:10496
  ds_read_b128 v[112:115], v146 offset:5120
  s_waitcnt lgkmcnt(12)
  v_mfma_f32_16x16x32_bf16 v[136:139], v[32:35], v[96:99], v[136:139]
  ds_read_b64_tr_b16 v[52:53], v142 offset:11264
  ds_read_b64_tr_b16 v[54:55], v142 offset:11520
  ds_read_b128 v[116:119], v147 offset:5632
  s_waitcnt lgkmcnt(12)
  v_mfma_f32_16x16x32_bf16 v[136:139], v[36:39], v[100:103], v[136:139]
  ds_read_b64_tr_b16 v[56:57], v142 offset:12288
  ds_read_b64_tr_b16 v[58:59], v142 offset:12544
  ds_read_b128 v[120:123], v144 offset:6144
  s_waitcnt lgkmcnt(12)
  v_mfma_f32_16x16x32_bf16 v[136:139], v[40:43], v[104:107], v[136:139]
  ds_read_b64_tr_b16 v[60:61], v142 offset:13312
  ds_read_b64_tr_b16 v[62:63], v142 offset:13568
  ds_read_b128 v[124:127], v145 offset:6656
  s_waitcnt lgkmcnt(12)
  v_mfma_f32_16x16x32_bf16 v[136:139], v[44:47], v[108:111], v[136:139]
  ds_read_b64_tr_b16 v[64:65], v142 offset:14336
  ds_read_b64_tr_b16 v[66:67], v142 offset:14592
  ds_read_b128 v[128:131], v146 offset:7168
  s_waitcnt lgkmcnt(12)
  v_mfma_f32_16x16x32_bf16 v[136:139], v[48:51], v[112:115], v[136:139]
  ds_read_b64_tr_b16 v[68:69], v142 offset:15360
  ds_read_b64_tr_b16 v[70:71], v142 offset:15616
  ds_read_b128 v[132:135], v147 offset:7680
  s_waitcnt lgkmcnt(12)
  v_mfma_f32_16x16x32_bf16 v[136:139], v[52:55], v[116:119], v[136:139]
  s_waitcnt lgkmcnt(9)
  v_mfma_f32_16x16x32_bf16 v[136:139], v[56:59], v[120:123], v[136:139]
  s_waitcnt lgkmcnt(6)
  v_mfma_f32_16x16x32_bf16 v[136:139], v[60:63], v[124:127], v[136:139]
  s_waitcnt lgkmcnt(3)
  v_mfma_f32_16x16x32_bf16 v[136:139], v[64:67], v[128:131], v[136:139]
  s_waitcnt lgkmcnt(0)
  v_mfma_f32_16x16x32_bf16 v[136:139], v[68:71], v[132:135], v[136:139]
  s_mov_b64 exec, 1
  ds_add_u32 v2, v3 offset:32
  s_mov_b64 exec, -1
  s_nop 7
  v_cvt_pk_bf16_f32 v136, v136, v137
  v_cvt_pk_bf16_f32 v137, v138, v139
  s_mov_b32 exec_lo, 0x00ff00ff
  s_mov_b32 exec_hi, 0x00ff00ff
  buffer_store_dwordx2 v[136:137], v148, s[32:35], s57 offen sc1
  s_mov_b64 exec, -1
  s_mov_b64 exec, 1
  ds_add_u32 v2, v3 offset:128
  s_mov_b64 exec, -1
  s_lshl_b32 s57, s53, 8
  s_lshl_b32 s58, s54, 2
  s_add_u32 s57, s57, s58
  s_add_u32 s57, s57, 720896
  v_lshlrev_b32 v148, 12, v0
  s_waitcnt vmcnt(0)
  ds_read_b32 v149, v2 offset:80
  s_waitcnt lgkmcnt(0)
  v_cmp_gt_u32 vcc, 1, v149
  s_cbranch_vccnz kvv_spin
kvv_ok:
  s_mov_b32 exec_lo, 0xffff
  s_mov_b32 exec_hi, 0x0
  buffer_atomic_swap v4, v148, s[32:35], s57 offen sc1
  s_mov_b64 exec, -1
  s_mov_b64 exec, 1
  ds_add_u32 v2, v3 offset:144
  s_mov_b64 exec, -1
  s_branch a_poll
a_vw:
  v_and_b32 v140, 15, v0
  v_lshrrev_b32 v141, 4, v0
  v_and_b32 v142, 1, v141
  v_lshrrev_b32 v143, 1, v141
  v_lshl_add_u32 v142, v143, 2, v142
  v_lshlrev_b32 v142, 7, v142
  v_lshrrev_b32 v144, 2, v140
  v_lshl_add_u32 v142, v144, 5, v142
  v_and_b32 v144, 3, v0
  v_lshl_add_u32 v142, v144, 3, v142
  v_add_u32 v142, 32768, v142
  v_and_b32 v144, 7, v0
  v_xor_b32 v144, v144, v143
  v_lshlrev_b32 v144, 4, v144
  v_lshl_add_u32 v144, v141, 7, v144
  v_add_u32 v144, 147456, v144
  v_xor_b32 v145, 32, v144
  v_xor_b32 v146, 64, v144
  v_xor_b32 v147, 96, v144
  ds_read_b64_tr_b16 v[8:9], v142 offset:0
  ds_read_b64_tr_b16 v[10:11], v142 offset:256
  ds_read_b128 v[72:75], v144 offset:0
  ds_read_b64_tr_b16 v[12:13], v142 offset:1024
  ds_read_b64_tr_b16 v[14:15], v142 offset:1280
  ds_read_b128 v[76:79], v145 offset:512
  ds_read_b64_tr_b16 v[16:17], v142 offset:2048
  ds_read_b64_tr_b16 v[18:19], v142 offset:2304
  ds_read_b128 v[80:83], v146 offset:1024
  ds_read_b64_tr_b16 v[20:21], v142 offset:3072
  ds_read_b64_tr_b16 v[22:23], v142 offset:3328
  ds_read_b128 v[84:87], v147 offset:1536
  ds_read_b64_tr_b16 v[24:25], v142 offset:4096
  ds_read_b64_tr_b16 v[26:27], v142 offset:4352
  ds_read_b128 v[88:91], v144 offset:2048
  v_lshlrev_b32 v148, 4, v140
  v_lshl_add_u32 v148, v141, 3, v148
  s_lshl_b32 s57, s5, 11
  s_and_b32 s58, s54, 2
  s_lshl_b32 s58, s58, 9
  s_add_u32 s57, s57, s58
  s_and_b32 s58, s54, 1
  s_lshl_b32 s58, s58, 9
  s_add_u32 s57, s57, s58
  s_add_u32 s57, s57, 327680
  s_waitcnt lgkmcnt(12)
  v_mfma_f32_16x16x32_bf16 v[136:139], v[72:75], v[8:11], 0
  ds_read_b64_tr_b16 v[28:29], v142 offset:5120
  ds_read_b64_tr_b16 v[30:31], v142 offset:5376
  ds_read_b128 v[92:95], v145 offset:2560
  s_waitcnt lgkmcnt(12)
  v_mfma_f32_16x16x32_bf16 v[136:139], v[76:79], v[12:15], v[136:139]
  ds_read_b64_tr_b16 v[32:33], v142 offset:6144
  ds_read_b64_tr_b16 v[34:35], v142 offset:6400
  ds_read_b128 v[96:99], v146 offset:3072
  s_waitcnt lgkmcnt(12)
  v_mfma_f32_16x16x32_bf16 v[136:139], v[80:83], v[16:19], v[136:139]
  ds_read_b64_tr_b16 v[36:37], v142 offset:7168
  ds_read_b64_tr_b16 v[38:39], v142 offset:7424
  ds_read_b128 v[100:103], v147 offset:3584
  s_waitcnt lgkmcnt(12)
  v_mfma_f32_16x16x32_bf16 v[136:139], v[84:87], v[20:23], v[136:139]
  ds_read_b64_tr_b16 v[40:41], v142 offset:8192
  ds_read_b64_tr_b16 v[42:43], v142 offset:8448
  ds_read_b128 v[104:107], v144 offset:4096
  s_waitcnt lgkmcnt(12)
  v_mfma_f32_16x16x32_bf16 v[136:139], v[88:91], v[24:27], v[136:139]
  ds_read_b64_tr_b16 v[44:45], v142 offset:9216
  ds_read_b64_tr_b16 v[46:47], v142 offset:9472
  ds_read_b128 v[108:111], v145 offset:4608
  s_waitcnt lgkmcnt(12)
  v_mfma_f32_16x16x32_bf16 v[136:139], v[92:95], v[28:31], v[136:139]
  ds_read_b64_tr_b16 v[48:49], v142 offset:10240
  ds_read_b64_tr_b16 v[50:51], v142 offset:10496
  ds_read_b128 v[112:115], v146 offset:5120
  s_waitcnt lgkmcnt(12)
  v_mfma_f32_16x16x32_bf16 v[136:139], v[96:99], v[32:35], v[136:139]
  ds_read_b64_tr_b16 v[52:53], v142 offset:11264
  ds_read_b64_tr_b16 v[54:55], v142 offset:11520
  ds_read_b128 v[116:119], v147 offset:5632
  s_waitcnt lgkmcnt(12)
  v_mfma_f32_16x16x32_bf16 v[136:139], v[100:103], v[36:39], v[136:139]
  ds_read_b64_tr_b16 v[56:57], v142 offset:12288
  ds_read_b64_tr_b16 v[58:59], v142 offset:12544
  ds_read_b128 v[120:123], v144 offset:6144
  s_waitcnt lgkmcnt(12)
  v_mfma_f32_16x16x32_bf16 v[136:139], v[104:107], v[40:43], v[136:139]
  ds_read_b64_tr_b16 v[60:61], v142 offset:13312
  ds_read_b64_tr_b16 v[62:63], v142 offset:13568
  ds_read_b128 v[124:127], v145 offset:6656
  s_waitcnt lgkmcnt(12)
  v_mfma_f32_16x16x32_bf16 v[136:139], v[108:111], v[44:47], v[136:139]
  ds_read_b64_tr_b16 v[64:65], v142 offset:14336
  ds_read_b64_tr_b16 v[66:67], v142 offset:14592
  ds_read_b128 v[128:131], v146 offset:7168
  s_waitcnt lgkmcnt(12)
  v_mfma_f32_16x16x32_bf16 v[136:139], v[112:115], v[48:51], v[136:139]
  ds_read_b64_tr_b16 v[68:69], v142 offset:15360
  ds_read_b64_tr_b16 v[70:71], v142 offset:15616
  ds_read_b128 v[132:135], v147 offset:7680
  s_waitcnt lgkmcnt(12)
  v_mfma_f32_16x16x32_bf16 v[136:139], v[116:119], v[52:55], v[136:139]
  s_waitcnt lgkmcnt(9)
  v_mfma_f32_16x16x32_bf16 v[136:139], v[120:123], v[56:59], v[136:139]
  s_waitcnt lgkmcnt(6)
  v_mfma_f32_16x16x32_bf16 v[136:139], v[124:127], v[60:63], v[136:139]
  s_waitcnt lgkmcnt(3)
  v_mfma_f32_16x16x32_bf16 v[136:139], v[128:131], v[64:67], v[136:139]
  s_waitcnt lgkmcnt(0)
  v_mfma_f32_16x16x32_bf16 v[136:139], v[132:135], v[68:71], v[136:139]
  s_mov_b64 exec, 1
  ds_add_u32 v2, v3 offset:32
  s_mov_b64 exec, -1
  s_nop 7
  v_cvt_pk_bf16_f32 v136, v136, v137
  v_cvt_pk_bf16_f32 v137, v138, v139
  s_mov_b32 exec_lo, -1
  s_mov_b32 exec_hi, 0
  buffer_store_dwordx2 v[136:137], v148, s[32:35], s57 offen sc1
  s_mov_b64 exec, -1
  s_mov_b64 exec, 1
  ds_add_u32 v2, v3 offset:128
  s_mov_b64 exec, -1
  s_waitcnt vmcnt(0)
  s_mov_b64 exec, 1
  ds_add_u32 v2, v3 offset:80
  s_mov_b64 exec, -1
a_poll:
  s_setprio 0
  v_and_b32 v24, 27, v0
  v_cmp_eq_u32 vcc, 16, v24
  v_mov_b32 v24, s65
  s_lshl_b32 s66, s63, 14
  v_cndmask_b32 v104, 0, v24, vcc
  v_mov_b32 v105, v104
  v_mov_b32 v106, v104
  v_mov_b32 v107, v104
  v_mov_b32 v108, v104
  v_mov_b32 v109, v104
  v_mov_b32 v110, v104
  v_mov_b32 v111, v104
  v_mov_b32 v112, v104
  v_mov_b32 v113, v104
  v_mov_b32 v114, v104
  v_mov_b32 v115, v104
  v_mov_b32 v116, v104
  v_mov_b32 v117, v104
  v_mov_b32 v118, v104
  v_mov_b32 v119, v104
  v_mov_b32 v120, v104
  v_mov_b32 v121, v104
  v_mov_b32 v122, v104
  v_mov_b32 v123, v104
  v_mov_b32 v124, v104
  v_mov_b32 v125, v104
  v_mov_b32 v126, v104
  v_mov_b32 v127, v104
  v_mov_b32 v128, v104
  v_mov_b32 v129, v104
  v_mov_b32 v130, v104
  v_mov_b32 v131, v104
  v_mov_b32 v132, v104
  v_mov_b32 v133, v104
  v_mov_b32 v134, v104
  v_mov_b32 v135, v104
  s_lshl_b32 s66, s63, 12
  s_add_u32 s66, s66, 262144
  s_lshl_b32 s67, s63, 13
  s_add_u32 s67, s67, 327680
  s_mov_b32 s68, 0xffff
  s_mov_b32 s69, 0xffff
  v_add_u32 v251, 139264, v1
  v_lshrrev_b32 v6, 1, v1
  v_xor_b32 v6, v6, v1
  v_and_b32 v6, 64, v6
  v_lshl_or_b32 v6, v6, 1, v6
  v_xor_b32 v7, v1, v6
  s_and_b32 s57, s2, 15
  s_lshl_b32 s57, s57, 12
  s_lshl_b32 s58, s63, 10
  s_add_u32 s57, s57, s58
  s_add_u32 s57, s57, 720896
  s_add_u32 s58, s57, 256
  s_add_u32 s59, s57, 512
  s_add_u32 s60, s57, 768
  s_and_b32 s57, s2, 15
  s_lshl_b32 s57, s57, 12
  s_lshl_b32 s58, s63, 8
  s_add_u32 s57, s57, s58
  s_add_u32 s57, s57, 720896
  s_add_u32 s58, s57, 1024
  s_add_u32 s74, s57, 3072
  s_add_u32 s75, s57, 2048
  ds_read_b32 v6, v2 offset:144
  s_waitcnt lgkmcnt(0)
  v_cmp_gt_u32 vcc, 1, v6
  s_cbranch_vccnz akf_spin
akf_ok:
  s_mov_b32 s24, s61
  s_mov_b32 s25, s61
  s_load_dwordx16 s[8:23], s[32:33], s57 glc
  s_load_dwordx16 s[36:51], s[32:33], s58 glc
  s_waitcnt lgkmcnt(0)
  s_xor_b64 s[8:9], s[8:9], s[24:25]
  s_xor_b64 s[10:11], s[10:11], s[24:25]
  s_xor_b64 s[12:13], s[12:13], s[24:25]
  s_xor_b64 s[14:15], s[14:15], s[24:25]
  s_xor_b64 s[16:17], s[16:17], s[24:25]
  s_xor_b64 s[18:19], s[18:19], s[24:25]
  s_xor_b64 s[20:21], s[20:21], s[24:25]
  s_xor_b64 s[22:23], s[22:23], s[24:25]
  s_xor_b64 s[36:37], s[36:37], s[24:25]
  s_xor_b64 s[38:39], s[38:39], s[24:25]
  s_xor_b64 s[40:41], s[40:41], s[24:25]
  s_xor_b64 s[42:43], s[42:43], s[24:25]
  s_xor_b64 s[44:45], s[44:45], s[24:25]
  s_xor_b64 s[46:47], s[46:47], s[24:25]
  s_xor_b64 s[48:49], s[48:49], s[24:25]
  s_xor_b64 s[50:51], s[50:51], s[24:25]
  s_or_b64 s[8:9], s[8:9], s[10:11]
  s_or_b64 s[8:9], s[8:9], s[12:13]
  s_or_b64 s[8:9], s[8:9], s[14:15]
  s_or_b64 s[8:9], s[8:9], s[16:17]
  s_or_b64 s[8:9], s[8:9], s[18:19]
  s_or_b64 s[8:9], s[8:9], s[20:21]
  s_or_b64 s[8:9], s[8:9], s[22:23]
  s_or_b64 s[8:9], s[8:9], s[36:37]
  s_or_b64 s[8:9], s[8:9], s[38:39]
  s_or_b64 s[8:9], s[8:9], s[40:41]
  s_or_b64 s[8:9], s[8:9], s[42:43]
  s_or_b64 s[8:9], s[8:9], s[44:45]
  s_or_b64 s[8:9], s[8:9], s[46:47]
  s_or_b64 s[8:9], s[8:9], s[48:49]
  s_or_b64 s[8:9], s[8:9], s[50:51]
  s_cbranch_scc0 sk1_d
  s_mov_b32 s24, s61
  s_mov_b32 s25, s61
  s_mov_b32 s62, 200000
sk0_l:
  s_load_dwordx16 s[8:23], s[32:33], s58 glc
  s_waitcnt lgkmcnt(0)
  s_xor_b64 s[8:9], s[8:9], s[24:25]
  s_xor_b64 s[10:11], s[10:11], s[24:25]
  s_xor_b64 s[12:13], s[12:13], s[24:25]
  s_xor_b64 s[14:15], s[14:15], s[24:25]
  s_xor_b64 s[16:17], s[16:17], s[24:25]
  s_xor_b64 s[18:19], s[18:19], s[24:25]
  s_xor_b64 s[20:21], s[20:21], s[24:25]
  s_xor_b64 s[22:23], s[22:23], s[24:25]
  s_or_b64 s[8:9], s[8:9], s[10:11]
  s_or_b64 s[8:9], s[8:9], s[12:13]
  s_or_b64 s[8:9], s[8:9], s[14:15]
  s_or_b64 s[8:9], s[8:9], s[16:17]
  s_or_b64 s[8:9], s[8:9], s[18:19]
  s_or_b64 s[8:9], s[8:9], s[20:21]
  s_or_b64 s[8:9], s[8:9], s[22:23]
  s_cbranch_scc0 sk0_d
  s_sleep 1
  s_sub_u32 s62, s62, 1
  s_cmp_lg_u32 s62, 0
  s_cbranch_scc1 sk0_l
sk0_d:
  s_mov_b32 s24, s61
  s_mov_b32 s25, s61
  s_mov_b32 s62, 200000
sk1_l:
  s_load_dwordx16 s[8:23], s[32:33], s57 glc
  s_waitcnt lgkmcnt(0)
  s_xor_b64 s[8:9], s[8:9], s[24:25]
  s_xor_b64 s[10:11], s[10:11], s[24:25]
  s_xor_b64 s[12:13], s[12:13], s[24:25]
  s_xor_b64 s[14:15], s[14:15], s[24:25]
  s_xor_b64 s[16:17], s[16:17], s[24:25]
  s_xor_b64 s[18:19], s[18:19], s[24:25]
  s_xor_b64 s[20:21], s[20:21], s[24:25]
  s_xor_b64 s[22:23], s[22:23], s[24:25]
  s_or_b64 s[8:9], s[8:9], s[10:11]
  s_or_b64 s[8:9], s[8:9], s[12:13]
  s_or_b64 s[8:9], s[8:9], s[14:15]
  s_or_b64 s[8:9], s[8:9], s[16:17]
  s_or_b64 s[8:9], s[8:9], s[18:19]
  s_or_b64 s[8:9], s[8:9], s[20:21]
  s_or_b64 s[8:9], s[8:9], s[22:23]
  s_cbranch_scc0 sk1_d
  s_sleep 1
  s_sub_u32 s62, s62, 1
  s_cmp_lg_u32 s62, 0
  s_cbranch_scc1 sk1_l
sk1_d:
  s_add_u32 s70, s66, 0
  buffer_load_dwordx4 v[40:43], v7, s[32:35], s70 offen offset:0
  s_add_u32 s71, s67, 0
  s_mov_b64 exec, s[68:69]
  buffer_load_dwordx4 v[104:107], v1, s[32:35], s71 offen offset:0
  buffer_load_dwordx4 v[108:111], v1, s[32:35], s71 offen offset:1024
  s_mov_b64 exec, -1
  buffer_load_dwordx4 v[44:47], v7, s[32:35], s70 offen offset:1024
  s_mov_b64 exec, s[68:69]
  buffer_load_dwordx4 v[112:115], v1, s[32:35], s71 offen offset:2048
  buffer_load_dwordx4 v[116:119], v1, s[32:35], s71 offen offset:3072
  s_mov_b64 exec, -1
  ds_read_b32 v6, v2 offset:16
  s_waitcnt lgkmcnt(0)
  v_cmp_gt_u32 vcc, 4, v6
  s_cbranch_vccnz aq_spin
aq_ok:
  ds_read_b128 v[8:11], v251 offset:0
  ds_read_b128 v[12:15], v251 offset:1024
  ds_read_b128 v[16:19], v251 offset:2048
  ds_read_b128 v[20:23], v251 offset:3072
  ds_read_b128 v[24:27], v251 offset:4096
  ds_read_b128 v[28:31], v251 offset:5120
  ds_read_b128 v[32:35], v251 offset:6144
  ds_read_b128 v[36:39], v251 offset:7168
  s_waitcnt vmcnt(5)
  s_waitcnt lgkmcnt(4)
  s_setprio 1
  v_mfma_f32_32x32x16_bf16 v[136:151], v[40:43], v[8:11], 0
  s_mul_i32 s57, s63, 9216
  s_add_u32 s57, s57, 65536
  v_add_u32 v5, s57, v1
  v_lshrrev_b32 v6, 2, v1
  v_add_u32 v6, s57, v6
  s_waitcnt lgkmcnt(0)
  s_nop 7
.p2align 3
  buffer_load_dwordx4 v[48:51], v7, s[32:35], s70 offen offset:2048
  s_add_u32 s71, s67, 4096
  s_mov_b64 exec, s[68:69]
  buffer_load_dwordx4 v[120:123], v1, s[32:35], s71 offen offset:0
  buffer_load_dwordx4 v[124:127], v1, s[32:35], s71 offen offset:1024
  s_mov_b64 exec, -1
  v_exp_f32 v136, v136
  v_exp_f32 v137, v137
  v_exp_f32 v138, v138
  v_mfma_f32_32x32x16_bf16 v[152:167], v[40:43], v[12:15], 0
  v_exp_f32 v139, v139
  v_cvt_pk_bf16_f32 v168, v136, v137
  v_exp_f32 v140, v140
  v_exp_f32 v141, v141
  v_cvt_pk_bf16_f32 v169, v138, v139
  v_exp_f32 v142, v142
  v_exp_f32 v143, v143
  v_cvt_pk_bf16_f32 v170, v140, v141
  v_exp_f32 v144, v144
  v_exp_f32 v145, v145
  v_cvt_pk_bf16_f32 v171, v142, v143
  v_exp_f32 v146, v146
  v_exp_f32 v147, v147
  v_cvt_pk_bf16_f32 v172, v144, v145
  v_exp_f32 v148, v148
  v_exp_f32 v149, v149
  v_cvt_pk_bf16_f32 v173, v146, v147
  v_exp_f32 v150, v150
  v_exp_f32 v151, v151
  v_cvt_pk_bf16_f32 v174, v148, v149
  v_cvt_pk_bf16_f32 v175, v150, v151
  s_waitcnt vmcnt(6)
  v_mfma_f32_32x32x16_bf16 v[184:199], v[104:107], v[168:171], 0
  s_mov_b64 exec, s[68:69]
  buffer_load_dwordx4 v[128:131], v1, s[32:35], s71 offen offset:2048
  buffer_load_dwordx4 v[132:135], v1, s[32:35], s71 offen offset:3072
  s_mov_b64 exec, -1
  v_exp_f32 v152, v152
  v_exp_f32 v153, v153
  v_exp_f32 v154, v154
  v_mfma_f32_32x32x16_bf16 v[136:151], v[40:43], v[16:19], 0
  v_exp_f32 v155, v155
  v_cvt_pk_bf16_f32 v176, v152, v153
  v_exp_f32 v156, v156
  v_exp_f32 v157, v157
  v_mfma_f32_32x32x16_bf16 v[184:199], v[108:111], v[172:175], v[184:199]
  v_cvt_pk_bf16_f32 v177, v154, v155
  v_exp_f32 v158, v158
  v_exp_f32 v159, v159
  v_cvt_pk_bf16_f32 v178, v156, v157
  v_exp_f32 v160, v160
  v_exp_f32 v161, v161
  v_cvt_pk_bf16_f32 v179, v158, v159
  v_exp_f32 v162, v162
  v_exp_f32 v163, v163
  v_cvt_pk_bf16_f32 v180, v160, v161
  v_exp_f32 v164, v164
  v_exp_f32 v165, v165
  v_cvt_pk_bf16_f32 v181, v162, v163
  v_exp_f32 v166, v166
  v_exp_f32 v167, v167
  v_cvt_pk_bf16_f32 v182, v164, v165
  v_cvt_pk_bf16_f32 v183, v166, v167
  v_mfma_f32_32x32x16_bf16 v[200:215], v[104:107], v[176:179], 0
  buffer_load_dwordx4 v[52:55], v7, s[32:35], s70 offen offset:3072
  v_exp_f32 v136, v136
  v_exp_f32 v137, v137
  v_exp_f32 v138, v138
  v_mfma_f32_32x32x16_bf16 v[152:167], v[40:43], v[20:23], 0
  v_exp_f32 v139, v139
  v_cvt_pk_bf16_f32 v168, v136, v137
  v_exp_f32 v140, v140
  v_exp_f32 v141, v141
  v_mfma_f32_32x32x16_bf16 v[200:215], v[108:111], v[180:183], v[200:215]
  v_cvt_pk_bf16_f32 v169, v138, v139
  v_exp_f32 v142, v142
  v_exp_f32 v143, v143
  v_cvt_pk_bf16_f32 v170, v140, v141
  v_exp_f32 v144, v144
  v_exp_f32 v145, v145
  v_cvt_pk_bf16_f32 v171, v142, v143
  v_exp_f32 v146, v146
  v_exp_f32 v147, v147
  v_cvt_pk_bf16_f32 v172, v144, v145
  v_exp_f32 v148, v148
  v_exp_f32 v149, v149
  v_cvt_pk_bf16_f32 v173, v146, v147
  v_exp_f32 v150, v150
  v_exp_f32 v151, v151
  v_cvt_pk_bf16_f32 v174, v148, v149
  v_cvt_pk_bf16_f32 v175, v150, v151
  s_waitcnt vmcnt(8)
  v_mfma_f32_32x32x16_bf16 v[216:231], v[104:107], v[168:171], 0
  s_add_u32 s70, s66, 16384
  buffer_load_dwordx4 v[56:59], v7, s[32:35], s70 offen offset:0
  v_exp_f32 v152, v152
  v_exp_f32 v153, v153
  v_exp_f32 v154, v154
  v_mfma_f32_32x32x16_bf16 v[136:151], v[44:47], v[8:11], 0
  v_exp_f32 v155, v155
  v_cvt_pk_bf16_f32 v176, v152, v153
  v_exp_f32 v156, v156
  v_exp_f32 v157, v157
  v_mfma_f32_32x32x16_bf16 v[216:231], v[108:111], v[172:175], v[216:231]
  v_cvt_pk_bf16_f32 v177, v154, v155
  v_exp_f32 v158, v158
  v_exp_f32 v159, v159
  v_cvt_pk_bf16_f32 v178, v156, v157
  v_exp_f32 v160, v160
  v_exp_f32 v161, v161
  v_cvt_pk_bf16_f32 v179, v158, v159
  v_exp_f32 v162, v162
  v_exp_f32 v163, v163
  v_cvt_pk_bf16_f32 v180, v160, v161
  v_exp_f32 v164, v164
  v_exp_f32 v165, v165
  v_cvt_pk_bf16_f32 v181, v162, v163
  v_exp_f32 v166, v166
  v_exp_f32 v167, v167
  v_cvt_pk_bf16_f32 v182, v164, v165
  v_cvt_pk_bf16_f32 v183, v166, v167
  v_mfma_f32_32x32x16_bf16 v[232:247], v[104:107], v[176:179], 0
  v_exp_f32 v136, v136
  v_exp_f32 v137, v137
  v_exp_f32 v138, v138
  v_mfma_f32_32x32x16_bf16 v[152:167], v[44:47], v[12:15], 0
  v_exp_f32 v139, v139
  v_cvt_pk_bf16_f32 v168, v136, v137
  v_exp_f32 v140, v140
  v_exp_f32 v141, v141
  v_mfma_f32_32x32x16_bf16 v[232:247], v[108:111], v[180:183], v[232:247]
  v_cvt_pk_bf16_f32 v169, v138, v139
  v_exp_f32 v142, v142
  v_exp_f32 v143, v143
  v_cvt_pk_bf16_f32 v170, v140, v141
  v_exp_f32 v144, v144
  v_exp_f32 v145, v145
  v_cvt_pk_bf16_f32 v171, v142, v143
  v_exp_f32 v146, v146
  v_exp_f32 v147, v147
  v_cvt_pk_bf16_f32 v172, v144, v145
  v_exp_f32 v148, v148
  v_exp_f32 v149, v149
  v_cvt_pk_bf16_f32 v173, v146, v147
  v_exp_f32 v150, v150
  v_exp_f32 v151, v151
  v_cvt_pk_bf16_f32 v174, v148, v149
  v_cvt_pk_bf16_f32 v175, v150, v151
  s_waitcnt vmcnt(7)
  v_mfma_f32_32x32x16_bf16 v[184:199], v[112:115], v[168:171], v[184:199]
  s_add_u32 s71, s67, 32768
  s_mov_b64 exec, s[68:69]
  buffer_load_dwordx4 v[104:107], v1, s[32:35], s71 offen offset:0
  buffer_load_dwordx4 v[108:111], v1, s[32:35], s71 offen offset:1024
  s_mov_b64 exec, -1
  v_exp_f32 v152, v152
  v_exp_f32 v153, v153
  v_exp_f32 v154, v154
  v_mfma_f32_32x32x16_bf16 v[136:151], v[44:47], v[16:19], 0
  v_exp_f32 v155, v155
  v_cvt_pk_bf16_f32 v176, v152, v153
  v_exp_f32 v156, v156
  v_exp_f32 v157, v157
  v_mfma_f32_32x32x16_bf16 v[184:199], v[116:119], v[172:175], v[184:199]
  v_cvt_pk_bf16_f32 v177, v154, v155
  v_exp_f32 v158, v158
  v_exp_f32 v159, v159
  v_cvt_pk_bf16_f32 v178, v156, v157
  v_exp_f32 v160, v160
  v_exp_f32 v161, v161
  v_cvt_pk_bf16_f32 v179, v158, v159
  v_exp_f32 v162, v162
  v_exp_f32 v163, v163
  v_cvt_pk_bf16_f32 v180, v160, v161
  v_exp_f32 v164, v164
  v_exp_f32 v165, v165
  v_cvt_pk_bf16_f32 v181, v162, v163
  v_exp_f32 v166, v166
  v_exp_f32 v167, v167
  v_cvt_pk_bf16_f32 v182, v164, v165
  v_cvt_pk_bf16_f32 v183, v166, v167
  v_mfma_f32_32x32x16_bf16 v[200:215], v[112:115], v[176:179], v[200:215]
  v_exp_f32 v136, v136
  v_exp_f32 v137, v137
  v_exp_f32 v138, v138
  v_mfma_f32_32x32x16_bf16 v[152:167], v[44:47], v[20:23], 0
  v_exp_f32 v139, v139
  v_cvt_pk_bf16_f32 v168, v136, v137
  v_exp_f32 v140, v140
  v_exp_f32 v141, v141
  v_mfma_f32_32x32x16_bf16 v[200:215], v[116:119], v[180:183], v[200:215]
  v_cvt_pk_bf16_f32 v169, v138, v139
  v_exp_f32 v142, v142
  v_exp_f32 v143, v143
  v_cvt_pk_bf16_f32 v170, v140, v141
  v_exp_f32 v144, v144
  v_exp_f32 v145, v145
  v_cvt_pk_bf16_f32 v171, v142, v143
  v_exp_f32 v146, v146
  v_exp_f32 v147, v147
  v_cvt_pk_bf16_f32 v172, v144, v145
  v_exp_f32 v148, v148
  v_exp_f32 v149, v149
  v_cvt_pk_bf16_f32 v173, v146, v147
  v_exp_f32 v150, v150
  v_exp_f32 v151, v151
  v_cvt_pk_bf16_f32 v174, v148, v149
  v_cvt_pk_bf16_f32 v175, v150, v151
  s_waitcnt vmcnt(8)
  v_mfma_f32_32x32x16_bf16 v[216:231], v[112:115], v[168:171], v[216:231]
  buffer_load_dwordx4 v[60:63], v7, s[32:35], s70 offen offset:1024
  v_exp_f32 v152, v152
  v_exp_f32 v153, v153
  v_exp_f32 v154, v154
  v_mfma_f32_32x32x16_bf16 v[136:151], v[48:51], v[8:11], 0
  v_exp_f32 v155, v155
  v_cvt_pk_bf16_f32 v176, v152, v153
  v_exp_f32 v156, v156
  v_exp_f32 v157, v157
  v_mfma_f32_32x32x16_bf16 v[216:231], v[116:119], v[172:175], v[216:231]
  v_cvt_pk_bf16_f32 v177, v154, v155
  v_exp_f32 v158, v158
  v_exp_f32 v159, v159
  v_cvt_pk_bf16_f32 v178, v156, v157
  v_exp_f32 v160, v160
  v_exp_f32 v161, v161
  v_cvt_pk_bf16_f32 v179, v158, v159
  v_exp_f32 v162, v162
  v_exp_f32 v163, v163
  v_cvt_pk_bf16_f32 v180, v160, v161
  v_exp_f32 v164, v164
  v_exp_f32 v165, v165
  v_cvt_pk_bf16_f32 v181, v162, v163
  v_exp_f32 v166, v166
  v_exp_f32 v167, v167
  v_cvt_pk_bf16_f32 v182, v164, v165
  v_cvt_pk_bf16_f32 v183, v166, v167
  v_mfma_f32_32x32x16_bf16 v[232:247], v[112:115], v[176:179], v[232:247]
  v_exp_f32 v136, v136
  v_exp_f32 v137, v137
  v_exp_f32 v138, v138
  v_mfma_f32_32x32x16_bf16 v[152:167], v[48:51], v[12:15], 0
  v_exp_f32 v139, v139
  v_cvt_pk_bf16_f32 v168, v136, v137
  v_exp_f32 v140, v140
  v_exp_f32 v141, v141
  v_mfma_f32_32x32x16_bf16 v[232:247], v[116:119], v[180:183], v[232:247]
  v_cvt_pk_bf16_f32 v169, v138, v139
  v_exp_f32 v142, v142
  v_exp_f32 v143, v143
  v_cvt_pk_bf16_f32 v170, v140, v141
  v_exp_f32 v144, v144
  v_exp_f32 v145, v145
  v_cvt_pk_bf16_f32 v171, v142, v143
  v_exp_f32 v146, v146
  v_exp_f32 v147, v147
  v_cvt_pk_bf16_f32 v172, v144, v145
  v_exp_f32 v148, v148
  v_exp_f32 v149, v149
  v_cvt_pk_bf16_f32 v173, v146, v147
  v_exp_f32 v150, v150
  v_exp_f32 v151, v151
  v_cvt_pk_bf16_f32 v174, v148, v149
  v_cvt_pk_bf16_f32 v175, v150, v151
  s_waitcnt vmcnt(7)
  v_mfma_f32_32x32x16_bf16 v[184:199], v[120:123], v[168:171], v[184:199]
  s_mov_b64 exec, s[68:69]
  buffer_load_dwordx4 v[112:115], v1, s[32:35], s71 offen offset:2048
  buffer_load_dwordx4 v[116:119], v1, s[32:35], s71 offen offset:3072
  s_mov_b64 exec, -1
  v_exp_f32 v152, v152
  v_exp_f32 v153, v153
  v_exp_f32 v154, v154
  v_mfma_f32_32x32x16_bf16 v[136:151], v[48:51], v[16:19], 0
  v_exp_f32 v155, v155
  v_cvt_pk_bf16_f32 v176, v152, v153
  v_exp_f32 v156, v156
  v_exp_f32 v157, v157
  v_mfma_f32_32x32x16_bf16 v[184:199], v[124:127], v[172:175], v[184:199]
  v_cvt_pk_bf16_f32 v177, v154, v155
  v_exp_f32 v158, v158
  v_exp_f32 v159, v159
  v_cvt_pk_bf16_f32 v178, v156, v157
  v_exp_f32 v160, v160
  v_exp_f32 v161, v161
  v_cvt_pk_bf16_f32 v179, v158, v159
  v_exp_f32 v162, v162
  v_exp_f32 v163, v163
  v_cvt_pk_bf16_f32 v180, v160, v161
  v_exp_f32 v164, v164
  v_exp_f32 v165, v165
  v_cvt_pk_bf16_f32 v181, v162, v163
  v_exp_f32 v166, v166
  v_exp_f32 v167, v167
  v_cvt_pk_bf16_f32 v182, v164, v165
  v_cvt_pk_bf16_f32 v183, v166, v167
  v_mfma_f32_32x32x16_bf16 v[200:215], v[120:123], v[176:179], v[200:215]
  v_exp_f32 v136, v136
  v_exp_f32 v137, v137
  v_exp_f32 v138, v138
  v_mfma_f32_32x32x16_bf16 v[152:167], v[48:51], v[20:23], 0
  v_exp_f32 v139, v139
  v_cvt_pk_bf16_f32 v168, v136, v137
  v_exp_f32 v140, v140
  v_exp_f32 v141, v141
  v_mfma_f32_32x32x16_bf16 v[200:215], v[124:127], v[180:183], v[200:215]
  v_cvt_pk_bf16_f32 v169, v138, v139
  v_exp_f32 v142, v142
  v_exp_f32 v143, v143
  v_cvt_pk_bf16_f32 v170, v140, v141
  v_exp_f32 v144, v144
  v_exp_f32 v145, v145
  v_cvt_pk_bf16_f32 v171, v142, v143
  v_exp_f32 v146, v146
  v_exp_f32 v147, v147
  v_cvt_pk_bf16_f32 v172, v144, v145
  v_exp_f32 v148, v148
  v_exp_f32 v149, v149
  v_cvt_pk_bf16_f32 v173, v146, v147
  v_exp_f32 v150, v150
  v_exp_f32 v151, v151
  v_cvt_pk_bf16_f32 v174, v148, v149
  v_cvt_pk_bf16_f32 v175, v150, v151
  s_waitcnt vmcnt(6)
  v_mfma_f32_32x32x16_bf16 v[216:231], v[120:123], v[168:171], v[216:231]
  buffer_load_dwordx4 v[64:67], v7, s[32:35], s70 offen offset:2048
  v_exp_f32 v152, v152
  v_exp_f32 v153, v153
  v_exp_f32 v154, v154
  v_mfma_f32_32x32x16_bf16 v[136:151], v[52:55], v[8:11], 0
  v_exp_f32 v155, v155
  v_cvt_pk_bf16_f32 v176, v152, v153
  v_exp_f32 v156, v156
  v_exp_f32 v157, v157
  v_mfma_f32_32x32x16_bf16 v[216:231], v[124:127], v[172:175], v[216:231]
  v_cvt_pk_bf16_f32 v177, v154, v155
  v_exp_f32 v158, v158
  v_exp_f32 v159, v159
  v_cvt_pk_bf16_f32 v178, v156, v157
  v_exp_f32 v160, v160
  v_exp_f32 v161, v161
  v_cvt_pk_bf16_f32 v179, v158, v159
  v_exp_f32 v162, v162
  v_exp_f32 v163, v163
  v_cvt_pk_bf16_f32 v180, v160, v161
  v_exp_f32 v164, v164
  v_exp_f32 v165, v165
  v_cvt_pk_bf16_f32 v181, v162, v163
  v_exp_f32 v166, v166
  v_exp_f32 v167, v167
  v_cvt_pk_bf16_f32 v182, v164, v165
  v_cvt_pk_bf16_f32 v183, v166, v167
  v_mfma_f32_32x32x16_bf16 v[232:247], v[120:123], v[176:179], v[232:247]
  v_exp_f32 v136, v136
  v_exp_f32 v137, v137
  v_exp_f32 v138, v138
  v_mfma_f32_32x32x16_bf16 v[152:167], v[52:55], v[12:15], 0
  v_exp_f32 v139, v139
  v_cvt_pk_bf16_f32 v168, v136, v137
  v_exp_f32 v140, v140
  v_exp_f32 v141, v141
  v_mfma_f32_32x32x16_bf16 v[232:247], v[124:127], v[180:183], v[232:247]
  v_cvt_pk_bf16_f32 v169, v138, v139
  v_exp_f32 v142, v142
  v_exp_f32 v143, v143
  v_cvt_pk_bf16_f32 v170, v140, v141
  v_exp_f32 v144, v144
  v_exp_f32 v145, v145
  v_cvt_pk_bf16_f32 v171, v142, v143
  v_exp_f32 v146, v146
  v_exp_f32 v147, v147
  v_cvt_pk_bf16_f32 v172, v144, v145
  v_exp_f32 v148, v148
  v_exp_f32 v149, v149
  v_cvt_pk_bf16_f32 v173, v146, v147
  v_exp_f32 v150, v150
  v_exp_f32 v151, v151
  v_cvt_pk_bf16_f32 v174, v148, v149
  v_cvt_pk_bf16_f32 v175, v150, v151
  v_mfma_f32_32x32x16_bf16 v[184:199], v[128:131], v[168:171], v[184:199]
  s_add_u32 s71, s67, 36864
  s_mov_b64 exec, s[68:69]
  buffer_load_dwordx4 v[120:123], v1, s[32:35], s71 offen offset:0
  buffer_load_dwordx4 v[124:127], v1, s[32:35], s71 offen offset:1024
  s_mov_b64 exec, -1
  v_exp_f32 v152, v152
  v_exp_f32 v153, v153
  v_exp_f32 v154, v154
  v_mfma_f32_32x32x16_bf16 v[136:151], v[52:55], v[16:19], 0
  v_exp_f32 v155, v155
  v_cvt_pk_bf16_f32 v176, v152, v153
  v_exp_f32 v156, v156
  v_exp_f32 v157, v157
  v_mfma_f32_32x32x16_bf16 v[184:199], v[132:135], v[172:175], v[184:199]
  v_cvt_pk_bf16_f32 v177, v154, v155
  v_exp_f32 v158, v158
  v_exp_f32 v159, v159
  v_cvt_pk_bf16_f32 v178, v156, v157
  v_exp_f32 v160, v160
  v_exp_f32 v161, v161
  v_cvt_pk_bf16_f32 v179, v158, v159
  v_exp_f32 v162, v162
  v_exp_f32 v163, v163
  v_cvt_pk_bf16_f32 v180, v160, v161
  v_exp_f32 v164, v164
  v_exp_f32 v165, v165
  v_cvt_pk_bf16_f32 v181, v162, v163
  v_exp_f32 v166, v166
  v_exp_f32 v167, v167
  v_cvt_pk_bf16_f32 v182, v164, v165
  v_cvt_pk_bf16_f32 v183, v166, v167
  v_mfma_f32_32x32x16_bf16 v[200:215], v[128:131], v[176:179], v[200:215]
  v_exp_f32 v136, v136
  v_exp_f32 v137, v137
  v_exp_f32 v138, v138
  v_mfma_f32_32x32x16_bf16 v[152:167], v[52:55], v[20:23], 0
  v_exp_f32 v139, v139
  v_cvt_pk_bf16_f32 v168, v136, v137
  v_exp_f32 v140, v140
  v_exp_f32 v141, v141
  v_mfma_f32_32x32x16_bf16 v[200:215], v[132:135], v[180:183], v[200:215]
  v_cvt_pk_bf16_f32 v169, v138, v139
  v_exp_f32 v142, v142
  v_exp_f32 v143, v143
  v_cvt_pk_bf16_f32 v170, v140, v141
  v_exp_f32 v144, v144
  v_exp_f32 v145, v145
  v_cvt_pk_bf16_f32 v171, v142, v143
  v_exp_f32 v146, v146
  v_exp_f32 v147, v147
  v_cvt_pk_bf16_f32 v172, v144, v145
  v_exp_f32 v148, v148
  v_exp_f32 v149, v149
  v_cvt_pk_bf16_f32 v173, v146, v147
  v_exp_f32 v150, v150
  v_exp_f32 v151, v151
  v_cvt_pk_bf16_f32 v174, v148, v149
  v_cvt_pk_bf16_f32 v175, v150, v151
  s_load_dwordx16 s[8:23], s[32:33], s74 glc
  s_waitcnt vmcnt(8)
  v_mfma_f32_32x32x16_bf16 v[216:231], v[128:131], v[168:171], v[216:231]
  buffer_load_dwordx4 v[68:71], v7, s[32:35], s70 offen offset:3072
  v_exp_f32 v152, v152
  v_exp_f32 v153, v153
  v_exp_f32 v154, v154
  v_mfma_f32_32x32x16_bf16 v[136:151], v[56:59], v[8:11], 0
  v_exp_f32 v155, v155
  v_cvt_pk_bf16_f32 v176, v152, v153
  v_exp_f32 v156, v156
  v_exp_f32 v157, v157
  v_mfma_f32_32x32x16_bf16 v[216:231], v[132:135], v[172:175], v[216:231]
  v_cvt_pk_bf16_f32 v177, v154, v155
  v_exp_f32 v158, v158
  v_exp_f32 v159, v159
  v_cvt_pk_bf16_f32 v178, v156, v157
  v_exp_f32 v160, v160
  v_exp_f32 v161, v161
  v_cvt_pk_bf16_f32 v179, v158, v159
  v_exp_f32 v162, v162
  v_exp_f32 v163, v163
  v_cvt_pk_bf16_f32 v180, v160, v161
  v_exp_f32 v164, v164
  v_exp_f32 v165, v165
  v_cvt_pk_bf16_f32 v181, v162, v163
  v_exp_f32 v166, v166
  v_exp_f32 v167, v167
  v_cvt_pk_bf16_f32 v182, v164, v165
  v_cvt_pk_bf16_f32 v183, v166, v167
  v_mfma_f32_32x32x16_bf16 v[232:247], v[128:131], v[176:179], v[232:247]
  v_exp_f32 v136, v136
  v_exp_f32 v137, v137
  v_exp_f32 v138, v138
  v_mfma_f32_32x32x16_bf16 v[152:167], v[56:59], v[12:15], 0
  v_exp_f32 v139, v139
  v_cvt_pk_bf16_f32 v168, v136, v137
  v_exp_f32 v140, v140
  v_exp_f32 v141, v141
  v_mfma_f32_32x32x16_bf16 v[232:247], v[132:135], v[180:183], v[232:247]
  v_cvt_pk_bf16_f32 v169, v138, v139
  v_exp_f32 v142, v142
  v_exp_f32 v143, v143
  v_cvt_pk_bf16_f32 v170, v140, v141
  v_exp_f32 v144, v144
  v_exp_f32 v145, v145
  v_cvt_pk_bf16_f32 v171, v142, v143
  v_exp_f32 v146, v146
  v_exp_f32 v147, v147
  v_cvt_pk_bf16_f32 v172, v144, v145
  v_exp_f32 v148, v148
  v_exp_f32 v149, v149
  v_cvt_pk_bf16_f32 v173, v146, v147
  v_exp_f32 v150, v150
  v_exp_f32 v151, v151
  v_cvt_pk_bf16_f32 v174, v148, v149
  v_cvt_pk_bf16_f32 v175, v150, v151
  s_waitcnt vmcnt(7)
  v_mfma_f32_32x32x16_bf16 v[184:199], v[104:107], v[168:171], v[184:199]
  s_mov_b64 exec, s[68:69]
  buffer_load_dwordx4 v[128:131], v1, s[32:35], s71 offen offset:2048
  buffer_load_dwordx4 v[132:135], v1, s[32:35], s71 offen offset:3072
  s_mov_b64 exec, -1
  v_exp_f32 v152, v152
  v_exp_f32 v153, v153
  v_exp_f32 v154, v154
  v_mfma_f32_32x32x16_bf16 v[136:151], v[56:59], v[16:19], 0
  v_exp_f32 v155, v155
  v_cvt_pk_bf16_f32 v176, v152, v153
  v_exp_f32 v156, v156
  v_exp_f32 v157, v157
  v_mfma_f32_32x32x16_bf16 v[184:199], v[108:111], v[172:175], v[184:199]
  v_cvt_pk_bf16_f32 v177, v154, v155
  v_exp_f32 v158, v158
  v_exp_f32 v159, v159
  v_cvt_pk_bf16_f32 v178, v156, v157
  v_exp_f32 v160, v160
  v_exp_f32 v161, v161
  v_cvt_pk_bf16_f32 v179, v158, v159
  v_exp_f32 v162, v162
  v_exp_f32 v163, v163
  v_cvt_pk_bf16_f32 v180, v160, v161
  v_exp_f32 v164, v164
  v_exp_f32 v165, v165
  v_cvt_pk_bf16_f32 v181, v162, v163
  v_exp_f32 v166, v166
  v_exp_f32 v167, v167
  v_cvt_pk_bf16_f32 v182, v164, v165
  v_cvt_pk_bf16_f32 v183, v166, v167
  v_mfma_f32_32x32x16_bf16 v[200:215], v[104:107], v[176:179], v[200:215]
  v_exp_f32 v136, v136
  v_exp_f32 v137, v137
  v_exp_f32 v138, v138
  v_mfma_f32_32x32x16_bf16 v[152:167], v[56:59], v[20:23], 0
  v_exp_f32 v139, v139
  v_cvt_pk_bf16_f32 v168, v136, v137
  v_exp_f32 v140, v140
  v_exp_f32 v141, v141
  v_mfma_f32_32x32x16_bf16 v[200:215], v[108:111], v[180:183], v[200:215]
  v_cvt_pk_bf16_f32 v169, v138, v139
  v_exp_f32 v142, v142
  v_exp_f32 v143, v143
  v_cvt_pk_bf16_f32 v170, v140, v141
  v_exp_f32 v144, v144
  v_exp_f32 v145, v145
  v_cvt_pk_bf16_f32 v171, v142, v143
  v_exp_f32 v146, v146
  v_exp_f32 v147, v147
  v_cvt_pk_bf16_f32 v172, v144, v145
  v_exp_f32 v148, v148
  v_exp_f32 v149, v149
  v_cvt_pk_bf16_f32 v173, v146, v147
  v_exp_f32 v150, v150
  v_exp_f32 v151, v151
  v_cvt_pk_bf16_f32 v174, v148, v149
  v_cvt_pk_bf16_f32 v175, v150, v151
  s_waitcnt lgkmcnt(0)
  s_xor_b64 s[8:9], s[8:9], s[24:25]
  s_xor_b64 s[10:11], s[10:11], s[24:25]
  s_xor_b64 s[12:13], s[12:13], s[24:25]
  s_xor_b64 s[14:15], s[14:15], s[24:25]
  s_xor_b64 s[16:17], s[16:17], s[24:25]
  s_xor_b64 s[18:19], s[18:19], s[24:25]
  s_xor_b64 s[20:21], s[20:21], s[24:25]
  s_xor_b64 s[22:23], s[22:23], s[24:25]
  s_or_b64 s[8:9], s[8:9], s[10:11]
  s_or_b64 s[12:13], s[12:13], s[14:15]
  s_or_b64 s[16:17], s[16:17], s[18:19]
  s_or_b64 s[20:21], s[20:21], s[22:23]
  s_or_b64 s[8:9], s[8:9], s[12:13]
  s_or_b64 s[16:17], s[16:17], s[20:21]
  s_or_b64 s[8:9], s[8:9], s[16:17]
  s_cbranch_scc1 skr2_spin
skr2_ok:
  s_waitcnt vmcnt(8)
  v_mfma_f32_32x32x16_bf16 v[216:231], v[104:107], v[168:171], v[216:231]
  s_add_u32 s70, s66, 49152
  buffer_load_dwordx4 v[72:75], v7, s[32:35], s70 offen offset:0
  v_exp_f32 v152, v152
  v_exp_f32 v153, v153
  v_exp_f32 v154, v154
  v_mfma_f32_32x32x16_bf16 v[136:151], v[60:63], v[8:11], 0
  v_exp_f32 v155, v155
  v_cvt_pk_bf16_f32 v176, v152, v153
  v_exp_f32 v156, v156
  v_exp_f32 v157, v157
  v_mfma_f32_32x32x16_bf16 v[216:231], v[108:111], v[172:175], v[216:231]
  v_cvt_pk_bf16_f32 v177, v154, v155
  v_exp_f32 v158, v158
  v_exp_f32 v159, v159
  v_cvt_pk_bf16_f32 v178, v156, v157
  v_exp_f32 v160, v160
  v_exp_f32 v161, v161
  v_cvt_pk_bf16_f32 v179, v158, v159
  v_exp_f32 v162, v162
  v_exp_f32 v163, v163
  v_cvt_pk_bf16_f32 v180, v160, v161
  v_exp_f32 v164, v164
  v_exp_f32 v165, v165
  v_cvt_pk_bf16_f32 v181, v162, v163
  v_exp_f32 v166, v166
  v_exp_f32 v167, v167
  v_cvt_pk_bf16_f32 v182, v164, v165
  v_cvt_pk_bf16_f32 v183, v166, v167
  v_mfma_f32_32x32x16_bf16 v[232:247], v[104:107], v[176:179], v[232:247]
  v_exp_f32 v136, v136
  v_exp_f32 v137, v137
  v_exp_f32 v138, v138
  v_mfma_f32_32x32x16_bf16 v[152:167], v[60:63], v[12:15], 0
  v_exp_f32 v139, v139
  v_cvt_pk_bf16_f32 v168, v136, v137
  v_exp_f32 v140, v140
  v_exp_f32 v141, v141
  v_mfma_f32_32x32x16_bf16 v[232:247], v[108:111], v[180:183], v[232:247]
  v_cvt_pk_bf16_f32 v169, v138, v139
  v_exp_f32 v142, v142
  v_exp_f32 v143, v143
  v_cvt_pk_bf16_f32 v170, v140, v141
  v_exp_f32 v144, v144
  v_exp_f32 v145, v145
  v_cvt_pk_bf16_f32 v171, v142, v143
  v_exp_f32 v146, v146
  v_exp_f32 v147, v147
  v_cvt_pk_bf16_f32 v172, v144, v145
  v_exp_f32 v148, v148
  v_exp_f32 v149, v149
  v_cvt_pk_bf16_f32 v173, v146, v147
  v_exp_f32 v150, v150
  v_exp_f32 v151, v151
  v_cvt_pk_bf16_f32 v174, v148, v149
  v_cvt_pk_bf16_f32 v175, v150, v151
  s_waitcnt vmcnt(7)
  v_mfma_f32_32x32x16_bf16 v[184:199], v[112:115], v[168:171], v[184:199]
  s_add_u32 s71, s67, 98304
  s_mov_b64 exec, s[68:69]
  buffer_load_dwordx4 v[104:107], v1, s[32:35], s71 offen offset:0
  buffer_load_dwordx4 v[108:111], v1, s[32:35], s71 offen offset:1024
  s_mov_b64 exec, -1
  v_exp_f32 v152, v152
  v_exp_f32 v153, v153
  v_exp_f32 v154, v154
  v_mfma_f32_32x32x16_bf16 v[136:151], v[60:63], v[16:19], 0
  v_exp_f32 v155, v155
  v_cvt_pk_bf16_f32 v176, v152, v153
  v_exp_f32 v156, v156
  v_exp_f32 v157, v157
  v_mfma_f32_32x32x16_bf16 v[184:199], v[116:119], v[172:175], v[184:199]
  v_cvt_pk_bf16_f32 v177, v154, v155
  v_exp_f32 v158, v158
  v_exp_f32 v159, v159
  v_cvt_pk_bf16_f32 v178, v156, v157
  v_exp_f32 v160, v160
  v_exp_f32 v161, v161
  v_cvt_pk_bf16_f32 v179, v158, v159
  v_exp_f32 v162, v162
  v_exp_f32 v163, v163
  v_cvt_pk_bf16_f32 v180, v160, v161
  v_exp_f32 v164, v164
  v_exp_f32 v165, v165
  v_cvt_pk_bf16_f32 v181, v162, v163
  v_exp_f32 v166, v166
  v_exp_f32 v167, v167
  v_cvt_pk_bf16_f32 v182, v164, v165
  v_cvt_pk_bf16_f32 v183, v166, v167
  v_mfma_f32_32x32x16_bf16 v[200:215], v[112:115], v[176:179], v[200:215]
  v_exp_f32 v136, v136
  v_exp_f32 v137, v137
  v_exp_f32 v138, v138
  v_mfma_f32_32x32x16_bf16 v[152:167], v[60:63], v[20:23], 0
  v_exp_f32 v139, v139
  v_cvt_pk_bf16_f32 v168, v136, v137
  v_exp_f32 v140, v140
  v_exp_f32 v141, v141
  v_mfma_f32_32x32x16_bf16 v[200:215], v[116:119], v[180:183], v[200:215]
  v_cvt_pk_bf16_f32 v169, v138, v139
  v_exp_f32 v142, v142
  v_exp_f32 v143, v143
  v_cvt_pk_bf16_f32 v170, v140, v141
  v_exp_f32 v144, v144
  v_exp_f32 v145, v145
  v_cvt_pk_bf16_f32 v171, v142, v143
  v_exp_f32 v146, v146
  v_exp_f32 v147, v147
  v_cvt_pk_bf16_f32 v172, v144, v145
  v_exp_f32 v148, v148
  v_exp_f32 v149, v149
  v_cvt_pk_bf16_f32 v173, v146, v147
  v_exp_f32 v150, v150
  v_exp_f32 v151, v151
  v_cvt_pk_bf16_f32 v174, v148, v149
  v_cvt_pk_bf16_f32 v175, v150, v151
  s_waitcnt vmcnt(8)
  v_mfma_f32_32x32x16_bf16 v[216:231], v[112:115], v[168:171], v[216:231]
  buffer_load_dwordx4 v[76:79], v7, s[32:35], s70 offen offset:1024
  v_exp_f32 v152, v152
  v_exp_f32 v153, v153
  v_exp_f32 v154, v154
  v_mfma_f32_32x32x16_bf16 v[136:151], v[64:67], v[8:11], 0
  v_exp_f32 v155, v155
  v_cvt_pk_bf16_f32 v176, v152, v153
  v_exp_f32 v156, v156
  v_exp_f32 v157, v157
  v_mfma_f32_32x32x16_bf16 v[216:231], v[116:119], v[172:175], v[216:231]
  v_cvt_pk_bf16_f32 v177, v154, v155
  v_exp_f32 v158, v158
  v_exp_f32 v159, v159
  v_cvt_pk_bf16_f32 v178, v156, v157
  v_exp_f32 v160, v160
  v_exp_f32 v161, v161
  v_cvt_pk_bf16_f32 v179, v158, v159
  v_exp_f32 v162, v162
  v_exp_f32 v163, v163
  v_cvt_pk_bf16_f32 v180, v160, v161
  v_exp_f32 v164, v164
  v_exp_f32 v165, v165
  v_cvt_pk_bf16_f32 v181, v162, v163
  v_exp_f32 v166, v166
  v_exp_f32 v167, v167
  v_cvt_pk_bf16_f32 v182, v164, v165
  v_cvt_pk_bf16_f32 v183, v166, v167
  v_mfma_f32_32x32x16_bf16 v[232:247], v[112:115], v[176:179], v[232:247]
  v_exp_f32 v136, v136
  v_exp_f32 v137, v137
  v_exp_f32 v138, v138
  v_mfma_f32_32x32x16_bf16 v[152:167], v[64:67], v[12:15], 0
  v_exp_f32 v139, v139
  v_cvt_pk_bf16_f32 v168, v136, v137
  v_exp_f32 v140, v140
  v_exp_f32 v141, v141
  v_mfma_f32_32x32x16_bf16 v[232:247], v[116:119], v[180:183], v[232:247]
  v_cvt_pk_bf16_f32 v169, v138, v139
  v_exp_f32 v142, v142
  v_exp_f32 v143, v143
  v_cvt_pk_bf16_f32 v170, v140, v141
  v_exp_f32 v144, v144
  v_exp_f32 v145, v145
  v_cvt_pk_bf16_f32 v171, v142, v143
  v_exp_f32 v146, v146
  v_exp_f32 v147, v147
  v_cvt_pk_bf16_f32 v172, v144, v145
  v_exp_f32 v148, v148
  v_exp_f32 v149, v149
  v_cvt_pk_bf16_f32 v173, v146, v147
  v_exp_f32 v150, v150
  v_exp_f32 v151, v151
  v_cvt_pk_bf16_f32 v174, v148, v149
  v_cvt_pk_bf16_f32 v175, v150, v151
  s_waitcnt vmcnt(7)
  v_mfma_f32_32x32x16_bf16 v[184:199], v[120:123], v[168:171], v[184:199]
  s_mov_b64 exec, s[68:69]
  buffer_load_dwordx4 v[112:115], v1, s[32:35], s71 offen offset:2048
  buffer_load_dwordx4 v[116:119], v1, s[32:35], s71 offen offset:3072
  s_mov_b64 exec, -1
  v_exp_f32 v152, v152
  v_exp_f32 v153, v153
  v_exp_f32 v154, v154
  v_mfma_f32_32x32x16_bf16 v[136:151], v[64:67], v[16:19], 0
  v_exp_f32 v155, v155
  v_cvt_pk_bf16_f32 v176, v152, v153
  v_exp_f32 v156, v156
  v_exp_f32 v157, v157
  v_mfma_f32_32x32x16_bf16 v[184:199], v[124:127], v[172:175], v[184:199]
  v_cvt_pk_bf16_f32 v177, v154, v155
  v_exp_f32 v158, v158
  v_exp_f32 v159, v159
  v_cvt_pk_bf16_f32 v178, v156, v157
  v_exp_f32 v160, v160
  v_exp_f32 v161, v161
  v_cvt_pk_bf16_f32 v179, v158, v159
  v_exp_f32 v162, v162
  v_exp_f32 v163, v163
  v_cvt_pk_bf16_f32 v180, v160, v161
  v_exp_f32 v164, v164
  v_exp_f32 v165, v165
  v_cvt_pk_bf16_f32 v181, v162, v163
  v_exp_f32 v166, v166
  v_exp_f32 v167, v167
  v_cvt_pk_bf16_f32 v182, v164, v165
  v_cvt_pk_bf16_f32 v183, v166, v167
  v_mfma_f32_32x32x16_bf16 v[200:215], v[120:123], v[176:179], v[200:215]
  v_exp_f32 v136, v136
  v_exp_f32 v137, v137
  v_exp_f32 v138, v138
  v_mfma_f32_32x32x16_bf16 v[152:167], v[64:67], v[20:23], 0
  v_exp_f32 v139, v139
  v_cvt_pk_bf16_f32 v168, v136, v137
  v_exp_f32 v140, v140
  v_exp_f32 v141, v141
  v_mfma_f32_32x32x16_bf16 v[200:215], v[124:127], v[180:183], v[200:215]
  v_cvt_pk_bf16_f32 v169, v138, v139
  v_exp_f32 v142, v142
  v_exp_f32 v143, v143
  v_cvt_pk_bf16_f32 v170, v140, v141
  v_exp_f32 v144, v144
  v_exp_f32 v145, v145
  v_cvt_pk_bf16_f32 v171, v142, v143
  v_exp_f32 v146, v146
  v_exp_f32 v147, v147
  v_cvt_pk_bf16_f32 v172, v144, v145
  v_exp_f32 v148, v148
  v_exp_f32 v149, v149
  v_cvt_pk_bf16_f32 v173, v146, v147
  v_exp_f32 v150, v150
  v_exp_f32 v151, v151
  v_cvt_pk_bf16_f32 v174, v148, v149
  v_cvt_pk_bf16_f32 v175, v150, v151
  s_waitcnt vmcnt(8)
  v_mfma_f32_32x32x16_bf16 v[216:231], v[120:123], v[168:171], v[216:231]
  buffer_load_dwordx4 v[80:83], v7, s[32:35], s70 offen offset:2048
  v_exp_f32 v152, v152
  v_exp_f32 v153, v153
  v_exp_f32 v154, v154
  v_mfma_f32_32x32x16_bf16 v[136:151], v[68:71], v[8:11], 0
  v_exp_f32 v155, v155
  v_cvt_pk_bf16_f32 v176, v152, v153
  v_exp_f32 v156, v156
  v_exp_f32 v157, v157
  v_mfma_f32_32x32x16_bf16 v[216:231], v[124:127], v[172:175], v[216:231]
  v_cvt_pk_bf16_f32 v177, v154, v155
  v_exp_f32 v158, v158
  v_exp_f32 v159, v159
  v_cvt_pk_bf16_f32 v178, v156, v157
  v_exp_f32 v160, v160
  v_exp_f32 v161, v161
  v_cvt_pk_bf16_f32 v179, v158, v159
  v_exp_f32 v162, v162
  v_exp_f32 v163, v163
  v_cvt_pk_bf16_f32 v180, v160, v161
  v_exp_f32 v164, v164
  v_exp_f32 v165, v165
  v_cvt_pk_bf16_f32 v181, v162, v163
  v_exp_f32 v166, v166
  v_exp_f32 v167, v167
  v_cvt_pk_bf16_f32 v182, v164, v165
  v_cvt_pk_bf16_f32 v183, v166, v167
  v_mfma_f32_32x32x16_bf16 v[232:247], v[120:123], v[176:179], v[232:247]
  v_exp_f32 v136, v136
  v_exp_f32 v137, v137
  v_exp_f32 v138, v138
  v_mfma_f32_32x32x16_bf16 v[152:167], v[68:71], v[12:15], 0
  v_exp_f32 v139, v139
  v_cvt_pk_bf16_f32 v168, v136, v137
  v_exp_f32 v140, v140
  v_exp_f32 v141, v141
  v_mfma_f32_32x32x16_bf16 v[232:247], v[124:127], v[180:183], v[232:247]
  v_cvt_pk_bf16_f32 v169, v138, v139
  v_exp_f32 v142, v142
  v_exp_f32 v143, v143
  v_cvt_pk_bf16_f32 v170, v140, v141
  v_exp_f32 v144, v144
  v_exp_f32 v145, v145
  v_cvt_pk_bf16_f32 v171, v142, v143
  v_exp_f32 v146, v146
  v_exp_f32 v147, v147
  v_cvt_pk_bf16_f32 v172, v144, v145
  v_exp_f32 v148, v148
  v_exp_f32 v149, v149
  v_cvt_pk_bf16_f32 v173, v146, v147
  v_exp_f32 v150, v150
  v_exp_f32 v151, v151
  v_cvt_pk_bf16_f32 v174, v148, v149
  v_cvt_pk_bf16_f32 v175, v150, v151
  s_waitcnt vmcnt(7)
  v_mfma_f32_32x32x16_bf16 v[184:199], v[128:131], v[168:171], v[184:199]
  s_add_u32 s71, s67, 102400
  s_mov_b64 exec, s[68:69]
  buffer_load_dwordx4 v[120:123], v1, s[32:35], s71 offen offset:0
  buffer_load_dwordx4 v[124:127], v1, s[32:35], s71 offen offset:1024
  s_mov_b64 exec, -1
  v_exp_f32 v152, v152
  v_exp_f32 v153, v153
  v_exp_f32 v154, v154
  v_mfma_f32_32x32x16_bf16 v[136:151], v[68:71], v[16:19], 0
  v_exp_f32 v155, v155
  v_cvt_pk_bf16_f32 v176, v152, v153
  v_exp_f32 v156, v156
  v_exp_f32 v157, v157
  v_mfma_f32_32x32x16_bf16 v[184:199], v[132:135], v[172:175], v[184:199]
  v_cvt_pk_bf16_f32 v177, v154, v155
  v_exp_f32 v158, v158
  v_exp_f32 v159, v159
  v_cvt_pk_bf16_f32 v178, v156, v157
  v_exp_f32 v160, v160
  v_exp_f32 v161, v161
  v_cvt_pk_bf16_f32 v179, v158, v159
  v_exp_f32 v162, v162
  v_exp_f32 v163, v163
  v_cvt_pk_bf16_f32 v180, v160, v161
  v_exp_f32 v164, v164
  v_exp_f32 v165, v165
  v_cvt_pk_bf16_f32 v181, v162, v163
  v_exp_f32 v166, v166
  v_exp_f32 v167, v167
  v_cvt_pk_bf16_f32 v182, v164, v165
  v_cvt_pk_bf16_f32 v183, v166, v167
  v_mfma_f32_32x32x16_bf16 v[200:215], v[128:131], v[176:179], v[200:215]
  v_exp_f32 v136, v136
  v_exp_f32 v137, v137
  v_exp_f32 v138, v138
  v_mfma_f32_32x32x16_bf16 v[152:167], v[68:71], v[20:23], 0
  v_exp_f32 v139, v139
  v_cvt_pk_bf16_f32 v168, v136, v137
  v_exp_f32 v140, v140
  v_exp_f32 v141, v141
  v_mfma_f32_32x32x16_bf16 v[200:215], v[132:135], v[180:183], v[200:215]
  v_cvt_pk_bf16_f32 v169, v138, v139
  v_exp_f32 v142, v142
  v_exp_f32 v143, v143
  v_cvt_pk_bf16_f32 v170, v140, v141
  v_exp_f32 v144, v144
  v_exp_f32 v145, v145
  v_cvt_pk_bf16_f32 v171, v142, v143
  v_exp_f32 v146, v146
  v_exp_f32 v147, v147
  v_cvt_pk_bf16_f32 v172, v144, v145
  v_exp_f32 v148, v148
  v_exp_f32 v149, v149
  v_cvt_pk_bf16_f32 v173, v146, v147
  v_exp_f32 v150, v150
  v_exp_f32 v151, v151
  v_cvt_pk_bf16_f32 v174, v148, v149
  v_cvt_pk_bf16_f32 v175, v150, v151
  s_load_dwordx16 s[8:23], s[32:33], s75 glc
  s_waitcnt vmcnt(8)
  v_mfma_f32_32x32x16_bf16 v[216:231], v[128:131], v[168:171], v[216:231]
  buffer_load_dwordx4 v[84:87], v7, s[32:35], s70 offen offset:3072
  v_exp_f32 v152, v152
  v_exp_f32 v153, v153
  v_exp_f32 v154, v154
  v_mfma_f32_32x32x16_bf16 v[136:151], v[72:75], v[8:11], 0
  v_exp_f32 v155, v155
  v_cvt_pk_bf16_f32 v176, v152, v153
  v_exp_f32 v156, v156
  v_exp_f32 v157, v157
  v_mfma_f32_32x32x16_bf16 v[216:231], v[132:135], v[172:175], v[216:231]
  v_cvt_pk_bf16_f32 v177, v154, v155
  v_exp_f32 v158, v158
  v_exp_f32 v159, v159
  v_cvt_pk_bf16_f32 v178, v156, v157
  v_exp_f32 v160, v160
  v_exp_f32 v161, v161
  v_cvt_pk_bf16_f32 v179, v158, v159
  v_exp_f32 v162, v162
  v_exp_f32 v163, v163
  v_cvt_pk_bf16_f32 v180, v160, v161
  v_exp_f32 v164, v164
  v_exp_f32 v165, v165
  v_cvt_pk_bf16_f32 v181, v162, v163
  v_exp_f32 v166, v166
  v_exp_f32 v167, v167
  v_cvt_pk_bf16_f32 v182, v164, v165
  v_cvt_pk_bf16_f32 v183, v166, v167
  v_mfma_f32_32x32x16_bf16 v[232:247], v[128:131], v[176:179], v[232:247]
  v_exp_f32 v136, v136
  v_exp_f32 v137, v137
  v_exp_f32 v138, v138
  v_mfma_f32_32x32x16_bf16 v[152:167], v[72:75], v[12:15], 0
  v_exp_f32 v139, v139
  v_cvt_pk_bf16_f32 v168, v136, v137
  v_exp_f32 v140, v140
  v_exp_f32 v141, v141
  v_mfma_f32_32x32x16_bf16 v[232:247], v[132:135], v[180:183], v[232:247]
  v_cvt_pk_bf16_f32 v169, v138, v139
  v_exp_f32 v142, v142
  v_exp_f32 v143, v143
  v_cvt_pk_bf16_f32 v170, v140, v141
  v_exp_f32 v144, v144
  v_exp_f32 v145, v145
  v_cvt_pk_bf16_f32 v171, v142, v143
  v_exp_f32 v146, v146
  v_exp_f32 v147, v147
  v_cvt_pk_bf16_f32 v172, v144, v145
  v_exp_f32 v148, v148
  v_exp_f32 v149, v149
  v_cvt_pk_bf16_f32 v173, v146, v147
  v_exp_f32 v150, v150
  v_exp_f32 v151, v151
  v_cvt_pk_bf16_f32 v174, v148, v149
  v_cvt_pk_bf16_f32 v175, v150, v151
  s_waitcnt vmcnt(7)
  v_mfma_f32_32x32x16_bf16 v[184:199], v[104:107], v[168:171], v[184:199]
  s_mov_b64 exec, s[68:69]
  buffer_load_dwordx4 v[128:131], v1, s[32:35], s71 offen offset:2048
  buffer_load_dwordx4 v[132:135], v1, s[32:35], s71 offen offset:3072
  s_mov_b64 exec, -1
  v_exp_f32 v152, v152
  v_exp_f32 v153, v153
  v_exp_f32 v154, v154
  v_mfma_f32_32x32x16_bf16 v[136:151], v[72:75], v[16:19], 0
  v_exp_f32 v155, v155
  v_cvt_pk_bf16_f32 v176, v152, v153
  v_exp_f32 v156, v156
  v_exp_f32 v157, v157
  v_mfma_f32_32x32x16_bf16 v[184:199], v[108:111], v[172:175], v[184:199]
  v_cvt_pk_bf16_f32 v177, v154, v155
  v_exp_f32 v158, v158
  v_exp_f32 v159, v159
  v_cvt_pk_bf16_f32 v178, v156, v157
  v_exp_f32 v160, v160
  v_exp_f32 v161, v161
  v_cvt_pk_bf16_f32 v179, v158, v159
  v_exp_f32 v162, v162
  v_exp_f32 v163, v163
  v_cvt_pk_bf16_f32 v180, v160, v161
  v_exp_f32 v164, v164
  v_exp_f32 v165, v165
  v_cvt_pk_bf16_f32 v181, v162, v163
  v_exp_f32 v166, v166
  v_exp_f32 v167, v167
  v_cvt_pk_bf16_f32 v182, v164, v165
  v_cvt_pk_bf16_f32 v183, v166, v167
  v_mfma_f32_32x32x16_bf16 v[200:215], v[104:107], v[176:179], v[200:215]
  v_exp_f32 v136, v136
  v_exp_f32 v137, v137
  v_exp_f32 v138, v138
  v_mfma_f32_32x32x16_bf16 v[152:167], v[72:75], v[20:23], 0
  v_exp_f32 v139, v139
  v_cvt_pk_bf16_f32 v168, v136, v137
  v_exp_f32 v140, v140
  v_exp_f32 v141, v141
  v_mfma_f32_32x32x16_bf16 v[200:215], v[108:111], v[180:183], v[200:215]
  v_cvt_pk_bf16_f32 v169, v138, v139
  v_exp_f32 v142, v142
  v_exp_f32 v143, v143
  v_cvt_pk_bf16_f32 v170, v140, v141
  v_exp_f32 v144, v144
  v_exp_f32 v145, v145
  v_cvt_pk_bf16_f32 v171, v142, v143
  v_exp_f32 v146, v146
  v_exp_f32 v147, v147
  v_cvt_pk_bf16_f32 v172, v144, v145
  v_exp_f32 v148, v148
  v_exp_f32 v149, v149
  v_cvt_pk_bf16_f32 v173, v146, v147
  v_exp_f32 v150, v150
  v_exp_f32 v151, v151
  v_cvt_pk_bf16_f32 v174, v148, v149
  v_cvt_pk_bf16_f32 v175, v150, v151
  s_waitcnt lgkmcnt(0)
  s_xor_b64 s[8:9], s[8:9], s[24:25]
  s_xor_b64 s[10:11], s[10:11], s[24:25]
  s_xor_b64 s[12:13], s[12:13], s[24:25]
  s_xor_b64 s[14:15], s[14:15], s[24:25]
  s_xor_b64 s[16:17], s[16:17], s[24:25]
  s_xor_b64 s[18:19], s[18:19], s[24:25]
  s_xor_b64 s[20:21], s[20:21], s[24:25]
  s_xor_b64 s[22:23], s[22:23], s[24:25]
  s_or_b64 s[8:9], s[8:9], s[10:11]
  s_or_b64 s[12:13], s[12:13], s[14:15]
  s_or_b64 s[16:17], s[16:17], s[18:19]
  s_or_b64 s[20:21], s[20:21], s[22:23]
  s_or_b64 s[8:9], s[8:9], s[12:13]
  s_or_b64 s[16:17], s[16:17], s[20:21]
  s_or_b64 s[8:9], s[8:9], s[16:17]
  s_cbranch_scc1 skr3_spin
skr3_ok:
  s_waitcnt vmcnt(8)
  v_mfma_f32_32x32x16_bf16 v[216:231], v[104:107], v[168:171], v[216:231]
  s_add_u32 s70, s66, 32768
  buffer_load_dwordx4 v[88:91], v7, s[32:35], s70 offen offset:0
  v_exp_f32 v152, v152
  v_exp_f32 v153, v153
  v_exp_f32 v154, v154
  v_mfma_f32_32x32x16_bf16 v[136:151], v[76:79], v[8:11], 0
  v_exp_f32 v155, v155
  v_cvt_pk_bf16_f32 v176, v152, v153
  v_exp_f32 v156, v156
  v_exp_f32 v157, v157
  v_mfma_f32_32x32x16_bf16 v[216:231], v[108:111], v[172:175], v[216:231]
  v_cvt_pk_bf16_f32 v177, v154, v155
  v_exp_f32 v158, v158
  v_exp_f32 v159, v159
  v_cvt_pk_bf16_f32 v178, v156, v157
  v_exp_f32 v160, v160
  v_exp_f32 v161, v161
  v_cvt_pk_bf16_f32 v179, v158, v159
  v_exp_f32 v162, v162
  v_exp_f32 v163, v163
  v_cvt_pk_bf16_f32 v180, v160, v161
  v_exp_f32 v164, v164
  v_exp_f32 v165, v165
  v_cvt_pk_bf16_f32 v181, v162, v163
  v_exp_f32 v166, v166
  v_exp_f32 v167, v167
  v_cvt_pk_bf16_f32 v182, v164, v165
  v_cvt_pk_bf16_f32 v183, v166, v167
  v_mfma_f32_32x32x16_bf16 v[232:247], v[104:107], v[176:179], v[232:247]
  v_exp_f32 v136, v136
  v_exp_f32 v137, v137
  v_exp_f32 v138, v138
  v_mfma_f32_32x32x16_bf16 v[152:167], v[76:79], v[12:15], 0
  v_exp_f32 v139, v139
  v_cvt_pk_bf16_f32 v168, v136, v137
  v_exp_f32 v140, v140
  v_exp_f32 v141, v141
  v_mfma_f32_32x32x16_bf16 v[232:247], v[108:111], v[180:183], v[232:247]
  v_cvt_pk_bf16_f32 v169, v138, v139
  v_exp_f32 v142, v142
  v_exp_f32 v143, v143
  v_cvt_pk_bf16_f32 v170, v140, v141
  v_exp_f32 v144, v144
  v_exp_f32 v145, v145
  v_cvt_pk_bf16_f32 v171, v142, v143
  v_exp_f32 v146, v146
  v_exp_f32 v147, v147
  v_cvt_pk_bf16_f32 v172, v144, v145
  v_exp_f32 v148, v148
  v_exp_f32 v149, v149
  v_cvt_pk_bf16_f32 v173, v146, v147
  v_exp_f32 v150, v150
  v_exp_f32 v151, v151
  v_cvt_pk_bf16_f32 v174, v148, v149
  v_cvt_pk_bf16_f32 v175, v150, v151
  s_waitcnt vmcnt(7)
  v_mfma_f32_32x32x16_bf16 v[184:199], v[112:115], v[168:171], v[184:199]
  s_add_u32 s71, s67, 65536
  s_mov_b64 exec, s[68:69]
  buffer_load_dwordx4 v[104:107], v1, s[32:35], s71 offen offset:0
  buffer_load_dwordx4 v[108:111], v1, s[32:35], s71 offen offset:1024
  s_mov_b64 exec, -1
  v_exp_f32 v152, v152
  v_exp_f32 v153, v153
  v_exp_f32 v154, v154
  v_mfma_f32_32x32x16_bf16 v[136:151], v[76:79], v[16:19], 0
  v_exp_f32 v155, v155
  v_cvt_pk_bf16_f32 v176, v152, v153
  v_exp_f32 v156, v156
  v_exp_f32 v157, v157
  v_mfma_f32_32x32x16_bf16 v[184:199], v[116:119], v[172:175], v[184:199]
  v_cvt_pk_bf16_f32 v177, v154, v155
  v_exp_f32 v158, v158
  v_exp_f32 v159, v159
  v_cvt_pk_bf16_f32 v178, v156, v157
  v_exp_f32 v160, v160
  v_exp_f32 v161, v161
  v_cvt_pk_bf16_f32 v179, v158, v159
  v_exp_f32 v162, v162
  v_exp_f32 v163, v163
  v_cvt_pk_bf16_f32 v180, v160, v161
  v_exp_f32 v164, v164
  v_exp_f32 v165, v165
  v_cvt_pk_bf16_f32 v181, v162, v163
  v_exp_f32 v166, v166
  v_exp_f32 v167, v167
  v_cvt_pk_bf16_f32 v182, v164, v165
  v_cvt_pk_bf16_f32 v183, v166, v167
  v_mfma_f32_32x32x16_bf16 v[200:215], v[112:115], v[176:179], v[200:215]
  v_exp_f32 v136, v136
  v_exp_f32 v137, v137
  v_exp_f32 v138, v138
  v_mfma_f32_32x32x16_bf16 v[152:167], v[76:79], v[20:23], 0
  v_exp_f32 v139, v139
  v_cvt_pk_bf16_f32 v168, v136, v137
  v_exp_f32 v140, v140
  v_exp_f32 v141, v141
  v_mfma_f32_32x32x16_bf16 v[200:215], v[116:119], v[180:183], v[200:215]
  v_cvt_pk_bf16_f32 v169, v138, v139
  v_exp_f32 v142, v142
  v_exp_f32 v143, v143
  v_cvt_pk_bf16_f32 v170, v140, v141
  v_exp_f32 v144, v144
  v_exp_f32 v145, v145
  v_cvt_pk_bf16_f32 v171, v142, v143
  v_exp_f32 v146, v146
  v_exp_f32 v147, v147
  v_cvt_pk_bf16_f32 v172, v144, v145
  v_exp_f32 v148, v148
  v_exp_f32 v149, v149
  v_cvt_pk_bf16_f32 v173, v146, v147
  v_exp_f32 v150, v150
  v_exp_f32 v151, v151
  v_cvt_pk_bf16_f32 v174, v148, v149
  v_cvt_pk_bf16_f32 v175, v150, v151
  s_waitcnt vmcnt(8)
  v_mfma_f32_32x32x16_bf16 v[216:231], v[112:115], v[168:171], v[216:231]
  buffer_load_dwordx4 v[92:95], v7, s[32:35], s70 offen offset:1024
  v_exp_f32 v152, v152
  v_exp_f32 v153, v153
  v_exp_f32 v154, v154
  v_mfma_f32_32x32x16_bf16 v[136:151], v[80:83], v[8:11], 0
  v_exp_f32 v155, v155
  v_cvt_pk_bf16_f32 v176, v152, v153
  v_exp_f32 v156, v156
  v_exp_f32 v157, v157
  v_mfma_f32_32x32x16_bf16 v[216:231], v[116:119], v[172:175], v[216:231]
  v_cvt_pk_bf16_f32 v177, v154, v155
  v_exp_f32 v158, v158
  v_exp_f32 v159, v159
  v_cvt_pk_bf16_f32 v178, v156, v157
  v_exp_f32 v160, v160
  v_exp_f32 v161, v161
  v_cvt_pk_bf16_f32 v179, v158, v159
  v_exp_f32 v162, v162
  v_exp_f32 v163, v163
  v_cvt_pk_bf16_f32 v180, v160, v161
  v_exp_f32 v164, v164
  v_exp_f32 v165, v165
  v_cvt_pk_bf16_f32 v181, v162, v163
  v_exp_f32 v166, v166
  v_exp_f32 v167, v167
  v_cvt_pk_bf16_f32 v182, v164, v165
  v_cvt_pk_bf16_f32 v183, v166, v167
  v_mfma_f32_32x32x16_bf16 v[232:247], v[112:115], v[176:179], v[232:247]
  v_exp_f32 v136, v136
  v_exp_f32 v137, v137
  v_exp_f32 v138, v138
  v_mfma_f32_32x32x16_bf16 v[152:167], v[80:83], v[12:15], 0
  v_exp_f32 v139, v139
  v_cvt_pk_bf16_f32 v168, v136, v137
  v_exp_f32 v140, v140
  v_exp_f32 v141, v141
  v_mfma_f32_32x32x16_bf16 v[232:247], v[116:119], v[180:183], v[232:247]
  v_cvt_pk_bf16_f32 v169, v138, v139
  v_exp_f32 v142, v142
  v_exp_f32 v143, v143
  v_cvt_pk_bf16_f32 v170, v140, v141
  v_exp_f32 v144, v144
  v_exp_f32 v145, v145
  v_cvt_pk_bf16_f32 v171, v142, v143
  v_exp_f32 v146, v146
  v_exp_f32 v147, v147
  v_cvt_pk_bf16_f32 v172, v144, v145
  v_exp_f32 v148, v148
  v_exp_f32 v149, v149
  v_cvt_pk_bf16_f32 v173, v146, v147
  v_exp_f32 v150, v150
  v_exp_f32 v151, v151
  v_cvt_pk_bf16_f32 v174, v148, v149
  v_cvt_pk_bf16_f32 v175, v150, v151
  s_waitcnt vmcnt(7)
  v_mfma_f32_32x32x16_bf16 v[184:199], v[120:123], v[168:171], v[184:199]
  s_mov_b64 exec, s[68:69]
  buffer_load_dwordx4 v[112:115], v1, s[32:35], s71 offen offset:2048
  buffer_load_dwordx4 v[116:119], v1, s[32:35], s71 offen offset:3072
  s_mov_b64 exec, -1
  v_exp_f32 v152, v152
  v_exp_f32 v153, v153
  v_exp_f32 v154, v154
  v_mfma_f32_32x32x16_bf16 v[136:151], v[80:83], v[16:19], 0
  v_exp_f32 v155, v155
  v_cvt_pk_bf16_f32 v176, v152, v153
  v_exp_f32 v156, v156
  v_exp_f32 v157, v157
  v_mfma_f32_32x32x16_bf16 v[184:199], v[124:127], v[172:175], v[184:199]
  v_cvt_pk_bf16_f32 v177, v154, v155
  v_exp_f32 v158, v158
  v_exp_f32 v159, v159
  v_cvt_pk_bf16_f32 v178, v156, v157
  v_exp_f32 v160, v160
  v_exp_f32 v161, v161
  v_cvt_pk_bf16_f32 v179, v158, v159
  v_exp_f32 v162, v162
  v_exp_f32 v163, v163
  v_cvt_pk_bf16_f32 v180, v160, v161
  v_exp_f32 v164, v164
  v_exp_f32 v165, v165
  v_cvt_pk_bf16_f32 v181, v162, v163
  v_exp_f32 v166, v166
  v_exp_f32 v167, v167
  v_cvt_pk_bf16_f32 v182, v164, v165
  v_cvt_pk_bf16_f32 v183, v166, v167
  v_mfma_f32_32x32x16_bf16 v[200:215], v[120:123], v[176:179], v[200:215]
  v_exp_f32 v136, v136
  v_exp_f32 v137, v137
  v_exp_f32 v138, v138
  v_mfma_f32_32x32x16_bf16 v[152:167], v[80:83], v[20:23], 0
  v_exp_f32 v139, v139
  v_cvt_pk_bf16_f32 v168, v136, v137
  v_exp_f32 v140, v140
  v_exp_f32 v141, v141
  v_mfma_f32_32x32x16_bf16 v[200:215], v[124:127], v[180:183], v[200:215]
  v_cvt_pk_bf16_f32 v169, v138, v139
  v_exp_f32 v142, v142
  v_exp_f32 v143, v143
  v_cvt_pk_bf16_f32 v170, v140, v141
  v_exp_f32 v144, v144
  v_exp_f32 v145, v145
  v_cvt_pk_bf16_f32 v171, v142, v143
  v_exp_f32 v146, v146
  v_exp_f32 v147, v147
  v_cvt_pk_bf16_f32 v172, v144, v145
  v_exp_f32 v148, v148
  v_exp_f32 v149, v149
  v_cvt_pk_bf16_f32 v173, v146, v147
  v_exp_f32 v150, v150
  v_exp_f32 v151, v151
  v_cvt_pk_bf16_f32 v174, v148, v149
  v_cvt_pk_bf16_f32 v175, v150, v151
  s_waitcnt vmcnt(8)
  v_mfma_f32_32x32x16_bf16 v[216:231], v[120:123], v[168:171], v[216:231]
  buffer_load_dwordx4 v[96:99], v7, s[32:35], s70 offen offset:2048
  v_exp_f32 v152, v152
  v_exp_f32 v153, v153
  v_exp_f32 v154, v154
  v_mfma_f32_32x32x16_bf16 v[136:151], v[84:87], v[8:11], 0
  v_exp_f32 v155, v155
  v_cvt_pk_bf16_f32 v176, v152, v153
  v_exp_f32 v156, v156
  v_exp_f32 v157, v157
  v_mfma_f32_32x32x16_bf16 v[216:231], v[124:127], v[172:175], v[216:231]
  v_cvt_pk_bf16_f32 v177, v154, v155
  v_exp_f32 v158, v158
  v_exp_f32 v159, v159
  v_cvt_pk_bf16_f32 v178, v156, v157
  v_exp_f32 v160, v160
  v_exp_f32 v161, v161
  v_cvt_pk_bf16_f32 v179, v158, v159
  v_exp_f32 v162, v162
  v_exp_f32 v163, v163
  v_cvt_pk_bf16_f32 v180, v160, v161
  v_exp_f32 v164, v164
  v_exp_f32 v165, v165
  v_cvt_pk_bf16_f32 v181, v162, v163
  v_exp_f32 v166, v166
  v_exp_f32 v167, v167
  v_cvt_pk_bf16_f32 v182, v164, v165
  v_cvt_pk_bf16_f32 v183, v166, v167
  v_mfma_f32_32x32x16_bf16 v[232:247], v[120:123], v[176:179], v[232:247]
  v_exp_f32 v136, v136
  v_exp_f32 v137, v137
  v_exp_f32 v138, v138
  v_mfma_f32_32x32x16_bf16 v[152:167], v[84:87], v[12:15], 0
  v_exp_f32 v139, v139
  v_cvt_pk_bf16_f32 v168, v136, v137
  v_exp_f32 v140, v140
  v_exp_f32 v141, v141
  v_mfma_f32_32x32x16_bf16 v[232:247], v[124:127], v[180:183], v[232:247]
  v_cvt_pk_bf16_f32 v169, v138, v139
  v_exp_f32 v142, v142
  v_exp_f32 v143, v143
  v_cvt_pk_bf16_f32 v170, v140, v141
  v_exp_f32 v144, v144
  v_exp_f32 v145, v145
  v_cvt_pk_bf16_f32 v171, v142, v143
  v_exp_f32 v146, v146
  v_exp_f32 v147, v147
  v_cvt_pk_bf16_f32 v172, v144, v145
  v_exp_f32 v148, v148
  v_exp_f32 v149, v149
  v_cvt_pk_bf16_f32 v173, v146, v147
  v_exp_f32 v150, v150
  v_exp_f32 v151, v151
  v_cvt_pk_bf16_f32 v174, v148, v149
  v_cvt_pk_bf16_f32 v175, v150, v151
  s_waitcnt vmcnt(7)
  v_mfma_f32_32x32x16_bf16 v[184:199], v[128:131], v[168:171], v[184:199]
  s_add_u32 s71, s67, 69632
  s_mov_b64 exec, s[68:69]
  buffer_load_dwordx4 v[120:123], v1, s[32:35], s71 offen offset:0
  buffer_load_dwordx4 v[124:127], v1, s[32:35], s71 offen offset:1024
  s_mov_b64 exec, -1
  v_exp_f32 v152, v152
  v_exp_f32 v153, v153
  v_exp_f32 v154, v154
  v_mfma_f32_32x32x16_bf16 v[136:151], v[84:87], v[16:19], 0
  v_exp_f32 v155, v155
  v_cvt_pk_bf16_f32 v176, v152, v153
  v_exp_f32 v156, v156
  v_exp_f32 v157, v157
  v_mfma_f32_32x32x16_bf16 v[184:199], v[132:135], v[172:175], v[184:199]
  v_cvt_pk_bf16_f32 v177, v154, v155
  v_exp_f32 v158, v158
  v_exp_f32 v159, v159
  v_cvt_pk_bf16_f32 v178, v156, v157
  v_exp_f32 v160, v160
  v_exp_f32 v161, v161
  v_cvt_pk_bf16_f32 v179, v158, v159
  v_exp_f32 v162, v162
  v_exp_f32 v163, v163
  v_cvt_pk_bf16_f32 v180, v160, v161
  v_exp_f32 v164, v164
  v_exp_f32 v165, v165
  v_cvt_pk_bf16_f32 v181, v162, v163
  v_exp_f32 v166, v166
  v_exp_f32 v167, v167
  v_cvt_pk_bf16_f32 v182, v164, v165
  v_cvt_pk_bf16_f32 v183, v166, v167
  v_mfma_f32_32x32x16_bf16 v[200:215], v[128:131], v[176:179], v[200:215]
  v_exp_f32 v136, v136
  v_exp_f32 v137, v137
  v_exp_f32 v138, v138
  v_mfma_f32_32x32x16_bf16 v[152:167], v[84:87], v[20:23], 0
  v_exp_f32 v139, v139
  v_cvt_pk_bf16_f32 v168, v136, v137
  v_exp_f32 v140, v140
  v_exp_f32 v141, v141
  v_mfma_f32_32x32x16_bf16 v[200:215], v[132:135], v[180:183], v[200:215]
  v_cvt_pk_bf16_f32 v169, v138, v139
  v_exp_f32 v142, v142
  v_exp_f32 v143, v143
  v_cvt_pk_bf16_f32 v170, v140, v141
  v_exp_f32 v144, v144
  v_exp_f32 v145, v145
  v_cvt_pk_bf16_f32 v171, v142, v143
  v_exp_f32 v146, v146
  v_exp_f32 v147, v147
  v_cvt_pk_bf16_f32 v172, v144, v145
  v_exp_f32 v148, v148
  v_exp_f32 v149, v149
  v_cvt_pk_bf16_f32 v173, v146, v147
  v_exp_f32 v150, v150
  v_exp_f32 v151, v151
  v_cvt_pk_bf16_f32 v174, v148, v149
  v_cvt_pk_bf16_f32 v175, v150, v151
  s_waitcnt vmcnt(8)
  v_mfma_f32_32x32x16_bf16 v[216:231], v[128:131], v[168:171], v[216:231]
  buffer_load_dwordx4 v[100:103], v7, s[32:35], s70 offen offset:3072
  v_exp_f32 v152, v152
  v_exp_f32 v153, v153
  v_exp_f32 v154, v154
  v_mfma_f32_32x32x16_bf16 v[136:151], v[88:91], v[8:11], 0
  v_exp_f32 v155, v155
  v_cvt_pk_bf16_f32 v176, v152, v153
  v_exp_f32 v156, v156
  v_exp_f32 v157, v157
  v_mfma_f32_32x32x16_bf16 v[216:231], v[132:135], v[172:175], v[216:231]
  v_cvt_pk_bf16_f32 v177, v154, v155
  v_exp_f32 v158, v158
  v_exp_f32 v159, v159
  v_cvt_pk_bf16_f32 v178, v156, v157
  v_exp_f32 v160, v160
  v_exp_f32 v161, v161
  v_cvt_pk_bf16_f32 v179, v158, v159
  v_exp_f32 v162, v162
  v_exp_f32 v163, v163
  v_cvt_pk_bf16_f32 v180, v160, v161
  v_exp_f32 v164, v164
  v_exp_f32 v165, v165
  v_cvt_pk_bf16_f32 v181, v162, v163
  v_exp_f32 v166, v166
  v_exp_f32 v167, v167
  v_cvt_pk_bf16_f32 v182, v164, v165
  v_cvt_pk_bf16_f32 v183, v166, v167
  v_mfma_f32_32x32x16_bf16 v[232:247], v[128:131], v[176:179], v[232:247]
  v_exp_f32 v136, v136
  v_exp_f32 v137, v137
  v_exp_f32 v138, v138
  v_mfma_f32_32x32x16_bf16 v[152:167], v[88:91], v[12:15], 0
  v_exp_f32 v139, v139
  v_cvt_pk_bf16_f32 v168, v136, v137
  v_exp_f32 v140, v140
  v_exp_f32 v141, v141
  v_mfma_f32_32x32x16_bf16 v[232:247], v[132:135], v[180:183], v[232:247]
  v_cvt_pk_bf16_f32 v169, v138, v139
  v_exp_f32 v142, v142
  v_exp_f32 v143, v143
  v_cvt_pk_bf16_f32 v170, v140, v141
  v_exp_f32 v144, v144
  v_exp_f32 v145, v145
  v_cvt_pk_bf16_f32 v171, v142, v143
  v_exp_f32 v146, v146
  v_exp_f32 v147, v147
  v_cvt_pk_bf16_f32 v172, v144, v145
  v_exp_f32 v148, v148
  v_exp_f32 v149, v149
  v_cvt_pk_bf16_f32 v173, v146, v147
  v_exp_f32 v150, v150
  v_exp_f32 v151, v151
  v_cvt_pk_bf16_f32 v174, v148, v149
  v_cvt_pk_bf16_f32 v175, v150, v151
  s_waitcnt vmcnt(7)
  v_mfma_f32_32x32x16_bf16 v[184:199], v[104:107], v[168:171], v[184:199]
  s_mov_b64 exec, s[68:69]
  buffer_load_dwordx4 v[128:131], v1, s[32:35], s71 offen offset:2048
  buffer_load_dwordx4 v[132:135], v1, s[32:35], s71 offen offset:3072
  s_mov_b64 exec, -1
  v_exp_f32 v152, v152
  v_exp_f32 v153, v153
  v_exp_f32 v154, v154
  v_mfma_f32_32x32x16_bf16 v[136:151], v[88:91], v[16:19], 0
  v_exp_f32 v155, v155
  v_cvt_pk_bf16_f32 v176, v152, v153
  v_exp_f32 v156, v156
  v_exp_f32 v157, v157
  v_mfma_f32_32x32x16_bf16 v[184:199], v[108:111], v[172:175], v[184:199]
  v_cvt_pk_bf16_f32 v177, v154, v155
  v_exp_f32 v158, v158
  v_exp_f32 v159, v159
  v_cvt_pk_bf16_f32 v178, v156, v157
  v_exp_f32 v160, v160
  v_exp_f32 v161, v161
  v_cvt_pk_bf16_f32 v179, v158, v159
  v_exp_f32 v162, v162
  v_exp_f32 v163, v163
  v_cvt_pk_bf16_f32 v180, v160, v161
  v_exp_f32 v164, v164
  v_exp_f32 v165, v165
  v_cvt_pk_bf16_f32 v181, v162, v163
  v_exp_f32 v166, v166
  v_exp_f32 v167, v167
  v_cvt_pk_bf16_f32 v182, v164, v165
  v_cvt_pk_bf16_f32 v183, v166, v167
  v_mfma_f32_32x32x16_bf16 v[200:215], v[104:107], v[176:179], v[200:215]
  v_exp_f32 v136, v136
  v_exp_f32 v137, v137
  v_exp_f32 v138, v138
  v_mfma_f32_32x32x16_bf16 v[152:167], v[88:91], v[20:23], 0
  v_exp_f32 v139, v139
  v_cvt_pk_bf16_f32 v168, v136, v137
  v_exp_f32 v140, v140
  v_exp_f32 v141, v141
  v_mfma_f32_32x32x16_bf16 v[200:215], v[108:111], v[180:183], v[200:215]
  v_cvt_pk_bf16_f32 v169, v138, v139
  v_exp_f32 v142, v142
  v_exp_f32 v143, v143
  v_cvt_pk_bf16_f32 v170, v140, v141
  v_exp_f32 v144, v144
  v_exp_f32 v145, v145
  v_cvt_pk_bf16_f32 v171, v142, v143
  v_exp_f32 v146, v146
  v_exp_f32 v147, v147
  v_cvt_pk_bf16_f32 v172, v144, v145
  v_exp_f32 v148, v148
  v_exp_f32 v149, v149
  v_cvt_pk_bf16_f32 v173, v146, v147
  v_exp_f32 v150, v150
  v_exp_f32 v151, v151
  v_cvt_pk_bf16_f32 v174, v148, v149
  v_cvt_pk_bf16_f32 v175, v150, v151
  s_waitcnt vmcnt(8)
  v_mfma_f32_32x32x16_bf16 v[216:231], v[104:107], v[168:171], v[216:231]
  v_exp_f32 v152, v152
  v_exp_f32 v153, v153
  v_exp_f32 v154, v154
  v_mfma_f32_32x32x16_bf16 v[136:151], v[92:95], v[8:11], 0
  v_exp_f32 v155, v155
  v_cvt_pk_bf16_f32 v176, v152, v153
  v_exp_f32 v156, v156
  v_exp_f32 v157, v157
  v_mfma_f32_32x32x16_bf16 v[216:231], v[108:111], v[172:175], v[216:231]
  v_cvt_pk_bf16_f32 v177, v154, v155
  v_exp_f32 v158, v158
  v_exp_f32 v159, v159
  v_cvt_pk_bf16_f32 v178, v156, v157
  v_exp_f32 v160, v160
  v_exp_f32 v161, v161
  v_cvt_pk_bf16_f32 v179, v158, v159
  v_exp_f32 v162, v162
  v_exp_f32 v163, v163
  v_cvt_pk_bf16_f32 v180, v160, v161
  v_exp_f32 v164, v164
  v_exp_f32 v165, v165
  v_cvt_pk_bf16_f32 v181, v162, v163
  v_exp_f32 v166, v166
  v_exp_f32 v167, v167
  v_cvt_pk_bf16_f32 v182, v164, v165
  v_cvt_pk_bf16_f32 v183, v166, v167
  v_mfma_f32_32x32x16_bf16 v[232:247], v[104:107], v[176:179], v[232:247]
  v_exp_f32 v136, v136
  v_exp_f32 v137, v137
  v_exp_f32 v138, v138
  v_mfma_f32_32x32x16_bf16 v[152:167], v[92:95], v[12:15], 0
  v_exp_f32 v139, v139
  v_cvt_pk_bf16_f32 v168, v136, v137
  v_exp_f32 v140, v140
  v_exp_f32 v141, v141
  v_mfma_f32_32x32x16_bf16 v[232:247], v[108:111], v[180:183], v[232:247]
  v_cvt_pk_bf16_f32 v169, v138, v139
  v_exp_f32 v142, v142
  v_exp_f32 v143, v143
  v_cvt_pk_bf16_f32 v170, v140, v141
  v_exp_f32 v144, v144
  v_exp_f32 v145, v145
  v_cvt_pk_bf16_f32 v171, v142, v143
  v_exp_f32 v146, v146
  v_exp_f32 v147, v147
  v_cvt_pk_bf16_f32 v172, v144, v145
  v_exp_f32 v148, v148
  v_exp_f32 v149, v149
  v_cvt_pk_bf16_f32 v173, v146, v147
  v_exp_f32 v150, v150
  v_exp_f32 v151, v151
  v_cvt_pk_bf16_f32 v174, v148, v149
  v_cvt_pk_bf16_f32 v175, v150, v151
  s_waitcnt vmcnt(6)
  v_mfma_f32_32x32x16_bf16 v[184:199], v[112:115], v[168:171], v[184:199]
  s_add_u32 s71, s67, 0
  s_mov_b64 exec, s[68:69]
  buffer_load_dwordx4 v[104:107], v1, s[32:35], s71 offen offset:0
  buffer_load_dwordx4 v[108:111], v1, s[32:35], s71 offen offset:1024
  s_mov_b64 exec, -1
  v_exp_f32 v152, v152
  v_exp_f32 v153, v153
  v_exp_f32 v154, v154
  v_mfma_f32_32x32x16_bf16 v[136:151], v[92:95], v[16:19], 0
  v_exp_f32 v155, v155
  v_cvt_pk_bf16_f32 v176, v152, v153
  v_exp_f32 v156, v156
  v_exp_f32 v157, v157
  v_mfma_f32_32x32x16_bf16 v[184:199], v[116:119], v[172:175], v[184:199]
  v_cvt_pk_bf16_f32 v177, v154, v155
  v_exp_f32 v158, v158
  v_exp_f32 v159, v159
  v_cvt_pk_bf16_f32 v178, v156, v157
  v_exp_f32 v160, v160
  v_exp_f32 v161, v161
  v_cvt_pk_bf16_f32 v179, v158, v159
  v_exp_f32 v162, v162
  v_exp_f32 v163, v163
  v_cvt_pk_bf16_f32 v180, v160, v161
  v_exp_f32 v164, v164
  v_exp_f32 v165, v165
  v_cvt_pk_bf16_f32 v181, v162, v163
  v_exp_f32 v166, v166
  v_exp_f32 v167, v167
  v_cvt_pk_bf16_f32 v182, v164, v165
  v_cvt_pk_bf16_f32 v183, v166, v167
  v_mfma_f32_32x32x16_bf16 v[200:215], v[112:115], v[176:179], v[200:215]
  v_exp_f32 v136, v136
  v_exp_f32 v137, v137
  v_exp_f32 v138, v138
  v_mfma_f32_32x32x16_bf16 v[152:167], v[92:95], v[20:23], 0
  v_exp_f32 v139, v139
  v_cvt_pk_bf16_f32 v168, v136, v137
  v_exp_f32 v140, v140
  v_exp_f32 v141, v141
  v_mfma_f32_32x32x16_bf16 v[200:215], v[116:119], v[180:183], v[200:215]
  v_cvt_pk_bf16_f32 v169, v138, v139
  v_exp_f32 v142, v142
  v_exp_f32 v143, v143
  v_cvt_pk_bf16_f32 v170, v140, v141
  v_exp_f32 v144, v144
  v_exp_f32 v145, v145
  v_cvt_pk_bf16_f32 v171, v142, v143
  v_exp_f32 v146, v146
  v_exp_f32 v147, v147
  v_cvt_pk_bf16_f32 v172, v144, v145
  v_exp_f32 v148, v148
  v_exp_f32 v149, v149
  v_cvt_pk_bf16_f32 v173, v146, v147
  v_exp_f32 v150, v150
  v_exp_f32 v151, v151
  v_cvt_pk_bf16_f32 v174, v148, v149
  v_cvt_pk_bf16_f32 v175, v150, v151
  s_waitcnt vmcnt(7)
  v_mfma_f32_32x32x16_bf16 v[216:231], v[112:115], v[168:171], v[216:231]
  v_exp_f32 v152, v152
  v_exp_f32 v153, v153
  v_exp_f32 v154, v154
  v_mfma_f32_32x32x16_bf16 v[136:151], v[96:99], v[8:11], 0
  v_exp_f32 v155, v155
  v_cvt_pk_bf16_f32 v176, v152, v153
  v_exp_f32 v156, v156
  v_exp_f32 v157, v157
  v_mfma_f32_32x32x16_bf16 v[216:231], v[116:119], v[172:175], v[216:231]
  v_cvt_pk_bf16_f32 v177, v154, v155
  v_exp_f32 v158, v158
  v_exp_f32 v159, v159
  v_cvt_pk_bf16_f32 v178, v156, v157
  v_exp_f32 v160, v160
  v_exp_f32 v161, v161
  v_cvt_pk_bf16_f32 v179, v158, v159
  v_exp_f32 v162, v162
  v_exp_f32 v163, v163
  v_cvt_pk_bf16_f32 v180, v160, v161
  v_exp_f32 v164, v164
  v_exp_f32 v165, v165
  v_cvt_pk_bf16_f32 v181, v162, v163
  v_exp_f32 v166, v166
  v_exp_f32 v167, v167
  v_cvt_pk_bf16_f32 v182, v164, v165
  v_cvt_pk_bf16_f32 v183, v166, v167
  v_mfma_f32_32x32x16_bf16 v[232:247], v[112:115], v[176:179], v[232:247]
  v_exp_f32 v136, v136
  v_exp_f32 v137, v137
  v_exp_f32 v138, v138
  v_mfma_f32_32x32x16_bf16 v[152:167], v[96:99], v[12:15], 0
  v_exp_f32 v139, v139
  v_cvt_pk_bf16_f32 v168, v136, v137
  v_exp_f32 v140, v140
  v_exp_f32 v141, v141
  v_mfma_f32_32x32x16_bf16 v[232:247], v[116:119], v[180:183], v[232:247]
  v_cvt_pk_bf16_f32 v169, v138, v139
  v_exp_f32 v142, v142
  v_exp_f32 v143, v143
  v_cvt_pk_bf16_f32 v170, v140, v141
  v_exp_f32 v144, v144
  v_exp_f32 v145, v145
  v_cvt_pk_bf16_f32 v171, v142, v143
  v_exp_f32 v146, v146
  v_exp_f32 v147, v147
  v_cvt_pk_bf16_f32 v172, v144, v145
  v_exp_f32 v148, v148
  v_exp_f32 v149, v149
  v_cvt_pk_bf16_f32 v173, v146, v147
  v_exp_f32 v150, v150
  v_exp_f32 v151, v151
  v_cvt_pk_bf16_f32 v174, v148, v149
  v_cvt_pk_bf16_f32 v175, v150, v151
  s_waitcnt vmcnt(5)
  v_mfma_f32_32x32x16_bf16 v[184:199], v[120:123], v[168:171], v[184:199]
  s_mov_b64 exec, s[68:69]
  buffer_load_dwordx4 v[112:115], v1, s[32:35], s71 offen offset:2048
  buffer_load_dwordx4 v[116:119], v1, s[32:35], s71 offen offset:3072
  s_mov_b64 exec, -1
  v_exp_f32 v152, v152
  v_exp_f32 v153, v153
  v_exp_f32 v154, v154
  v_mfma_f32_32x32x16_bf16 v[136:151], v[96:99], v[16:19], 0
  v_exp_f32 v155, v155
  v_cvt_pk_bf16_f32 v176, v152, v153
  v_exp_f32 v156, v156
  v_exp_f32 v157, v157
  v_mfma_f32_32x32x16_bf16 v[184:199], v[124:127], v[172:175], v[184:199]
  v_cvt_pk_bf16_f32 v177, v154, v155
  v_exp_f32 v158, v158
  v_exp_f32 v159, v159
  v_cvt_pk_bf16_f32 v178, v156, v157
  v_exp_f32 v160, v160
  v_exp_f32 v161, v161
  v_cvt_pk_bf16_f32 v179, v158, v159
  v_exp_f32 v162, v162
  v_exp_f32 v163, v163
  v_cvt_pk_bf16_f32 v180, v160, v161
  v_exp_f32 v164, v164
  v_exp_f32 v165, v165
  v_cvt_pk_bf16_f32 v181, v162, v163
  v_exp_f32 v166, v166
  v_exp_f32 v167, v167
  v_cvt_pk_bf16_f32 v182, v164, v165
  v_cvt_pk_bf16_f32 v183, v166, v167
  v_mfma_f32_32x32x16_bf16 v[200:215], v[120:123], v[176:179], v[200:215]
  v_exp_f32 v136, v136
  v_exp_f32 v137, v137
  v_exp_f32 v138, v138
  v_mfma_f32_32x32x16_bf16 v[152:167], v[96:99], v[20:23], 0
  v_exp_f32 v139, v139
  v_cvt_pk_bf16_f32 v168, v136, v137
  v_exp_f32 v140, v140
  v_exp_f32 v141, v141
  v_mfma_f32_32x32x16_bf16 v[200:215], v[124:127], v[180:183], v[200:215]
  v_cvt_pk_bf16_f32 v169, v138, v139
  v_exp_f32 v142, v142
  v_exp_f32 v143, v143
  v_cvt_pk_bf16_f32 v170, v140, v141
  v_exp_f32 v144, v144
  v_exp_f32 v145, v145
  v_cvt_pk_bf16_f32 v171, v142, v143
  v_exp_f32 v146, v146
  v_exp_f32 v147, v147
  v_cvt_pk_bf16_f32 v172, v144, v145
  v_exp_f32 v148, v148
  v_exp_f32 v149, v149
  v_cvt_pk_bf16_f32 v173, v146, v147
  v_exp_f32 v150, v150
  v_exp_f32 v151, v151
  v_cvt_pk_bf16_f32 v174, v148, v149
  v_cvt_pk_bf16_f32 v175, v150, v151
  s_waitcnt vmcnt(6)
  v_mfma_f32_32x32x16_bf16 v[216:231], v[120:123], v[168:171], v[216:231]
  v_exp_f32 v152, v152
  v_exp_f32 v153, v153
  v_exp_f32 v154, v154
  v_mfma_f32_32x32x16_bf16 v[136:151], v[100:103], v[8:11], 0
  v_exp_f32 v155, v155
  v_cvt_pk_bf16_f32 v176, v152, v153
  v_exp_f32 v156, v156
  v_exp_f32 v157, v157
  v_mfma_f32_32x32x16_bf16 v[216:231], v[124:127], v[172:175], v[216:231]
  v_cvt_pk_bf16_f32 v177, v154, v155
  v_exp_f32 v158, v158
  v_exp_f32 v159, v159
  v_cvt_pk_bf16_f32 v178, v156, v157
  v_exp_f32 v160, v160
  v_exp_f32 v161, v161
  v_cvt_pk_bf16_f32 v179, v158, v159
  v_exp_f32 v162, v162
  v_exp_f32 v163, v163
  v_cvt_pk_bf16_f32 v180, v160, v161
  v_exp_f32 v164, v164
  v_exp_f32 v165, v165
  v_cvt_pk_bf16_f32 v181, v162, v163
  v_exp_f32 v166, v166
  v_exp_f32 v167, v167
  v_cvt_pk_bf16_f32 v182, v164, v165
  v_cvt_pk_bf16_f32 v183, v166, v167
  v_mfma_f32_32x32x16_bf16 v[232:247], v[120:123], v[176:179], v[232:247]
  v_exp_f32 v136, v136
  v_exp_f32 v137, v137
  v_exp_f32 v138, v138
  v_mfma_f32_32x32x16_bf16 v[152:167], v[100:103], v[12:15], 0
  v_exp_f32 v139, v139
  v_cvt_pk_bf16_f32 v168, v136, v137
  v_exp_f32 v140, v140
  v_exp_f32 v141, v141
  v_mfma_f32_32x32x16_bf16 v[232:247], v[124:127], v[180:183], v[232:247]
  v_cvt_pk_bf16_f32 v169, v138, v139
  v_exp_f32 v142, v142
  v_exp_f32 v143, v143
  v_cvt_pk_bf16_f32 v170, v140, v141
  v_exp_f32 v144, v144
  v_exp_f32 v145, v145
  v_cvt_pk_bf16_f32 v171, v142, v143
  v_exp_f32 v146, v146
  v_exp_f32 v147, v147
  v_cvt_pk_bf16_f32 v172, v144, v145
  v_exp_f32 v148, v148
  v_exp_f32 v149, v149
  v_cvt_pk_bf16_f32 v173, v146, v147
  v_exp_f32 v150, v150
  v_exp_f32 v151, v151
  v_cvt_pk_bf16_f32 v174, v148, v149
  v_cvt_pk_bf16_f32 v175, v150, v151
  s_waitcnt vmcnt(4)
  v_mfma_f32_32x32x16_bf16 v[184:199], v[128:131], v[168:171], v[184:199]
  s_add_u32 s71, s67, 4096
  s_mov_b64 exec, s[68:69]
  buffer_load_dwordx4 v[120:123], v1, s[32:35], s71 offen offset:0
  buffer_load_dwordx4 v[124:127], v1, s[32:35], s71 offen offset:1024
  s_mov_b64 exec, -1
  v_exp_f32 v152, v152
  v_exp_f32 v153, v153
  v_exp_f32 v154, v154
  v_mfma_f32_32x32x16_bf16 v[136:151], v[100:103], v[16:19], 0
  v_exp_f32 v155, v155
  v_cvt_pk_bf16_f32 v176, v152, v153
  v_exp_f32 v156, v156
  v_exp_f32 v157, v157
  v_mfma_f32_32x32x16_bf16 v[184:199], v[132:135], v[172:175], v[184:199]
  v_cvt_pk_bf16_f32 v177, v154, v155
  v_exp_f32 v158, v158
  v_exp_f32 v159, v159
  v_cvt_pk_bf16_f32 v178, v156, v157
  v_exp_f32 v160, v160
  v_exp_f32 v161, v161
  v_cvt_pk_bf16_f32 v179, v158, v159
  v_exp_f32 v162, v162
  v_exp_f32 v163, v163
  v_cvt_pk_bf16_f32 v180, v160, v161
  v_exp_f32 v164, v164
  v_exp_f32 v165, v165
  v_cvt_pk_bf16_f32 v181, v162, v163
  v_exp_f32 v166, v166
  v_exp_f32 v167, v167
  v_cvt_pk_bf16_f32 v182, v164, v165
  v_cvt_pk_bf16_f32 v183, v166, v167
  v_mfma_f32_32x32x16_bf16 v[200:215], v[128:131], v[176:179], v[200:215]
  v_exp_f32 v136, v136
  v_exp_f32 v137, v137
  v_exp_f32 v138, v138
  v_mfma_f32_32x32x16_bf16 v[152:167], v[100:103], v[20:23], 0
  v_exp_f32 v139, v139
  v_cvt_pk_bf16_f32 v168, v136, v137
  v_exp_f32 v140, v140
  v_exp_f32 v141, v141
  v_mfma_f32_32x32x16_bf16 v[200:215], v[132:135], v[180:183], v[200:215]
  v_cvt_pk_bf16_f32 v169, v138, v139
  v_exp_f32 v142, v142
  v_exp_f32 v143, v143
  v_cvt_pk_bf16_f32 v170, v140, v141
  v_exp_f32 v144, v144
  v_exp_f32 v145, v145
  v_cvt_pk_bf16_f32 v171, v142, v143
  v_exp_f32 v146, v146
  v_exp_f32 v147, v147
  v_cvt_pk_bf16_f32 v172, v144, v145
  v_exp_f32 v148, v148
  v_exp_f32 v149, v149
  v_cvt_pk_bf16_f32 v173, v146, v147
  v_exp_f32 v150, v150
  v_exp_f32 v151, v151
  v_cvt_pk_bf16_f32 v174, v148, v149
  v_cvt_pk_bf16_f32 v175, v150, v151
  v_mfma_f32_32x32x16_bf16 v[216:231], v[128:131], v[168:171], v[216:231]
  v_exp_f32 v152, v152
  v_exp_f32 v153, v153
  v_exp_f32 v154, v154
  v_mfma_f32_32x32x16_bf16 v[136:151], v[40:43], v[24:27], 0
  v_exp_f32 v155, v155
  v_cvt_pk_bf16_f32 v176, v152, v153
  v_exp_f32 v156, v156
  v_exp_f32 v157, v157
  v_mfma_f32_32x32x16_bf16 v[216:231], v[132:135], v[172:175], v[216:231]
  v_cvt_pk_bf16_f32 v177, v154, v155
  v_exp_f32 v158, v158
  v_exp_f32 v159, v159
  v_cvt_pk_bf16_f32 v178, v156, v157
  v_exp_f32 v160, v160
  v_exp_f32 v161, v161
  v_cvt_pk_bf16_f32 v179, v158, v159
  v_exp_f32 v162, v162
  v_exp_f32 v163, v163
  v_cvt_pk_bf16_f32 v180, v160, v161
  v_exp_f32 v164, v164
  v_exp_f32 v165, v165
  v_cvt_pk_bf16_f32 v181, v162, v163
  v_exp_f32 v166, v166
  v_exp_f32 v167, v167
  v_cvt_pk_bf16_f32 v182, v164, v165
  v_cvt_pk_bf16_f32 v183, v166, v167
  ds_write_b128 v5, v[184:187] offset:0
  ds_write_b128 v5, v[188:191] offset:1024
  ds_write_b32 v6, v192 offset:2048
  v_mfma_f32_32x32x16_bf16 v[232:247], v[128:131], v[176:179], v[232:247]
  v_exp_f32 v136, v136
  v_exp_f32 v137, v137
  v_exp_f32 v138, v138
  v_mfma_f32_32x32x16_bf16 v[152:167], v[40:43], v[28:31], 0
  v_exp_f32 v139, v139
  v_cvt_pk_bf16_f32 v168, v136, v137
  v_exp_f32 v140, v140
  v_exp_f32 v141, v141
  v_mfma_f32_32x32x16_bf16 v[232:247], v[132:135], v[180:183], v[232:247]
  v_cvt_pk_bf16_f32 v169, v138, v139
  v_exp_f32 v142, v142
  v_exp_f32 v143, v143
  v_cvt_pk_bf16_f32 v170, v140, v141
  v_exp_f32 v144, v144
  v_exp_f32 v145, v145
  v_cvt_pk_bf16_f32 v171, v142, v143
  v_exp_f32 v146, v146
  v_exp_f32 v147, v147
  v_cvt_pk_bf16_f32 v172, v144, v145
  v_exp_f32 v148, v148
  v_exp_f32 v149, v149
  v_cvt_pk_bf16_f32 v173, v146, v147
  v_exp_f32 v150, v150
  v_exp_f32 v151, v151
  v_cvt_pk_bf16_f32 v174, v148, v149
  v_cvt_pk_bf16_f32 v175, v150, v151
  ds_write_b128 v5, v[200:203] offset:2304
  ds_write_b128 v5, v[204:207] offset:3328
  ds_write_b32 v6, v208 offset:4352
  s_waitcnt lgkmcnt(0)
  s_waitcnt vmcnt(4)
  v_mfma_f32_32x32x16_bf16 v[184:199], v[104:107], v[168:171], 0
  s_mov_b64 exec, s[68:69]
  buffer_load_dwordx4 v[128:131], v1, s[32:35], s71 offen offset:2048
  buffer_load_dwordx4 v[132:135], v1, s[32:35], s71 offen offset:3072
  s_mov_b64 exec, -1
  v_exp_f32 v152, v152
  v_exp_f32 v153, v153
  v_exp_f32 v154, v154
  v_mfma_f32_32x32x16_bf16 v[136:151], v[40:43], v[32:35], 0
  v_exp_f32 v155, v155
  v_cvt_pk_bf16_f32 v176, v152, v153
  v_exp_f32 v156, v156
  v_exp_f32 v157, v157
  v_mfma_f32_32x32x16_bf16 v[184:199], v[108:111], v[172:175], v[184:199]
  v_cvt_pk_bf16_f32 v177, v154, v155
  v_exp_f32 v158, v158
  v_exp_f32 v159, v159
  v_cvt_pk_bf16_f32 v178, v156, v157
  v_exp_f32 v160, v160
  v_exp_f32 v161, v161
  v_cvt_pk_bf16_f32 v179, v158, v159
  v_exp_f32 v162, v162
  v_exp_f32 v163, v163
  v_cvt_pk_bf16_f32 v180, v160, v161
  v_exp_f32 v164, v164
  v_exp_f32 v165, v165
  v_cvt_pk_bf16_f32 v181, v162, v163
  v_exp_f32 v166, v166
  v_exp_f32 v167, v167
  v_cvt_pk_bf16_f32 v182, v164, v165
  v_cvt_pk_bf16_f32 v183, v166, v167
  ds_write_b128 v5, v[216:219] offset:4608
  ds_write_b128 v5, v[220:223] offset:5632
  ds_write_b32 v6, v224 offset:6656
  s_waitcnt lgkmcnt(0)
  v_mfma_f32_32x32x16_bf16 v[200:215], v[104:107], v[176:179], 0
  v_exp_f32 v136, v136
  v_exp_f32 v137, v137
  v_exp_f32 v138, v138
  v_mfma_f32_32x32x16_bf16 v[152:167], v[40:43], v[36:39], 0
  v_exp_f32 v139, v139
  v_cvt_pk_bf16_f32 v168, v136, v137
  v_exp_f32 v140, v140
  v_exp_f32 v141, v141
  v_mfma_f32_32x32x16_bf16 v[200:215], v[108:111], v[180:183], v[200:215]
  v_cvt_pk_bf16_f32 v169, v138, v139
  v_exp_f32 v142, v142
  v_exp_f32 v143, v143
  v_cvt_pk_bf16_f32 v170, v140, v141
  v_exp_f32 v144, v144
  v_exp_f32 v145, v145
  v_cvt_pk_bf16_f32 v171, v142, v143
  v_exp_f32 v146, v146
  v_exp_f32 v147, v147
  v_cvt_pk_bf16_f32 v172, v144, v145
  v_exp_f32 v148, v148
  v_exp_f32 v149, v149
  v_cvt_pk_bf16_f32 v173, v146, v147
  v_exp_f32 v150, v150
  v_exp_f32 v151, v151
  v_cvt_pk_bf16_f32 v174, v148, v149
  v_cvt_pk_bf16_f32 v175, v150, v151
  ds_write_b128 v5, v[232:235] offset:6912
  ds_write_b128 v5, v[236:239] offset:7936
  ds_write_b32 v6, v240 offset:8960
  s_waitcnt lgkmcnt(0)
  v_mfma_f32_32x32x16_bf16 v[216:231], v[104:107], v[168:171], 0
  v_exp_f32 v152, v152
  v_exp_f32 v153, v153
  v_exp_f32 v154, v154
  v_mfma_f32_32x32x16_bf16 v[136:151], v[44:47], v[24:27], 0
  v_exp_f32 v155, v155
  v_cvt_pk_bf16_f32 v176, v152, v153
  v_exp_f32 v156, v156
  v_exp_f32 v157, v157
  v_mfma_f32_32x32x16_bf16 v[216:231], v[108:111], v[172:175], v[216:231]
  v_cvt_pk_bf16_f32 v177, v154, v155
  v_exp_f32 v158, v158
  v_exp_f32 v159, v159
  v_cvt_pk_bf16_f32 v178, v156, v157
  v_exp_f32 v160, v160
  v_exp_f32 v161, v161
  v_cvt_pk_bf16_f32 v179, v158, v159
  v_exp_f32 v162, v162
  v_exp_f32 v163, v163
  v_cvt_pk_bf16_f32 v180, v160, v161
  v_exp_f32 v164, v164
  v_exp_f32 v165, v165
  v_cvt_pk_bf16_f32 v181, v162, v163
  v_exp_f32 v166, v166
  v_exp_f32 v167, v167
  v_cvt_pk_bf16_f32 v182, v164, v165
  v_cvt_pk_bf16_f32 v183, v166, v167
  s_waitcnt lgkmcnt(0)
  s_mov_b64 exec, 1
  ds_add_u32 v2, v3 offset:48
  s_mov_b64 exec, -1
  v_mfma_f32_32x32x16_bf16 v[232:247], v[104:107], v[176:179], 0
  v_exp_f32 v136, v136
  v_exp_f32 v137, v137
  v_exp_f32 v138, v138
  v_mfma_f32_32x32x16_bf16 v[152:167], v[44:47], v[28:31], 0
  v_exp_f32 v139, v139
  v_cvt_pk_bf16_f32 v168, v136, v137
  v_exp_f32 v140, v140
  v_exp_f32 v141, v141
  v_mfma_f32_32x32x16_bf16 v[232:247], v[108:111], v[180:183], v[232:247]
  v_cvt_pk_bf16_f32 v169, v138, v139
  v_exp_f32 v142, v142
  v_exp_f32 v143, v143
  v_cvt_pk_bf16_f32 v170, v140, v141
  v_exp_f32 v144, v144
  v_exp_f32 v145, v145
  v_cvt_pk_bf16_f32 v171, v142, v143
  v_exp_f32 v146, v146
  v_exp_f32 v147, v147
  v_cvt_pk_bf16_f32 v172, v144, v145
  v_exp_f32 v148, v148
  v_exp_f32 v149, v149
  v_cvt_pk_bf16_f32 v173, v146, v147
  v_exp_f32 v150, v150
  v_exp_f32 v151, v151
  v_cvt_pk_bf16_f32 v174, v148, v149
  v_cvt_pk_bf16_f32 v175, v150, v151
  s_waitcnt vmcnt(4)
  v_mfma_f32_32x32x16_bf16 v[184:199], v[112:115], v[168:171], v[184:199]
  s_add_u32 s71, s67, 32768
  s_mov_b64 exec, s[68:69]
  buffer_load_dwordx4 v[104:107], v1, s[32:35], s71 offen offset:0
  buffer_load_dwordx4 v[108:111], v1, s[32:35], s71 offen offset:1024
  s_mov_b64 exec, -1
  v_exp_f32 v152, v152
  v_exp_f32 v153, v153
  v_exp_f32 v154, v154
  v_mfma_f32_32x32x16_bf16 v[136:151], v[44:47], v[32:35], 0
  v_exp_f32 v155, v155
  v_cvt_pk_bf16_f32 v176, v152, v153
  v_exp_f32 v156, v156
  v_exp_f32 v157, v157
  v_mfma_f32_32x32x16_bf16 v[184:199], v[116:119], v[172:175], v[184:199]
  v_cvt_pk_bf16_f32 v177, v154, v155
  v_exp_f32 v158, v158
  v_exp_f32 v159, v159
  v_cvt_pk_bf16_f32 v178, v156, v157
  v_exp_f32 v160, v160
  v_exp_f32 v161, v161
  v_cvt_pk_bf16_f32 v179, v158, v159
  v_exp_f32 v162, v162
  v_exp_f32 v163, v163
  v_cvt_pk_bf16_f32 v180, v160, v161
  v_exp_f32 v164, v164
  v_exp_f32 v165, v165
  v_cvt_pk_bf16_f32 v181, v162, v163
  v_exp_f32 v166, v166
  v_exp_f32 v167, v167
  v_cvt_pk_bf16_f32 v182, v164, v165
  v_cvt_pk_bf16_f32 v183, v166, v167
  v_mfma_f32_32x32x16_bf16 v[200:215], v[112:115], v[176:179], v[200:215]
  v_exp_f32 v136, v136
  v_exp_f32 v137, v137
  v_exp_f32 v138, v138
  v_mfma_f32_32x32x16_bf16 v[152:167], v[44:47], v[36:39], 0
  v_exp_f32 v139, v139
  v_cvt_pk_bf16_f32 v168, v136, v137
  v_exp_f32 v140, v140
  v_exp_f32 v141, v141
  v_mfma_f32_32x32x16_bf16 v[200:215], v[116:119], v[180:183], v[200:215]
  v_cvt_pk_bf16_f32 v169, v138, v139
  v_exp_f32 v142, v142
  v_exp_f32 v143, v143
  v_cvt_pk_bf16_f32 v170, v140, v141
  v_exp_f32 v144, v144
  v_exp_f32 v145, v145
  v_cvt_pk_bf16_f32 v171, v142, v143
  v_exp_f32 v146, v146
  v_exp_f32 v147, v147
  v_cvt_pk_bf16_f32 v172, v144, v145
  v_exp_f32 v148, v148
  v_exp_f32 v149, v149
  v_cvt_pk_bf16_f32 v173, v146, v147
  v_exp_f32 v150, v150
  v_exp_f32 v151, v151
  v_cvt_pk_bf16_f32 v174, v148, v149
  v_cvt_pk_bf16_f32 v175, v150, v151
  v_mfma_f32_32x32x16_bf16 v[216:231], v[112:115], v[168:171], v[216:231]
  v_exp_f32 v152, v152
  v_exp_f32 v153, v153
  v_exp_f32 v154, v154
  v_mfma_f32_32x32x16_bf16 v[136:151], v[48:51], v[24:27], 0
  v_exp_f32 v155, v155
  v_cvt_pk_bf16_f32 v176, v152, v153
  v_exp_f32 v156, v156
  v_exp_f32 v157, v157
  v_mfma_f32_32x32x16_bf16 v[216:231], v[116:119], v[172:175], v[216:231]
  v_cvt_pk_bf16_f32 v177, v154, v155
  v_exp_f32 v158, v158
  v_exp_f32 v159, v159
  v_cvt_pk_bf16_f32 v178, v156, v157
  v_exp_f32 v160, v160
  v_exp_f32 v161, v161
  v_cvt_pk_bf16_f32 v179, v158, v159
  v_exp_f32 v162, v162
  v_exp_f32 v163, v163
  v_cvt_pk_bf16_f32 v180, v160, v161
  v_exp_f32 v164, v164
  v_exp_f32 v165, v165
  v_cvt_pk_bf16_f32 v181, v162, v163
  v_exp_f32 v166, v166
  v_exp_f32 v167, v167
  v_cvt_pk_bf16_f32 v182, v164, v165
  v_cvt_pk_bf16_f32 v183, v166, v167
  v_mfma_f32_32x32x16_bf16 v[232:247], v[112:115], v[176:179], v[232:247]
  v_exp_f32 v136, v136
  v_exp_f32 v137, v137
  v_exp_f32 v138, v138
  v_mfma_f32_32x32x16_bf16 v[152:167], v[48:51], v[28:31], 0
  v_exp_f32 v139, v139
  v_cvt_pk_bf16_f32 v168, v136, v137
  v_exp_f32 v140, v140
  v_exp_f32 v141, v141
  v_mfma_f32_32x32x16_bf16 v[232:247], v[116:119], v[180:183], v[232:247]
  v_cvt_pk_bf16_f32 v169, v138, v139
  v_exp_f32 v142, v142
  v_exp_f32 v143, v143
  v_cvt_pk_bf16_f32 v170, v140, v141
  v_exp_f32 v144, v144
  v_exp_f32 v145, v145
  v_cvt_pk_bf16_f32 v171, v142, v143
  v_exp_f32 v146, v146
  v_exp_f32 v147, v147
  v_cvt_pk_bf16_f32 v172, v144, v145
  v_exp_f32 v148, v148
  v_exp_f32 v149, v149
  v_cvt_pk_bf16_f32 v173, v146, v147
  v_exp_f32 v150, v150
  v_exp_f32 v151, v151
  v_cvt_pk_bf16_f32 v174, v148, v149
  v_cvt_pk_bf16_f32 v175, v150, v151
  s_waitcnt vmcnt(4)
  v_mfma_f32_32x32x16_bf16 v[184:199], v[120:123], v[168:171], v[184:199]
  s_mov_b64 exec, s[68:69]
  buffer_load_dwordx4 v[112:115], v1, s[32:35], s71 offen offset:2048
  buffer_load_dwordx4 v[116:119], v1, s[32:35], s71 offen offset:3072
  s_mov_b64 exec, -1
  v_exp_f32 v152, v152
  v_exp_f32 v153, v153
  v_exp_f32 v154, v154
  v_mfma_f32_32x32x16_bf16 v[136:151], v[48:51], v[32:35], 0
  v_exp_f32 v155, v155
  v_cvt_pk_bf16_f32 v176, v152, v153
  v_exp_f32 v156, v156
  v_exp_f32 v157, v157
  v_mfma_f32_32x32x16_bf16 v[184:199], v[124:127], v[172:175], v[184:199]
  v_cvt_pk_bf16_f32 v177, v154, v155
  v_exp_f32 v158, v158
  v_exp_f32 v159, v159
  v_cvt_pk_bf16_f32 v178, v156, v157
  v_exp_f32 v160, v160
  v_exp_f32 v161, v161
  v_cvt_pk_bf16_f32 v179, v158, v159
  v_exp_f32 v162, v162
  v_exp_f32 v163, v163
  v_cvt_pk_bf16_f32 v180, v160, v161
  v_exp_f32 v164, v164
  v_exp_f32 v165, v165
  v_cvt_pk_bf16_f32 v181, v162, v163
  v_exp_f32 v166, v166
  v_exp_f32 v167, v167
  v_cvt_pk_bf16_f32 v182, v164, v165
  v_cvt_pk_bf16_f32 v183, v166, v167
  v_mfma_f32_32x32x16_bf16 v[200:215], v[120:123], v[176:179], v[200:215]
  v_exp_f32 v136, v136
  v_exp_f32 v137, v137
  v_exp_f32 v138, v138
  v_mfma_f32_32x32x16_bf16 v[152:167], v[48:51], v[36:39], 0
  v_exp_f32 v139, v139
  v_cvt_pk_bf16_f32 v168, v136, v137
  v_exp_f32 v140, v140
  v_exp_f32 v141, v141
  v_mfma_f32_32x32x16_bf16 v[200:215], v[124:127], v[180:183], v[200:215]
  v_cvt_pk_bf16_f32 v169, v138, v139
  v_exp_f32 v142, v142
  v_exp_f32 v143, v143
  v_cvt_pk_bf16_f32 v170, v140, v141
  v_exp_f32 v144, v144
  v_exp_f32 v145, v145
  v_cvt_pk_bf16_f32 v171, v142, v143
  v_exp_f32 v146, v146
  v_exp_f32 v147, v147
  v_cvt_pk_bf16_f32 v172, v144, v145
  v_exp_f32 v148, v148
  v_exp_f32 v149, v149
  v_cvt_pk_bf16_f32 v173, v146, v147
  v_exp_f32 v150, v150
  v_exp_f32 v151, v151
  v_cvt_pk_bf16_f32 v174, v148, v149
  v_cvt_pk_bf16_f32 v175, v150, v151
  v_mfma_f32_32x32x16_bf16 v[216:231], v[120:123], v[168:171], v[216:231]
  v_exp_f32 v152, v152
  v_exp_f32 v153, v153
  v_exp_f32 v154, v154
  v_mfma_f32_32x32x16_bf16 v[136:151], v[52:55], v[24:27], 0
  v_exp_f32 v155, v155
  v_cvt_pk_bf16_f32 v176, v152, v153
  v_exp_f32 v156, v156
  v_exp_f32 v157, v157
  v_mfma_f32_32x32x16_bf16 v[216:231], v[124:127], v[172:175], v[216:231]
  v_cvt_pk_bf16_f32 v177, v154, v155
  v_exp_f32 v158, v158
  v_exp_f32 v159, v159
  v_cvt_pk_bf16_f32 v178, v156, v157
  v_exp_f32 v160, v160
  v_exp_f32 v161, v161
  v_cvt_pk_bf16_f32 v179, v158, v159
  v_exp_f32 v162, v162
  v_exp_f32 v163, v163
  v_cvt_pk_bf16_f32 v180, v160, v161
  v_exp_f32 v164, v164
  v_exp_f32 v165, v165
  v_cvt_pk_bf16_f32 v181, v162, v163
  v_exp_f32 v166, v166
  v_exp_f32 v167, v167
  v_cvt_pk_bf16_f32 v182, v164, v165
  v_cvt_pk_bf16_f32 v183, v166, v167
  v_mfma_f32_32x32x16_bf16 v[232:247], v[120:123], v[176:179], v[232:247]
  v_exp_f32 v136, v136
  v_exp_f32 v137, v137
  v_exp_f32 v138, v138
  v_mfma_f32_32x32x16_bf16 v[152:167], v[52:55], v[28:31], 0
  v_exp_f32 v139, v139
  v_cvt_pk_bf16_f32 v168, v136, v137
  v_exp_f32 v140, v140
  v_exp_f32 v141, v141
  v_mfma_f32_32x32x16_bf16 v[232:247], v[124:127], v[180:183], v[232:247]
  v_cvt_pk_bf16_f32 v169, v138, v139
  v_exp_f32 v142, v142
  v_exp_f32 v143, v143
  v_cvt_pk_bf16_f32 v170, v140, v141
  v_exp_f32 v144, v144
  v_exp_f32 v145, v145
  v_cvt_pk_bf16_f32 v171, v142, v143
  v_exp_f32 v146, v146
  v_exp_f32 v147, v147
  v_cvt_pk_bf16_f32 v172, v144, v145
  v_exp_f32 v148, v148
  v_exp_f32 v149, v149
  v_cvt_pk_bf16_f32 v173, v146, v147
  v_exp_f32 v150, v150
  v_exp_f32 v151, v151
  v_cvt_pk_bf16_f32 v174, v148, v149
  v_cvt_pk_bf16_f32 v175, v150, v151
  s_waitcnt vmcnt(4)
  v_mfma_f32_32x32x16_bf16 v[184:199], v[128:131], v[168:171], v[184:199]
  s_add_u32 s71, s67, 36864
  s_mov_b64 exec, s[68:69]
  buffer_load_dwordx4 v[120:123], v1, s[32:35], s71 offen offset:0
  buffer_load_dwordx4 v[124:127], v1, s[32:35], s71 offen offset:1024
  s_mov_b64 exec, -1
  v_exp_f32 v152, v152
  v_exp_f32 v153, v153
  v_exp_f32 v154, v154
  v_mfma_f32_32x32x16_bf16 v[136:151], v[52:55], v[32:35], 0
  v_exp_f32 v155, v155
  v_cvt_pk_bf16_f32 v176, v152, v153
  v_exp_f32 v156, v156
  v_exp_f32 v157, v157
  v_mfma_f32_32x32x16_bf16 v[184:199], v[132:135], v[172:175], v[184:199]
  v_cvt_pk_bf16_f32 v177, v154, v155
  v_exp_f32 v158, v158
  v_exp_f32 v159, v159
  v_cvt_pk_bf16_f32 v178, v156, v157
  v_exp_f32 v160, v160
  v_exp_f32 v161, v161
  v_cvt_pk_bf16_f32 v179, v158, v159
  v_exp_f32 v162, v162
  v_exp_f32 v163, v163
  v_cvt_pk_bf16_f32 v180, v160, v161
  v_exp_f32 v164, v164
  v_exp_f32 v165, v165
  v_cvt_pk_bf16_f32 v181, v162, v163
  v_exp_f32 v166, v166
  v_exp_f32 v167, v167
  v_cvt_pk_bf16_f32 v182, v164, v165
  v_cvt_pk_bf16_f32 v183, v166, v167
  v_mfma_f32_32x32x16_bf16 v[200:215], v[128:131], v[176:179], v[200:215]
  v_exp_f32 v136, v136
  v_exp_f32 v137, v137
  v_exp_f32 v138, v138
  v_mfma_f32_32x32x16_bf16 v[152:167], v[52:55], v[36:39], 0
  v_exp_f32 v139, v139
  v_cvt_pk_bf16_f32 v168, v136, v137
  v_exp_f32 v140, v140
  v_exp_f32 v141, v141
  v_mfma_f32_32x32x16_bf16 v[200:215], v[132:135], v[180:183], v[200:215]
  v_cvt_pk_bf16_f32 v169, v138, v139
  v_exp_f32 v142, v142
  v_exp_f32 v143, v143
  v_cvt_pk_bf16_f32 v170, v140, v141
  v_exp_f32 v144, v144
  v_exp_f32 v145, v145
  v_cvt_pk_bf16_f32 v171, v142, v143
  v_exp_f32 v146, v146
  v_exp_f32 v147, v147
  v_cvt_pk_bf16_f32 v172, v144, v145
  v_exp_f32 v148, v148
  v_exp_f32 v149, v149
  v_cvt_pk_bf16_f32 v173, v146, v147
  v_exp_f32 v150, v150
  v_exp_f32 v151, v151
  v_cvt_pk_bf16_f32 v174, v148, v149
  v_cvt_pk_bf16_f32 v175, v150, v151
  v_mfma_f32_32x32x16_bf16 v[216:231], v[128:131], v[168:171], v[216:231]
  v_exp_f32 v152, v152
  v_exp_f32 v153, v153
  v_exp_f32 v154, v154
  v_mfma_f32_32x32x16_bf16 v[136:151], v[56:59], v[24:27], 0
  v_exp_f32 v155, v155
  v_cvt_pk_bf16_f32 v176, v152, v153
  v_exp_f32 v156, v156
  v_exp_f32 v157, v157
  v_mfma_f32_32x32x16_bf16 v[216:231], v[132:135], v[172:175], v[216:231]
  v_cvt_pk_bf16_f32 v177, v154, v155
  v_exp_f32 v158, v158
  v_exp_f32 v159, v159
  v_cvt_pk_bf16_f32 v178, v156, v157
  v_exp_f32 v160, v160
  v_exp_f32 v161, v161
  v_cvt_pk_bf16_f32 v179, v158, v159
  v_exp_f32 v162, v162
  v_exp_f32 v163, v163
  v_cvt_pk_bf16_f32 v180, v160, v161
  v_exp_f32 v164, v164
  v_exp_f32 v165, v165
  v_cvt_pk_bf16_f32 v181, v162, v163
  v_exp_f32 v166, v166
  v_exp_f32 v167, v167
  v_cvt_pk_bf16_f32 v182, v164, v165
  v_cvt_pk_bf16_f32 v183, v166, v167
  v_mfma_f32_32x32x16_bf16 v[232:247], v[128:131], v[176:179], v[232:247]
  v_exp_f32 v136, v136
  v_exp_f32 v137, v137
  v_exp_f32 v138, v138
  v_mfma_f32_32x32x16_bf16 v[152:167], v[56:59], v[28:31], 0
  v_exp_f32 v139, v139
  v_cvt_pk_bf16_f32 v168, v136, v137
  v_exp_f32 v140, v140
  v_exp_f32 v141, v141
  v_mfma_f32_32x32x16_bf16 v[232:247], v[132:135], v[180:183], v[232:247]
  v_cvt_pk_bf16_f32 v169, v138, v139
  v_exp_f32 v142, v142
  v_exp_f32 v143, v143
  v_cvt_pk_bf16_f32 v170, v140, v141
  v_exp_f32 v144, v144
  v_exp_f32 v145, v145
  v_cvt_pk_bf16_f32 v171, v142, v143
  v_exp_f32 v146, v146
  v_exp_f32 v147, v147
  v_cvt_pk_bf16_f32 v172, v144, v145
  v_exp_f32 v148, v148
  v_exp_f32 v149, v149
  v_cvt_pk_bf16_f32 v173, v146, v147
  v_exp_f32 v150, v150
  v_exp_f32 v151, v151
  v_cvt_pk_bf16_f32 v174, v148, v149
  v_cvt_pk_bf16_f32 v175, v150, v151
  s_waitcnt vmcnt(4)
  v_mfma_f32_32x32x16_bf16 v[184:199], v[104:107], v[168:171], v[184:199]
  s_mov_b64 exec, s[68:69]
  buffer_load_dwordx4 v[128:131], v1, s[32:35], s71 offen offset:2048
  buffer_load_dwordx4 v[132:135], v1, s[32:35], s71 offen offset:3072
  s_mov_b64 exec, -1
  v_exp_f32 v152, v152
  v_exp_f32 v153, v153
  v_exp_f32 v154, v154
  v_mfma_f32_32x32x16_bf16 v[136:151], v[56:59], v[32:35], 0
  v_exp_f32 v155, v155
  v_cvt_pk_bf16_f32 v176, v152, v153
  v_exp_f32 v156, v156
  v_exp_f32 v157, v157
  v_mfma_f32_32x32x16_bf16 v[184:199], v[108:111], v[172:175], v[184:199]
  v_cvt_pk_bf16_f32 v177, v154, v155
  v_exp_f32 v158, v158
  v_exp_f32 v159, v159
  v_cvt_pk_bf16_f32 v178, v156, v157
  v_exp_f32 v160, v160
  v_exp_f32 v161, v161
  v_cvt_pk_bf16_f32 v179, v158, v159
  v_exp_f32 v162, v162
  v_exp_f32 v163, v163
  v_cvt_pk_bf16_f32 v180, v160, v161
  v_exp_f32 v164, v164
  v_exp_f32 v165, v165
  v_cvt_pk_bf16_f32 v181, v162, v163
  v_exp_f32 v166, v166
  v_exp_f32 v167, v167
  v_cvt_pk_bf16_f32 v182, v164, v165
  v_cvt_pk_bf16_f32 v183, v166, v167
  v_mfma_f32_32x32x16_bf16 v[200:215], v[104:107], v[176:179], v[200:215]
  v_exp_f32 v136, v136
  v_exp_f32 v137, v137
  v_exp_f32 v138, v138
  v_mfma_f32_32x32x16_bf16 v[152:167], v[56:59], v[36:39], 0
  v_exp_f32 v139, v139
  v_cvt_pk_bf16_f32 v168, v136, v137
  v_exp_f32 v140, v140
  v_exp_f32 v141, v141
  v_mfma_f32_32x32x16_bf16 v[200:215], v[108:111], v[180:183], v[200:215]
  v_cvt_pk_bf16_f32 v169, v138, v139
  v_exp_f32 v142, v142
  v_exp_f32 v143, v143
  v_cvt_pk_bf16_f32 v170, v140, v141
  v_exp_f32 v144, v144
  v_exp_f32 v145, v145
  v_cvt_pk_bf16_f32 v171, v142, v143
  v_exp_f32 v146, v146
  v_exp_f32 v147, v147
  v_cvt_pk_bf16_f32 v172, v144, v145
  v_exp_f32 v148, v148
  v_exp_f32 v149, v149
  v_cvt_pk_bf16_f32 v173, v146, v147
  v_exp_f32 v150, v150
  v_exp_f32 v151, v151
  v_cvt_pk_bf16_f32 v174, v148, v149
  v_cvt_pk_bf16_f32 v175, v150, v151
  v_mfma_f32_32x32x16_bf16 v[216:231], v[104:107], v[168:171], v[216:231]
  v_exp_f32 v152, v152
  v_exp_f32 v153, v153
  v_exp_f32 v154, v154
  v_mfma_f32_32x32x16_bf16 v[136:151], v[60:63], v[24:27], 0
  v_exp_f32 v155, v155
  v_cvt_pk_bf16_f32 v176, v152, v153
  v_exp_f32 v156, v156
  v_exp_f32 v157, v157
  v_mfma_f32_32x32x16_bf16 v[216:231], v[108:111], v[172:175], v[216:231]
  v_cvt_pk_bf16_f32 v177, v154, v155
  v_exp_f32 v158, v158
  v_exp_f32 v159, v159
  v_cvt_pk_bf16_f32 v178, v156, v157
  v_exp_f32 v160, v160
  v_exp_f32 v161, v161
  v_cvt_pk_bf16_f32 v179, v158, v159
  v_exp_f32 v162, v162
  v_exp_f32 v163, v163
  v_cvt_pk_bf16_f32 v180, v160, v161
  v_exp_f32 v164, v164
  v_exp_f32 v165, v165
  v_cvt_pk_bf16_f32 v181, v162, v163
  v_exp_f32 v166, v166
  v_exp_f32 v167, v167
  v_cvt_pk_bf16_f32 v182, v164, v165
  v_cvt_pk_bf16_f32 v183, v166, v167
  v_mfma_f32_32x32x16_bf16 v[232:247], v[104:107], v[176:179], v[232:247]
  v_exp_f32 v136, v136
  v_exp_f32 v137, v137
  v_exp_f32 v138, v138
  v_mfma_f32_32x32x16_bf16 v[152:167], v[60:63], v[28:31], 0
  v_exp_f32 v139, v139
  v_cvt_pk_bf16_f32 v168, v136, v137
  v_exp_f32 v140, v140
  v_exp_f32 v141, v141
  v_mfma_f32_32x32x16_bf16 v[232:247], v[108:111], v[180:183], v[232:247]
  v_cvt_pk_bf16_f32 v169, v138, v139
  v_exp_f32 v142, v142
  v_exp_f32 v143, v143
  v_cvt_pk_bf16_f32 v170, v140, v141
  v_exp_f32 v144, v144
  v_exp_f32 v145, v145
  v_cvt_pk_bf16_f32 v171, v142, v143
  v_exp_f32 v146, v146
  v_exp_f32 v147, v147
  v_cvt_pk_bf16_f32 v172, v144, v145
  v_exp_f32 v148, v148
  v_exp_f32 v149, v149
  v_cvt_pk_bf16_f32 v173, v146, v147
  v_exp_f32 v150, v150
  v_exp_f32 v151, v151
  v_cvt_pk_bf16_f32 v174, v148, v149
  v_cvt_pk_bf16_f32 v175, v150, v151
  s_waitcnt vmcnt(4)
  v_mfma_f32_32x32x16_bf16 v[184:199], v[112:115], v[168:171], v[184:199]
  s_add_u32 s71, s67, 98304
  s_mov_b64 exec, s[68:69]
  buffer_load_dwordx4 v[104:107], v1, s[32:35], s71 offen offset:0
  buffer_load_dwordx4 v[108:111], v1, s[32:35], s71 offen offset:1024
  s_mov_b64 exec, -1
  v_exp_f32 v152, v152
  v_exp_f32 v153, v153
  v_exp_f32 v154, v154
  v_mfma_f32_32x32x16_bf16 v[136:151], v[60:63], v[32:35], 0
  v_exp_f32 v155, v155
  v_cvt_pk_bf16_f32 v176, v152, v153
  v_exp_f32 v156, v156
  v_exp_f32 v157, v157
  v_mfma_f32_32x32x16_bf16 v[184:199], v[116:119], v[172:175], v[184:199]
  v_cvt_pk_bf16_f32 v177, v154, v155
  v_exp_f32 v158, v158
  v_exp_f32 v159, v159
  v_cvt_pk_bf16_f32 v178, v156, v157
  v_exp_f32 v160, v160
  v_exp_f32 v161, v161
  v_cvt_pk_bf16_f32 v179, v158, v159
  v_exp_f32 v162, v162
  v_exp_f32 v163, v163
  v_cvt_pk_bf16_f32 v180, v160, v161
  v_exp_f32 v164, v164
  v_exp_f32 v165, v165
  v_cvt_pk_bf16_f32 v181, v162, v163
  v_exp_f32 v166, v166
  v_exp_f32 v167, v167
  v_cvt_pk_bf16_f32 v182, v164, v165
  v_cvt_pk_bf16_f32 v183, v166, v167
  v_mfma_f32_32x32x16_bf16 v[200:215], v[112:115], v[176:179], v[200:215]
  v_exp_f32 v136, v136
  v_exp_f32 v137, v137
  v_exp_f32 v138, v138
  v_mfma_f32_32x32x16_bf16 v[152:167], v[60:63], v[36:39], 0
  v_exp_f32 v139, v139
  v_cvt_pk_bf16_f32 v168, v136, v137
  v_exp_f32 v140, v140
  v_exp_f32 v141, v141
  v_mfma_f32_32x32x16_bf16 v[200:215], v[116:119], v[180:183], v[200:215]
  v_cvt_pk_bf16_f32 v169, v138, v139
  v_exp_f32 v142, v142
  v_exp_f32 v143, v143
  v_cvt_pk_bf16_f32 v170, v140, v141
  v_exp_f32 v144, v144
  v_exp_f32 v145, v145
  v_cvt_pk_bf16_f32 v171, v142, v143
  v_exp_f32 v146, v146
  v_exp_f32 v147, v147
  v_cvt_pk_bf16_f32 v172, v144, v145
  v_exp_f32 v148, v148
  v_exp_f32 v149, v149
  v_cvt_pk_bf16_f32 v173, v146, v147
  v_exp_f32 v150, v150
  v_exp_f32 v151, v151
  v_cvt_pk_bf16_f32 v174, v148, v149
  v_cvt_pk_bf16_f32 v175, v150, v151
  v_mfma_f32_32x32x16_bf16 v[216:231], v[112:115], v[168:171], v[216:231]
  v_exp_f32 v152, v152
  v_exp_f32 v153, v153
  v_exp_f32 v154, v154
  v_mfma_f32_32x32x16_bf16 v[136:151], v[64:67], v[24:27], 0
  v_exp_f32 v155, v155
  v_cvt_pk_bf16_f32 v176, v152, v153
  v_exp_f32 v156, v156
  v_exp_f32 v157, v157
  v_mfma_f32_32x32x16_bf16 v[216:231], v[116:119], v[172:175], v[216:231]
  v_cvt_pk_bf16_f32 v177, v154, v155
  v_exp_f32 v158, v158
  v_exp_f32 v159, v159
  v_cvt_pk_bf16_f32 v178, v156, v157
  v_exp_f32 v160, v160
  v_exp_f32 v161, v161
  v_cvt_pk_bf16_f32 v179, v158, v159
  v_exp_f32 v162, v162
  v_exp_f32 v163, v163
  v_cvt_pk_bf16_f32 v180, v160, v161
  v_exp_f32 v164, v164
  v_exp_f32 v165, v165
  v_cvt_pk_bf16_f32 v181, v162, v163
  v_exp_f32 v166, v166
  v_exp_f32 v167, v167
  v_cvt_pk_bf16_f32 v182, v164, v165
  v_cvt_pk_bf16_f32 v183, v166, v167
  v_mfma_f32_32x32x16_bf16 v[232:247], v[112:115], v[176:179], v[232:247]
  v_exp_f32 v136, v136
  v_exp_f32 v137, v137
  v_exp_f32 v138, v138
  v_mfma_f32_32x32x16_bf16 v[152:167], v[64:67], v[28:31], 0
  v_exp_f32 v139, v139
  v_cvt_pk_bf16_f32 v168, v136, v137
  v_exp_f32 v140, v140
  v_exp_f32 v141, v141
  v_mfma_f32_32x32x16_bf16 v[232:247], v[116:119], v[180:183], v[232:247]
  v_cvt_pk_bf16_f32 v169, v138, v139
  v_exp_f32 v142, v142
  v_exp_f32 v143, v143
  v_cvt_pk_bf16_f32 v170, v140, v141
  v_exp_f32 v144, v144
  v_exp_f32 v145, v145
  v_cvt_pk_bf16_f32 v171, v142, v143
  v_exp_f32 v146, v146
  v_exp_f32 v147, v147
  v_cvt_pk_bf16_f32 v172, v144, v145
  v_exp_f32 v148, v148
  v_exp_f32 v149, v149
  v_cvt_pk_bf16_f32 v173, v146, v147
  v_exp_f32 v150, v150
  v_exp_f32 v151, v151
  v_cvt_pk_bf16_f32 v174, v148, v149
  v_cvt_pk_bf16_f32 v175, v150, v151
  s_waitcnt vmcnt(4)
  v_mfma_f32_32x32x16_bf16 v[184:199], v[120:123], v[168:171], v[184:199]
  s_mov_b64 exec, s[68:69]
  buffer_load_dwordx4 v[112:115], v1, s[32:35], s71 offen offset:2048
  buffer_load_dwordx4 v[116:119], v1, s[32:35], s71 offen offset:3072
  s_mov_b64 exec, -1
  v_exp_f32 v152, v152
  v_exp_f32 v153, v153
  v_exp_f32 v154, v154
  v_mfma_f32_32x32x16_bf16 v[136:151], v[64:67], v[32:35], 0
  v_exp_f32 v155, v155
  v_cvt_pk_bf16_f32 v176, v152, v153
  v_exp_f32 v156, v156
  v_exp_f32 v157, v157
  v_mfma_f32_32x32x16_bf16 v[184:199], v[124:127], v[172:175], v[184:199]
  v_cvt_pk_bf16_f32 v177, v154, v155
  v_exp_f32 v158, v158
  v_exp_f32 v159, v159
  v_cvt_pk_bf16_f32 v178, v156, v157
  v_exp_f32 v160, v160
  v_exp_f32 v161, v161
  v_cvt_pk_bf16_f32 v179, v158, v159
  v_exp_f32 v162, v162
  v_exp_f32 v163, v163
  v_cvt_pk_bf16_f32 v180, v160, v161
  v_exp_f32 v164, v164
  v_exp_f32 v165, v165
  v_cvt_pk_bf16_f32 v181, v162, v163
  v_exp_f32 v166, v166
  v_exp_f32 v167, v167
  v_cvt_pk_bf16_f32 v182, v164, v165
  v_cvt_pk_bf16_f32 v183, v166, v167
  v_mfma_f32_32x32x16_bf16 v[200:215], v[120:123], v[176:179], v[200:215]
  v_exp_f32 v136, v136
  v_exp_f32 v137, v137
  v_exp_f32 v138, v138
  v_mfma_f32_32x32x16_bf16 v[152:167], v[64:67], v[36:39], 0
  v_exp_f32 v139, v139
  v_cvt_pk_bf16_f32 v168, v136, v137
  v_exp_f32 v140, v140
  v_exp_f32 v141, v141
  v_mfma_f32_32x32x16_bf16 v[200:215], v[124:127], v[180:183], v[200:215]
  v_cvt_pk_bf16_f32 v169, v138, v139
  v_exp_f32 v142, v142
  v_exp_f32 v143, v143
  v_cvt_pk_bf16_f32 v170, v140, v141
  v_exp_f32 v144, v144
  v_exp_f32 v145, v145
  v_cvt_pk_bf16_f32 v171, v142, v143
  v_exp_f32 v146, v146
  v_exp_f32 v147, v147
  v_cvt_pk_bf16_f32 v172, v144, v145
  v_exp_f32 v148, v148
  v_exp_f32 v149, v149
  v_cvt_pk_bf16_f32 v173, v146, v147
  v_exp_f32 v150, v150
  v_exp_f32 v151, v151
  v_cvt_pk_bf16_f32 v174, v148, v149
  v_cvt_pk_bf16_f32 v175, v150, v151
  v_mfma_f32_32x32x16_bf16 v[216:231], v[120:123], v[168:171], v[216:231]
  v_exp_f32 v152, v152
  v_exp_f32 v153, v153
  v_exp_f32 v154, v154
  v_mfma_f32_32x32x16_bf16 v[136:151], v[68:71], v[24:27], 0
  v_exp_f32 v155, v155
  v_cvt_pk_bf16_f32 v176, v152, v153
  v_exp_f32 v156, v156
  v_exp_f32 v157, v157
  v_mfma_f32_32x32x16_bf16 v[216:231], v[124:127], v[172:175], v[216:231]
  v_cvt_pk_bf16_f32 v177, v154, v155
  v_exp_f32 v158, v158
  v_exp_f32 v159, v159
  v_cvt_pk_bf16_f32 v178, v156, v157
  v_exp_f32 v160, v160
  v_exp_f32 v161, v161
  v_cvt_pk_bf16_f32 v179, v158, v159
  v_exp_f32 v162, v162
  v_exp_f32 v163, v163
  v_cvt_pk_bf16_f32 v180, v160, v161
  v_exp_f32 v164, v164
  v_exp_f32 v165, v165
  v_cvt_pk_bf16_f32 v181, v162, v163
  v_exp_f32 v166, v166
  v_exp_f32 v167, v167
  v_cvt_pk_bf16_f32 v182, v164, v165
  v_cvt_pk_bf16_f32 v183, v166, v167
  v_mfma_f32_32x32x16_bf16 v[232:247], v[120:123], v[176:179], v[232:247]
  v_exp_f32 v136, v136
  v_exp_f32 v137, v137
  v_exp_f32 v138, v138
  v_mfma_f32_32x32x16_bf16 v[152:167], v[68:71], v[28:31], 0
  v_exp_f32 v139, v139
  v_cvt_pk_bf16_f32 v168, v136, v137
  v_exp_f32 v140, v140
  v_exp_f32 v141, v141
  v_mfma_f32_32x32x16_bf16 v[232:247], v[124:127], v[180:183], v[232:247]
  v_cvt_pk_bf16_f32 v169, v138, v139
  v_exp_f32 v142, v142
  v_exp_f32 v143, v143
  v_cvt_pk_bf16_f32 v170, v140, v141
  v_exp_f32 v144, v144
  v_exp_f32 v145, v145
  v_cvt_pk_bf16_f32 v171, v142, v143
  v_exp_f32 v146, v146
  v_exp_f32 v147, v147
  v_cvt_pk_bf16_f32 v172, v144, v145
  v_exp_f32 v148, v148
  v_exp_f32 v149, v149
  v_cvt_pk_bf16_f32 v173, v146, v147
  v_exp_f32 v150, v150
  v_exp_f32 v151, v151
  v_cvt_pk_bf16_f32 v174, v148, v149
  v_cvt_pk_bf16_f32 v175, v150, v151
  s_waitcnt vmcnt(4)
  v_mfma_f32_32x32x16_bf16 v[184:199], v[128:131], v[168:171], v[184:199]
  s_add_u32 s71, s67, 102400
  s_mov_b64 exec, s[68:69]
  buffer_load_dwordx4 v[120:123], v1, s[32:35], s71 offen offset:0
  buffer_load_dwordx4 v[124:127], v1, s[32:35], s71 offen offset:1024
  s_mov_b64 exec, -1
  v_exp_f32 v152, v152
  v_exp_f32 v153, v153
  v_exp_f32 v154, v154
  v_mfma_f32_32x32x16_bf16 v[136:151], v[68:71], v[32:35], 0
  v_exp_f32 v155, v155
  v_cvt_pk_bf16_f32 v176, v152, v153
  v_exp_f32 v156, v156
  v_exp_f32 v157, v157
  v_mfma_f32_32x32x16_bf16 v[184:199], v[132:135], v[172:175], v[184:199]
  v_cvt_pk_bf16_f32 v177, v154, v155
  v_exp_f32 v158, v158
  v_exp_f32 v159, v159
  v_cvt_pk_bf16_f32 v178, v156, v157
  v_exp_f32 v160, v160
  v_exp_f32 v161, v161
  v_cvt_pk_bf16_f32 v179, v158, v159
  v_exp_f32 v162, v162
  v_exp_f32 v163, v163
  v_cvt_pk_bf16_f32 v180, v160, v161
  v_exp_f32 v164, v164
  v_exp_f32 v165, v165
  v_cvt_pk_bf16_f32 v181, v162, v163
  v_exp_f32 v166, v166
  v_exp_f32 v167, v167
  v_cvt_pk_bf16_f32 v182, v164, v165
  v_cvt_pk_bf16_f32 v183, v166, v167
  v_mfma_f32_32x32x16_bf16 v[200:215], v[128:131], v[176:179], v[200:215]
  v_exp_f32 v136, v136
  v_exp_f32 v137, v137
  v_exp_f32 v138, v138
  v_mfma_f32_32x32x16_bf16 v[152:167], v[68:71], v[36:39], 0
  v_exp_f32 v139, v139
  v_cvt_pk_bf16_f32 v168, v136, v137
  v_exp_f32 v140, v140
  v_exp_f32 v141, v141
  v_mfma_f32_32x32x16_bf16 v[200:215], v[132:135], v[180:183], v[200:215]
  v_cvt_pk_bf16_f32 v169, v138, v139
  v_exp_f32 v142, v142
  v_exp_f32 v143, v143
  v_cvt_pk_bf16_f32 v170, v140, v141
  v_exp_f32 v144, v144
  v_exp_f32 v145, v145
  v_cvt_pk_bf16_f32 v171, v142, v143
  v_exp_f32 v146, v146
  v_exp_f32 v147, v147
  v_cvt_pk_bf16_f32 v172, v144, v145
  v_exp_f32 v148, v148
  v_exp_f32 v149, v149
  v_cvt_pk_bf16_f32 v173, v146, v147
  v_exp_f32 v150, v150
  v_exp_f32 v151, v151
  v_cvt_pk_bf16_f32 v174, v148, v149
  v_cvt_pk_bf16_f32 v175, v150, v151
  v_mfma_f32_32x32x16_bf16 v[216:231], v[128:131], v[168:171], v[216:231]
  v_exp_f32 v152, v152
  v_exp_f32 v153, v153
  v_exp_f32 v154, v154
  v_mfma_f32_32x32x16_bf16 v[136:151], v[72:75], v[24:27], 0
  v_exp_f32 v155, v155
  v_cvt_pk_bf16_f32 v176, v152, v153
  v_exp_f32 v156, v156
  v_exp_f32 v157, v157
  v_mfma_f32_32x32x16_bf16 v[216:231], v[132:135], v[172:175], v[216:231]
  v_cvt_pk_bf16_f32 v177, v154, v155
  v_exp_f32 v158, v158
  v_exp_f32 v159, v159
  v_cvt_pk_bf16_f32 v178, v156, v157
  v_exp_f32 v160, v160
  v_exp_f32 v161, v161
  v_cvt_pk_bf16_f32 v179, v158, v159
  v_exp_f32 v162, v162
  v_exp_f32 v163, v163
  v_cvt_pk_bf16_f32 v180, v160, v161
  v_exp_f32 v164, v164
  v_exp_f32 v165, v165
  v_cvt_pk_bf16_f32 v181, v162, v163
  v_exp_f32 v166, v166
  v_exp_f32 v167, v167
  v_cvt_pk_bf16_f32 v182, v164, v165
  v_cvt_pk_bf16_f32 v183, v166, v167
  v_mfma_f32_32x32x16_bf16 v[232:247], v[128:131], v[176:179], v[232:247]
  v_exp_f32 v136, v136
  v_exp_f32 v137, v137
  v_exp_f32 v138, v138
  v_mfma_f32_32x32x16_bf16 v[152:167], v[72:75], v[28:31], 0
  v_exp_f32 v139, v139
  v_cvt_pk_bf16_f32 v168, v136, v137
  v_exp_f32 v140, v140
  v_exp_f32 v141, v141
  v_mfma_f32_32x32x16_bf16 v[232:247], v[132:135], v[180:183], v[232:247]
  v_cvt_pk_bf16_f32 v169, v138, v139
  v_exp_f32 v142, v142
  v_exp_f32 v143, v143
  v_cvt_pk_bf16_f32 v170, v140, v141
  v_exp_f32 v144, v144
  v_exp_f32 v145, v145
  v_cvt_pk_bf16_f32 v171, v142, v143
  v_exp_f32 v146, v146
  v_exp_f32 v147, v147
  v_cvt_pk_bf16_f32 v172, v144, v145
  v_exp_f32 v148, v148
  v_exp_f32 v149, v149
  v_cvt_pk_bf16_f32 v173, v146, v147
  v_exp_f32 v150, v150
  v_exp_f32 v151, v151
  v_cvt_pk_bf16_f32 v174, v148, v149
  v_cvt_pk_bf16_f32 v175, v150, v151
  s_waitcnt vmcnt(4)
  v_mfma_f32_32x32x16_bf16 v[184:199], v[104:107], v[168:171], v[184:199]
  s_mov_b64 exec, s[68:69]
  buffer_load_dwordx4 v[128:131], v1, s[32:35], s71 offen offset:2048
  buffer_load_dwordx4 v[132:135], v1, s[32:35], s71 offen offset:3072
  s_mov_b64 exec, -1
  v_exp_f32 v152, v152
  v_exp_f32 v153, v153
  v_exp_f32 v154, v154
  v_mfma_f32_32x32x16_bf16 v[136:151], v[72:75], v[32:35], 0
  v_exp_f32 v155, v155
  v_cvt_pk_bf16_f32 v176, v152, v153
  v_exp_f32 v156, v156
  v_exp_f32 v157, v157
  v_mfma_f32_32x32x16_bf16 v[184:199], v[108:111], v[172:175], v[184:199]
  v_cvt_pk_bf16_f32 v177, v154, v155
  v_exp_f32 v158, v158
  v_exp_f32 v159, v159
  v_cvt_pk_bf16_f32 v178, v156, v157
  v_exp_f32 v160, v160
  v_exp_f32 v161, v161
  v_cvt_pk_bf16_f32 v179, v158, v159
  v_exp_f32 v162, v162
  v_exp_f32 v163, v163
  v_cvt_pk_bf16_f32 v180, v160, v161
  v_exp_f32 v164, v164
  v_exp_f32 v165, v165
  v_cvt_pk_bf16_f32 v181, v162, v163
  v_exp_f32 v166, v166
  v_exp_f32 v167, v167
  v_cvt_pk_bf16_f32 v182, v164, v165
  v_cvt_pk_bf16_f32 v183, v166, v167
  v_mfma_f32_32x32x16_bf16 v[200:215], v[104:107], v[176:179], v[200:215]
  v_exp_f32 v136, v136
  v_exp_f32 v137, v137
  v_exp_f32 v138, v138
  v_mfma_f32_32x32x16_bf16 v[152:167], v[72:75], v[36:39], 0
  v_exp_f32 v139, v139
  v_cvt_pk_bf16_f32 v168, v136, v137
  v_exp_f32 v140, v140
  v_exp_f32 v141, v141
  v_mfma_f32_32x32x16_bf16 v[200:215], v[108:111], v[180:183], v[200:215]
  v_cvt_pk_bf16_f32 v169, v138, v139
  v_exp_f32 v142, v142
  v_exp_f32 v143, v143
  v_cvt_pk_bf16_f32 v170, v140, v141
  v_exp_f32 v144, v144
  v_exp_f32 v145, v145
  v_cvt_pk_bf16_f32 v171, v142, v143
  v_exp_f32 v146, v146
  v_exp_f32 v147, v147
  v_cvt_pk_bf16_f32 v172, v144, v145
  v_exp_f32 v148, v148
  v_exp_f32 v149, v149
  v_cvt_pk_bf16_f32 v173, v146, v147
  v_exp_f32 v150, v150
  v_exp_f32 v151, v151
  v_cvt_pk_bf16_f32 v174, v148, v149
  v_cvt_pk_bf16_f32 v175, v150, v151
  v_mfma_f32_32x32x16_bf16 v[216:231], v[104:107], v[168:171], v[216:231]
  v_exp_f32 v152, v152
  v_exp_f32 v153, v153
  v_exp_f32 v154, v154
  v_mfma_f32_32x32x16_bf16 v[136:151], v[76:79], v[24:27], 0
  v_exp_f32 v155, v155
  v_cvt_pk_bf16_f32 v176, v152, v153
  v_exp_f32 v156, v156
  v_exp_f32 v157, v157
  v_mfma_f32_32x32x16_bf16 v[216:231], v[108:111], v[172:175], v[216:231]
  v_cvt_pk_bf16_f32 v177, v154, v155
  v_exp_f32 v158, v158
  v_exp_f32 v159, v159
  v_cvt_pk_bf16_f32 v178, v156, v157
  v_exp_f32 v160, v160
  v_exp_f32 v161, v161
  v_cvt_pk_bf16_f32 v179, v158, v159
  v_exp_f32 v162, v162
  v_exp_f32 v163, v163
  v_cvt_pk_bf16_f32 v180, v160, v161
  v_exp_f32 v164, v164
  v_exp_f32 v165, v165
  v_cvt_pk_bf16_f32 v181, v162, v163
  v_exp_f32 v166, v166
  v_exp_f32 v167, v167
  v_cvt_pk_bf16_f32 v182, v164, v165
  v_cvt_pk_bf16_f32 v183, v166, v167
  v_mfma_f32_32x32x16_bf16 v[232:247], v[104:107], v[176:179], v[232:247]
  v_exp_f32 v136, v136
  v_exp_f32 v137, v137
  v_exp_f32 v138, v138
  v_mfma_f32_32x32x16_bf16 v[152:167], v[76:79], v[28:31], 0
  v_exp_f32 v139, v139
  v_cvt_pk_bf16_f32 v168, v136, v137
  v_exp_f32 v140, v140
  v_exp_f32 v141, v141
  v_mfma_f32_32x32x16_bf16 v[232:247], v[108:111], v[180:183], v[232:247]
  v_cvt_pk_bf16_f32 v169, v138, v139
  v_exp_f32 v142, v142
  v_exp_f32 v143, v143
  v_cvt_pk_bf16_f32 v170, v140, v141
  v_exp_f32 v144, v144
  v_exp_f32 v145, v145
  v_cvt_pk_bf16_f32 v171, v142, v143
  v_exp_f32 v146, v146
  v_exp_f32 v147, v147
  v_cvt_pk_bf16_f32 v172, v144, v145
  v_exp_f32 v148, v148
  v_exp_f32 v149, v149
  v_cvt_pk_bf16_f32 v173, v146, v147
  v_exp_f32 v150, v150
  v_exp_f32 v151, v151
  v_cvt_pk_bf16_f32 v174, v148, v149
  v_cvt_pk_bf16_f32 v175, v150, v151
  s_waitcnt vmcnt(4)
  v_mfma_f32_32x32x16_bf16 v[184:199], v[112:115], v[168:171], v[184:199]
  s_add_u32 s71, s67, 65536
  s_mov_b64 exec, s[68:69]
  buffer_load_dwordx4 v[104:107], v1, s[32:35], s71 offen offset:0
  buffer_load_dwordx4 v[108:111], v1, s[32:35], s71 offen offset:1024
  s_mov_b64 exec, -1
  v_exp_f32 v152, v152
  v_exp_f32 v153, v153
  v_exp_f32 v154, v154
  v_mfma_f32_32x32x16_bf16 v[136:151], v[76:79], v[32:35], 0
  v_exp_f32 v155, v155
  v_cvt_pk_bf16_f32 v176, v152, v153
  v_exp_f32 v156, v156
  v_exp_f32 v157, v157
  v_mfma_f32_32x32x16_bf16 v[184:199], v[116:119], v[172:175], v[184:199]
  v_cvt_pk_bf16_f32 v177, v154, v155
  v_exp_f32 v158, v158
  v_exp_f32 v159, v159
  v_cvt_pk_bf16_f32 v178, v156, v157
  v_exp_f32 v160, v160
  v_exp_f32 v161, v161
  v_cvt_pk_bf16_f32 v179, v158, v159
  v_exp_f32 v162, v162
  v_exp_f32 v163, v163
  v_cvt_pk_bf16_f32 v180, v160, v161
  v_exp_f32 v164, v164
  v_exp_f32 v165, v165
  v_cvt_pk_bf16_f32 v181, v162, v163
  v_exp_f32 v166, v166
  v_exp_f32 v167, v167
  v_cvt_pk_bf16_f32 v182, v164, v165
  v_cvt_pk_bf16_f32 v183, v166, v167
  v_mfma_f32_32x32x16_bf16 v[200:215], v[112:115], v[176:179], v[200:215]
  v_exp_f32 v136, v136
  v_exp_f32 v137, v137
  v_exp_f32 v138, v138
  v_mfma_f32_32x32x16_bf16 v[152:167], v[76:79], v[36:39], 0
  v_exp_f32 v139, v139
  v_cvt_pk_bf16_f32 v168, v136, v137
  v_exp_f32 v140, v140
  v_exp_f32 v141, v141
  v_mfma_f32_32x32x16_bf16 v[200:215], v[116:119], v[180:183], v[200:215]
  v_cvt_pk_bf16_f32 v169, v138, v139
  v_exp_f32 v142, v142
  v_exp_f32 v143, v143
  v_cvt_pk_bf16_f32 v170, v140, v141
  v_exp_f32 v144, v144
  v_exp_f32 v145, v145
  v_cvt_pk_bf16_f32 v171, v142, v143
  v_exp_f32 v146, v146
  v_exp_f32 v147, v147
  v_cvt_pk_bf16_f32 v172, v144, v145
  v_exp_f32 v148, v148
  v_exp_f32 v149, v149
  v_cvt_pk_bf16_f32 v173, v146, v147
  v_exp_f32 v150, v150
  v_exp_f32 v151, v151
  v_cvt_pk_bf16_f32 v174, v148, v149
  v_cvt_pk_bf16_f32 v175, v150, v151
  v_mfma_f32_32x32x16_bf16 v[216:231], v[112:115], v[168:171], v[216:231]
  v_exp_f32 v152, v152
  v_exp_f32 v153, v153
  v_exp_f32 v154, v154
  v_mfma_f32_32x32x16_bf16 v[136:151], v[80:83], v[24:27], 0
  v_exp_f32 v155, v155
  v_cvt_pk_bf16_f32 v176, v152, v153
  v_exp_f32 v156, v156
  v_exp_f32 v157, v157
  v_mfma_f32_32x32x16_bf16 v[216:231], v[116:119], v[172:175], v[216:231]
  v_cvt_pk_bf16_f32 v177, v154, v155
  v_exp_f32 v158, v158
  v_exp_f32 v159, v159
  v_cvt_pk_bf16_f32 v178, v156, v157
  v_exp_f32 v160, v160
  v_exp_f32 v161, v161
  v_cvt_pk_bf16_f32 v179, v158, v159
  v_exp_f32 v162, v162
  v_exp_f32 v163, v163
  v_cvt_pk_bf16_f32 v180, v160, v161
  v_exp_f32 v164, v164
  v_exp_f32 v165, v165
  v_cvt_pk_bf16_f32 v181, v162, v163
  v_exp_f32 v166, v166
  v_exp_f32 v167, v167
  v_cvt_pk_bf16_f32 v182, v164, v165
  v_cvt_pk_bf16_f32 v183, v166, v167
  v_mfma_f32_32x32x16_bf16 v[232:247], v[112:115], v[176:179], v[232:247]
  v_exp_f32 v136, v136
  v_exp_f32 v137, v137
  v_exp_f32 v138, v138
  v_mfma_f32_32x32x16_bf16 v[152:167], v[80:83], v[28:31], 0
  v_exp_f32 v139, v139
  v_cvt_pk_bf16_f32 v168, v136, v137
  v_exp_f32 v140, v140
  v_exp_f32 v141, v141
  v_mfma_f32_32x32x16_bf16 v[232:247], v[116:119], v[180:183], v[232:247]
  v_cvt_pk_bf16_f32 v169, v138, v139
  v_exp_f32 v142, v142
  v_exp_f32 v143, v143
  v_cvt_pk_bf16_f32 v170, v140, v141
  v_exp_f32 v144, v144
  v_exp_f32 v145, v145
  v_cvt_pk_bf16_f32 v171, v142, v143
  v_exp_f32 v146, v146
  v_exp_f32 v147, v147
  v_cvt_pk_bf16_f32 v172, v144, v145
  v_exp_f32 v148, v148
  v_exp_f32 v149, v149
  v_cvt_pk_bf16_f32 v173, v146, v147
  v_exp_f32 v150, v150
  v_exp_f32 v151, v151
  v_cvt_pk_bf16_f32 v174, v148, v149
  v_cvt_pk_bf16_f32 v175, v150, v151
  s_waitcnt vmcnt(4)
  v_mfma_f32_32x32x16_bf16 v[184:199], v[120:123], v[168:171], v[184:199]
  s_mov_b64 exec, s[68:69]
  buffer_load_dwordx4 v[112:115], v1, s[32:35], s71 offen offset:2048
  buffer_load_dwordx4 v[116:119], v1, s[32:35], s71 offen offset:3072
  s_mov_b64 exec, -1
  v_exp_f32 v152, v152
  v_exp_f32 v153, v153
  v_exp_f32 v154, v154
  v_mfma_f32_32x32x16_bf16 v[136:151], v[80:83], v[32:35], 0
  v_exp_f32 v155, v155
  v_cvt_pk_bf16_f32 v176, v152, v153
  v_exp_f32 v156, v156
  v_exp_f32 v157, v157
  v_mfma_f32_32x32x16_bf16 v[184:199], v[124:127], v[172:175], v[184:199]
  v_cvt_pk_bf16_f32 v177, v154, v155
  v_exp_f32 v158, v158
  v_exp_f32 v159, v159
  v_cvt_pk_bf16_f32 v178, v156, v157
  v_exp_f32 v160, v160
  v_exp_f32 v161, v161
  v_cvt_pk_bf16_f32 v179, v158, v159
  v_exp_f32 v162, v162
  v_exp_f32 v163, v163
  v_cvt_pk_bf16_f32 v180, v160, v161
  v_exp_f32 v164, v164
  v_exp_f32 v165, v165
  v_cvt_pk_bf16_f32 v181, v162, v163
  v_exp_f32 v166, v166
  v_exp_f32 v167, v167
  v_cvt_pk_bf16_f32 v182, v164, v165
  v_cvt_pk_bf16_f32 v183, v166, v167
  v_mfma_f32_32x32x16_bf16 v[200:215], v[120:123], v[176:179], v[200:215]
  v_exp_f32 v136, v136
  v_exp_f32 v137, v137
  v_exp_f32 v138, v138
  v_mfma_f32_32x32x16_bf16 v[152:167], v[80:83], v[36:39], 0
  v_exp_f32 v139, v139
  v_cvt_pk_bf16_f32 v168, v136, v137
  v_exp_f32 v140, v140
  v_exp_f32 v141, v141
  v_mfma_f32_32x32x16_bf16 v[200:215], v[124:127], v[180:183], v[200:215]
  v_cvt_pk_bf16_f32 v169, v138, v139
  v_exp_f32 v142, v142
  v_exp_f32 v143, v143
  v_cvt_pk_bf16_f32 v170, v140, v141
  v_exp_f32 v144, v144
  v_exp_f32 v145, v145
  v_cvt_pk_bf16_f32 v171, v142, v143
  v_exp_f32 v146, v146
  v_exp_f32 v147, v147
  v_cvt_pk_bf16_f32 v172, v144, v145
  v_exp_f32 v148, v148
  v_exp_f32 v149, v149
  v_cvt_pk_bf16_f32 v173, v146, v147
  v_exp_f32 v150, v150
  v_exp_f32 v151, v151
  v_cvt_pk_bf16_f32 v174, v148, v149
  v_cvt_pk_bf16_f32 v175, v150, v151
  v_mfma_f32_32x32x16_bf16 v[216:231], v[120:123], v[168:171], v[216:231]
  v_exp_f32 v152, v152
  v_exp_f32 v153, v153
  v_exp_f32 v154, v154
  v_mfma_f32_32x32x16_bf16 v[136:151], v[84:87], v[24:27], 0
  v_exp_f32 v155, v155
  v_cvt_pk_bf16_f32 v176, v152, v153
  v_exp_f32 v156, v156
  v_exp_f32 v157, v157
  v_mfma_f32_32x32x16_bf16 v[216:231], v[124:127], v[172:175], v[216:231]
  v_cvt_pk_bf16_f32 v177, v154, v155
  v_exp_f32 v158, v158
  v_exp_f32 v159, v159
  v_cvt_pk_bf16_f32 v178, v156, v157
  v_exp_f32 v160, v160
  v_exp_f32 v161, v161
  v_cvt_pk_bf16_f32 v179, v158, v159
  v_exp_f32 v162, v162
  v_exp_f32 v163, v163
  v_cvt_pk_bf16_f32 v180, v160, v161
  v_exp_f32 v164, v164
  v_exp_f32 v165, v165
  v_cvt_pk_bf16_f32 v181, v162, v163
  v_exp_f32 v166, v166
  v_exp_f32 v167, v167
  v_cvt_pk_bf16_f32 v182, v164, v165
  v_cvt_pk_bf16_f32 v183, v166, v167
  v_mfma_f32_32x32x16_bf16 v[232:247], v[120:123], v[176:179], v[232:247]
  v_exp_f32 v136, v136
  v_exp_f32 v137, v137
  v_exp_f32 v138, v138
  v_mfma_f32_32x32x16_bf16 v[152:167], v[84:87], v[28:31], 0
  v_exp_f32 v139, v139
  v_cvt_pk_bf16_f32 v168, v136, v137
  v_exp_f32 v140, v140
  v_exp_f32 v141, v141
  v_mfma_f32_32x32x16_bf16 v[232:247], v[124:127], v[180:183], v[232:247]
  v_cvt_pk_bf16_f32 v169, v138, v139
  v_exp_f32 v142, v142
  v_exp_f32 v143, v143
  v_cvt_pk_bf16_f32 v170, v140, v141
  v_exp_f32 v144, v144
  v_exp_f32 v145, v145
  v_cvt_pk_bf16_f32 v171, v142, v143
  v_exp_f32 v146, v146
  v_exp_f32 v147, v147
  v_cvt_pk_bf16_f32 v172, v144, v145
  v_exp_f32 v148, v148
  v_exp_f32 v149, v149
  v_cvt_pk_bf16_f32 v173, v146, v147
  v_exp_f32 v150, v150
  v_exp_f32 v151, v151
  v_cvt_pk_bf16_f32 v174, v148, v149
  v_cvt_pk_bf16_f32 v175, v150, v151
  s_waitcnt vmcnt(4)
  v_mfma_f32_32x32x16_bf16 v[184:199], v[128:131], v[168:171], v[184:199]
  s_add_u32 s71, s67, 69632
  s_mov_b64 exec, s[68:69]
  buffer_load_dwordx4 v[120:123], v1, s[32:35], s71 offen offset:0
  buffer_load_dwordx4 v[124:127], v1, s[32:35], s71 offen offset:1024
  s_mov_b64 exec, -1
  v_exp_f32 v152, v152
  v_exp_f32 v153, v153
  v_exp_f32 v154, v154
  v_mfma_f32_32x32x16_bf16 v[136:151], v[84:87], v[32:35], 0
  v_exp_f32 v155, v155
  v_cvt_pk_bf16_f32 v176, v152, v153
  v_exp_f32 v156, v156
  v_exp_f32 v157, v157
  v_mfma_f32_32x32x16_bf16 v[184:199], v[132:135], v[172:175], v[184:199]
  v_cvt_pk_bf16_f32 v177, v154, v155
  v_exp_f32 v158, v158
  v_exp_f32 v159, v159
  v_cvt_pk_bf16_f32 v178, v156, v157
  v_exp_f32 v160, v160
  v_exp_f32 v161, v161
  v_cvt_pk_bf16_f32 v179, v158, v159
  v_exp_f32 v162, v162
  v_exp_f32 v163, v163
  v_cvt_pk_bf16_f32 v180, v160, v161
  v_exp_f32 v164, v164
  v_exp_f32 v165, v165
  v_cvt_pk_bf16_f32 v181, v162, v163
  v_exp_f32 v166, v166
  v_exp_f32 v167, v167
  v_cvt_pk_bf16_f32 v182, v164, v165
  v_cvt_pk_bf16_f32 v183, v166, v167
  v_mfma_f32_32x32x16_bf16 v[200:215], v[128:131], v[176:179], v[200:215]
  v_exp_f32 v136, v136
  v_exp_f32 v137, v137
  v_exp_f32 v138, v138
  v_mfma_f32_32x32x16_bf16 v[152:167], v[84:87], v[36:39], 0
  v_exp_f32 v139, v139
  v_cvt_pk_bf16_f32 v168, v136, v137
  v_exp_f32 v140, v140
  v_exp_f32 v141, v141
  v_mfma_f32_32x32x16_bf16 v[200:215], v[132:135], v[180:183], v[200:215]
  v_cvt_pk_bf16_f32 v169, v138, v139
  v_exp_f32 v142, v142
  v_exp_f32 v143, v143
  v_cvt_pk_bf16_f32 v170, v140, v141
  v_exp_f32 v144, v144
  v_exp_f32 v145, v145
  v_cvt_pk_bf16_f32 v171, v142, v143
  v_exp_f32 v146, v146
  v_exp_f32 v147, v147
  v_cvt_pk_bf16_f32 v172, v144, v145
  v_exp_f32 v148, v148
  v_exp_f32 v149, v149
  v_cvt_pk_bf16_f32 v173, v146, v147
  v_exp_f32 v150, v150
  v_exp_f32 v151, v151
  v_cvt_pk_bf16_f32 v174, v148, v149
  v_cvt_pk_bf16_f32 v175, v150, v151
  v_mfma_f32_32x32x16_bf16 v[216:231], v[128:131], v[168:171], v[216:231]
  v_exp_f32 v152, v152
  v_exp_f32 v153, v153
  v_exp_f32 v154, v154
  v_mfma_f32_32x32x16_bf16 v[136:151], v[88:91], v[24:27], 0
  v_exp_f32 v155, v155
  v_cvt_pk_bf16_f32 v176, v152, v153
  v_exp_f32 v156, v156
  v_exp_f32 v157, v157
  v_mfma_f32_32x32x16_bf16 v[216:231], v[132:135], v[172:175], v[216:231]
  v_cvt_pk_bf16_f32 v177, v154, v155
  v_exp_f32 v158, v158
  v_exp_f32 v159, v159
  v_cvt_pk_bf16_f32 v178, v156, v157
  v_exp_f32 v160, v160
  v_exp_f32 v161, v161
  v_cvt_pk_bf16_f32 v179, v158, v159
  v_exp_f32 v162, v162
  v_exp_f32 v163, v163
  v_cvt_pk_bf16_f32 v180, v160, v161
  v_exp_f32 v164, v164
  v_exp_f32 v165, v165
  v_cvt_pk_bf16_f32 v181, v162, v163
  v_exp_f32 v166, v166
  v_exp_f32 v167, v167
  v_cvt_pk_bf16_f32 v182, v164, v165
  v_cvt_pk_bf16_f32 v183, v166, v167
  v_mfma_f32_32x32x16_bf16 v[232:247], v[128:131], v[176:179], v[232:247]
  v_exp_f32 v136, v136
  v_exp_f32 v137, v137
  v_exp_f32 v138, v138
  v_mfma_f32_32x32x16_bf16 v[152:167], v[88:91], v[28:31], 0
  v_exp_f32 v139, v139
  v_cvt_pk_bf16_f32 v168, v136, v137
  v_exp_f32 v140, v140
  v_exp_f32 v141, v141
  v_mfma_f32_32x32x16_bf16 v[232:247], v[132:135], v[180:183], v[232:247]
  v_cvt_pk_bf16_f32 v169, v138, v139
  v_exp_f32 v142, v142
  v_exp_f32 v143, v143
  v_cvt_pk_bf16_f32 v170, v140, v141
  v_exp_f32 v144, v144
  v_exp_f32 v145, v145
  v_cvt_pk_bf16_f32 v171, v142, v143
  v_exp_f32 v146, v146
  v_exp_f32 v147, v147
  v_cvt_pk_bf16_f32 v172, v144, v145
  v_exp_f32 v148, v148
  v_exp_f32 v149, v149
  v_cvt_pk_bf16_f32 v173, v146, v147
  v_exp_f32 v150, v150
  v_exp_f32 v151, v151
  v_cvt_pk_bf16_f32 v174, v148, v149
  v_cvt_pk_bf16_f32 v175, v150, v151
  s_waitcnt vmcnt(4)
  v_mfma_f32_32x32x16_bf16 v[184:199], v[104:107], v[168:171], v[184:199]
  s_mov_b64 exec, s[68:69]
  buffer_load_dwordx4 v[128:131], v1, s[32:35], s71 offen offset:2048
  buffer_load_dwordx4 v[132:135], v1, s[32:35], s71 offen offset:3072
  s_mov_b64 exec, -1
  v_exp_f32 v152, v152
  v_exp_f32 v153, v153
  v_exp_f32 v154, v154
  v_mfma_f32_32x32x16_bf16 v[136:151], v[88:91], v[32:35], 0
  v_exp_f32 v155, v155
  v_cvt_pk_bf16_f32 v176, v152, v153
  v_exp_f32 v156, v156
  v_exp_f32 v157, v157
  v_mfma_f32_32x32x16_bf16 v[184:199], v[108:111], v[172:175], v[184:199]
  v_cvt_pk_bf16_f32 v177, v154, v155
  v_exp_f32 v158, v158
  v_exp_f32 v159, v159
  v_cvt_pk_bf16_f32 v178, v156, v157
  v_exp_f32 v160, v160
  v_exp_f32 v161, v161
  v_cvt_pk_bf16_f32 v179, v158, v159
  v_exp_f32 v162, v162
  v_exp_f32 v163, v163
  v_cvt_pk_bf16_f32 v180, v160, v161
  v_exp_f32 v164, v164
  v_exp_f32 v165, v165
  v_cvt_pk_bf16_f32 v181, v162, v163
  v_exp_f32 v166, v166
  v_exp_f32 v167, v167
  v_cvt_pk_bf16_f32 v182, v164, v165
  v_cvt_pk_bf16_f32 v183, v166, v167
  v_mfma_f32_32x32x16_bf16 v[200:215], v[104:107], v[176:179], v[200:215]
  v_exp_f32 v136, v136
  v_exp_f32 v137, v137
  v_exp_f32 v138, v138
  v_mfma_f32_32x32x16_bf16 v[152:167], v[88:91], v[36:39], 0
  v_exp_f32 v139, v139
  v_cvt_pk_bf16_f32 v168, v136, v137
  v_exp_f32 v140, v140
  v_exp_f32 v141, v141
  v_mfma_f32_32x32x16_bf16 v[200:215], v[108:111], v[180:183], v[200:215]
  v_cvt_pk_bf16_f32 v169, v138, v139
  v_exp_f32 v142, v142
  v_exp_f32 v143, v143
  v_cvt_pk_bf16_f32 v170, v140, v141
  v_exp_f32 v144, v144
  v_exp_f32 v145, v145
  v_cvt_pk_bf16_f32 v171, v142, v143
  v_exp_f32 v146, v146
  v_exp_f32 v147, v147
  v_cvt_pk_bf16_f32 v172, v144, v145
  v_exp_f32 v148, v148
  v_exp_f32 v149, v149
  v_cvt_pk_bf16_f32 v173, v146, v147
  v_exp_f32 v150, v150
  v_exp_f32 v151, v151
  v_cvt_pk_bf16_f32 v174, v148, v149
  v_cvt_pk_bf16_f32 v175, v150, v151
  v_mfma_f32_32x32x16_bf16 v[216:231], v[104:107], v[168:171], v[216:231]
  v_exp_f32 v152, v152
  v_exp_f32 v153, v153
  v_exp_f32 v154, v154
  v_mfma_f32_32x32x16_bf16 v[136:151], v[92:95], v[24:27], 0
  v_exp_f32 v155, v155
  v_cvt_pk_bf16_f32 v176, v152, v153
  v_exp_f32 v156, v156
  v_exp_f32 v157, v157
  v_mfma_f32_32x32x16_bf16 v[216:231], v[108:111], v[172:175], v[216:231]
  v_cvt_pk_bf16_f32 v177, v154, v155
  v_exp_f32 v158, v158
  v_exp_f32 v159, v159
  v_cvt_pk_bf16_f32 v178, v156, v157
  v_exp_f32 v160, v160
  v_exp_f32 v161, v161
  v_cvt_pk_bf16_f32 v179, v158, v159
  v_exp_f32 v162, v162
  v_exp_f32 v163, v163
  v_cvt_pk_bf16_f32 v180, v160, v161
  v_exp_f32 v164, v164
  v_exp_f32 v165, v165
  v_cvt_pk_bf16_f32 v181, v162, v163
  v_exp_f32 v166, v166
  v_exp_f32 v167, v167
  v_cvt_pk_bf16_f32 v182, v164, v165
  v_cvt_pk_bf16_f32 v183, v166, v167
  v_mfma_f32_32x32x16_bf16 v[232:247], v[104:107], v[176:179], v[232:247]
  v_exp_f32 v136, v136
  v_exp_f32 v137, v137
  v_exp_f32 v138, v138
  v_mfma_f32_32x32x16_bf16 v[152:167], v[92:95], v[28:31], 0
  v_exp_f32 v139, v139
  v_cvt_pk_bf16_f32 v168, v136, v137
  v_exp_f32 v140, v140
  v_exp_f32 v141, v141
  v_mfma_f32_32x32x16_bf16 v[232:247], v[108:111], v[180:183], v[232:247]
  v_cvt_pk_bf16_f32 v169, v138, v139
  v_exp_f32 v142, v142
  v_exp_f32 v143, v143
  v_cvt_pk_bf16_f32 v170, v140, v141
  v_exp_f32 v144, v144
  v_exp_f32 v145, v145
  v_cvt_pk_bf16_f32 v171, v142, v143
  v_exp_f32 v146, v146
  v_exp_f32 v147, v147
  v_cvt_pk_bf16_f32 v172, v144, v145
  v_exp_f32 v148, v148
  v_exp_f32 v149, v149
  v_cvt_pk_bf16_f32 v173, v146, v147
  v_exp_f32 v150, v150
  v_exp_f32 v151, v151
  v_cvt_pk_bf16_f32 v174, v148, v149
  v_cvt_pk_bf16_f32 v175, v150, v151
  s_waitcnt vmcnt(4)
  v_mfma_f32_32x32x16_bf16 v[184:199], v[112:115], v[168:171], v[184:199]
  v_exp_f32 v152, v152
  v_exp_f32 v153, v153
  v_exp_f32 v154, v154
  v_mfma_f32_32x32x16_bf16 v[136:151], v[92:95], v[32:35], 0
  v_exp_f32 v155, v155
  v_cvt_pk_bf16_f32 v176, v152, v153
  v_exp_f32 v156, v156
  v_exp_f32 v157, v157
  v_mfma_f32_32x32x16_bf16 v[184:199], v[116:119], v[172:175], v[184:199]
  v_cvt_pk_bf16_f32 v177, v154, v155
  v_exp_f32 v158, v158
  v_exp_f32 v159, v159
  v_cvt_pk_bf16_f32 v178, v156, v157
  v_exp_f32 v160, v160
  v_exp_f32 v161, v161
  v_cvt_pk_bf16_f32 v179, v158, v159
  v_exp_f32 v162, v162
  v_exp_f32 v163, v163
  v_cvt_pk_bf16_f32 v180, v160, v161
  v_exp_f32 v164, v164
  v_exp_f32 v165, v165
  v_cvt_pk_bf16_f32 v181, v162, v163
  v_exp_f32 v166, v166
  v_exp_f32 v167, v167
  v_cvt_pk_bf16_f32 v182, v164, v165
  v_cvt_pk_bf16_f32 v183, v166, v167
  v_mfma_f32_32x32x16_bf16 v[200:215], v[112:115], v[176:179], v[200:215]
  v_exp_f32 v136, v136
  v_exp_f32 v137, v137
  v_exp_f32 v138, v138
  v_mfma_f32_32x32x16_bf16 v[152:167], v[92:95], v[36:39], 0
  v_exp_f32 v139, v139
  v_cvt_pk_bf16_f32 v168, v136, v137
  v_exp_f32 v140, v140
  v_exp_f32 v141, v141
  v_mfma_f32_32x32x16_bf16 v[200:215], v[116:119], v[180:183], v[200:215]
  v_cvt_pk_bf16_f32 v169, v138, v139
  v_exp_f32 v142, v142
  v_exp_f32 v143, v143
  v_cvt_pk_bf16_f32 v170, v140, v141
  v_exp_f32 v144, v144
  v_exp_f32 v145, v145
  v_cvt_pk_bf16_f32 v171, v142, v143
  v_exp_f32 v146, v146
  v_exp_f32 v147, v147
  v_cvt_pk_bf16_f32 v172, v144, v145
  v_exp_f32 v148, v148
  v_exp_f32 v149, v149
  v_cvt_pk_bf16_f32 v173, v146, v147
  v_exp_f32 v150, v150
  v_exp_f32 v151, v151
  v_cvt_pk_bf16_f32 v174, v148, v149
  v_cvt_pk_bf16_f32 v175, v150, v151
  v_mfma_f32_32x32x16_bf16 v[216:231], v[112:115], v[168:171], v[216:231]
  v_exp_f32 v152, v152
  v_exp_f32 v153, v153
  v_exp_f32 v154, v154
  v_mfma_f32_32x32x16_bf16 v[136:151], v[96:99], v[24:27], 0
  v_exp_f32 v155, v155
  v_cvt_pk_bf16_f32 v176, v152, v153
  v_exp_f32 v156, v156
  v_exp_f32 v157, v157
  v_mfma_f32_32x32x16_bf16 v[216:231], v[116:119], v[172:175], v[216:231]
  v_cvt_pk_bf16_f32 v177, v154, v155
  v_exp_f32 v158, v158
  v_exp_f32 v159, v159
  v_cvt_pk_bf16_f32 v178, v156, v157
  v_exp_f32 v160, v160
  v_exp_f32 v161, v161
  v_cvt_pk_bf16_f32 v179, v158, v159
  v_exp_f32 v162, v162
  v_exp_f32 v163, v163
  v_cvt_pk_bf16_f32 v180, v160, v161
  v_exp_f32 v164, v164
  v_exp_f32 v165, v165
  v_cvt_pk_bf16_f32 v181, v162, v163
  v_exp_f32 v166, v166
  v_exp_f32 v167, v167
  v_cvt_pk_bf16_f32 v182, v164, v165
  v_cvt_pk_bf16_f32 v183, v166, v167
  v_mfma_f32_32x32x16_bf16 v[232:247], v[112:115], v[176:179], v[232:247]
  v_exp_f32 v136, v136
  v_exp_f32 v137, v137
  v_exp_f32 v138, v138
  v_mfma_f32_32x32x16_bf16 v[152:167], v[96:99], v[28:31], 0
  v_exp_f32 v139, v139
  v_cvt_pk_bf16_f32 v168, v136, v137
  v_exp_f32 v140, v140
  v_exp_f32 v141, v141
  v_mfma_f32_32x32x16_bf16 v[232:247], v[116:119], v[180:183], v[232:247]
  v_cvt_pk_bf16_f32 v169, v138, v139
  v_exp_f32 v142, v142
  v_exp_f32 v143, v143
  v_cvt_pk_bf16_f32 v170, v140, v141
  v_exp_f32 v144, v144
  v_exp_f32 v145, v145
  v_cvt_pk_bf16_f32 v171, v142, v143
  v_exp_f32 v146, v146
  v_exp_f32 v147, v147
  v_cvt_pk_bf16_f32 v172, v144, v145
  v_exp_f32 v148, v148
  v_exp_f32 v149, v149
  v_cvt_pk_bf16_f32 v173, v146, v147
  v_exp_f32 v150, v150
  v_exp_f32 v151, v151
  v_cvt_pk_bf16_f32 v174, v148, v149
  v_cvt_pk_bf16_f32 v175, v150, v151
  s_waitcnt vmcnt(2)
  v_mfma_f32_32x32x16_bf16 v[184:199], v[120:123], v[168:171], v[184:199]
  v_exp_f32 v152, v152
  v_exp_f32 v153, v153
  v_exp_f32 v154, v154
  v_mfma_f32_32x32x16_bf16 v[136:151], v[96:99], v[32:35], 0
  v_exp_f32 v155, v155
  v_cvt_pk_bf16_f32 v176, v152, v153
  v_exp_f32 v156, v156
  v_exp_f32 v157, v157
  v_mfma_f32_32x32x16_bf16 v[184:199], v[124:127], v[172:175], v[184:199]
  v_cvt_pk_bf16_f32 v177, v154, v155
  v_exp_f32 v158, v158
  v_exp_f32 v159, v159
  v_cvt_pk_bf16_f32 v178, v156, v157
  v_exp_f32 v160, v160
  v_exp_f32 v161, v161
  v_cvt_pk_bf16_f32 v179, v158, v159
  v_exp_f32 v162, v162
  v_exp_f32 v163, v163
  v_cvt_pk_bf16_f32 v180, v160, v161
  v_exp_f32 v164, v164
  v_exp_f32 v165, v165
  v_cvt_pk_bf16_f32 v181, v162, v163
  v_exp_f32 v166, v166
  v_exp_f32 v167, v167
  v_cvt_pk_bf16_f32 v182, v164, v165
  v_cvt_pk_bf16_f32 v183, v166, v167
  v_mfma_f32_32x32x16_bf16 v[200:215], v[120:123], v[176:179], v[200:215]
  v_exp_f32 v136, v136
  v_exp_f32 v137, v137
  v_exp_f32 v138, v138
  v_mfma_f32_32x32x16_bf16 v[152:167], v[96:99], v[36:39], 0
  v_exp_f32 v139, v139
  v_cvt_pk_bf16_f32 v168, v136, v137
  v_exp_f32 v140, v140
  v_exp_f32 v141, v141
  v_mfma_f32_32x32x16_bf16 v[200:215], v[124:127], v[180:183], v[200:215]
  v_cvt_pk_bf16_f32 v169, v138, v139
  v_exp_f32 v142, v142
  v_exp_f32 v143, v143
  v_cvt_pk_bf16_f32 v170, v140, v141
  v_exp_f32 v144, v144
  v_exp_f32 v145, v145
  v_cvt_pk_bf16_f32 v171, v142, v143
  v_exp_f32 v146, v146
  v_exp_f32 v147, v147
  v_cvt_pk_bf16_f32 v172, v144, v145
  v_exp_f32 v148, v148
  v_exp_f32 v149, v149
  v_cvt_pk_bf16_f32 v173, v146, v147
  v_exp_f32 v150, v150
  v_exp_f32 v151, v151
  v_cvt_pk_bf16_f32 v174, v148, v149
  v_cvt_pk_bf16_f32 v175, v150, v151
  v_mfma_f32_32x32x16_bf16 v[216:231], v[120:123], v[168:171], v[216:231]
  v_exp_f32 v152, v152
  v_exp_f32 v153, v153
  v_exp_f32 v154, v154
  v_mfma_f32_32x32x16_bf16 v[136:151], v[100:103], v[24:27], 0
  v_exp_f32 v155, v155
  v_cvt_pk_bf16_f32 v176, v152, v153
  v_exp_f32 v156, v156
  v_exp_f32 v157, v157
  v_mfma_f32_32x32x16_bf16 v[216:231], v[124:127], v[172:175], v[216:231]
  v_cvt_pk_bf16_f32 v177, v154, v155
  v_exp_f32 v158, v158
  v_exp_f32 v159, v159
  v_cvt_pk_bf16_f32 v178, v156, v157
  v_exp_f32 v160, v160
  v_exp_f32 v161, v161
  v_cvt_pk_bf16_f32 v179, v158, v159
  v_exp_f32 v162, v162
  v_exp_f32 v163, v163
  v_cvt_pk_bf16_f32 v180, v160, v161
  v_exp_f32 v164, v164
  v_exp_f32 v165, v165
  v_cvt_pk_bf16_f32 v181, v162, v163
  v_exp_f32 v166, v166
  v_exp_f32 v167, v167
  v_cvt_pk_bf16_f32 v182, v164, v165
  v_cvt_pk_bf16_f32 v183, v166, v167
  v_mfma_f32_32x32x16_bf16 v[232:247], v[120:123], v[176:179], v[232:247]
  v_exp_f32 v136, v136
  v_exp_f32 v137, v137
  v_exp_f32 v138, v138
  v_mfma_f32_32x32x16_bf16 v[152:167], v[100:103], v[28:31], 0
  v_exp_f32 v139, v139
  v_cvt_pk_bf16_f32 v168, v136, v137
  v_exp_f32 v140, v140
  v_exp_f32 v141, v141
  v_mfma_f32_32x32x16_bf16 v[232:247], v[124:127], v[180:183], v[232:247]
  v_cvt_pk_bf16_f32 v169, v138, v139
  v_exp_f32 v142, v142
  v_exp_f32 v143, v143
  v_cvt_pk_bf16_f32 v170, v140, v141
  v_exp_f32 v144, v144
  v_exp_f32 v145, v145
  v_cvt_pk_bf16_f32 v171, v142, v143
  v_exp_f32 v146, v146
  v_exp_f32 v147, v147
  v_cvt_pk_bf16_f32 v172, v144, v145
  v_exp_f32 v148, v148
  v_exp_f32 v149, v149
  v_cvt_pk_bf16_f32 v173, v146, v147
  v_exp_f32 v150, v150
  v_exp_f32 v151, v151
  v_cvt_pk_bf16_f32 v174, v148, v149
  v_cvt_pk_bf16_f32 v175, v150, v151
  s_waitcnt vmcnt(0)
  v_mfma_f32_32x32x16_bf16 v[184:199], v[128:131], v[168:171], v[184:199]
  v_exp_f32 v152, v152
  v_exp_f32 v153, v153
  v_exp_f32 v154, v154
  v_mfma_f32_32x32x16_bf16 v[136:151], v[100:103], v[32:35], 0
  v_exp_f32 v155, v155
  v_cvt_pk_bf16_f32 v176, v152, v153
  v_exp_f32 v156, v156
  v_exp_f32 v157, v157
  v_mfma_f32_32x32x16_bf16 v[184:199], v[132:135], v[172:175], v[184:199]
  v_cvt_pk_bf16_f32 v177, v154, v155
  v_exp_f32 v158, v158
  v_exp_f32 v159, v159
  v_cvt_pk_bf16_f32 v178, v156, v157
  v_exp_f32 v160, v160
  v_exp_f32 v161, v161
  v_cvt_pk_bf16_f32 v179, v158, v159
  v_exp_f32 v162, v162
  v_exp_f32 v163, v163
  v_cvt_pk_bf16_f32 v180, v160, v161
  v_exp_f32 v164, v164
  v_exp_f32 v165, v165
  v_cvt_pk_bf16_f32 v181, v162, v163
  v_exp_f32 v166, v166
  v_exp_f32 v167, v167
  v_cvt_pk_bf16_f32 v182, v164, v165
  v_cvt_pk_bf16_f32 v183, v166, v167
  v_mfma_f32_32x32x16_bf16 v[200:215], v[128:131], v[176:179], v[200:215]
  v_exp_f32 v136, v136
  v_exp_f32 v137, v137
  v_exp_f32 v138, v138
  v_mfma_f32_32x32x16_bf16 v[152:167], v[100:103], v[36:39], 0
  v_exp_f32 v139, v139
  v_cvt_pk_bf16_f32 v168, v136, v137
  v_exp_f32 v140, v140
  v_exp_f32 v141, v141
  v_mfma_f32_32x32x16_bf16 v[200:215], v[132:135], v[180:183], v[200:215]
  v_cvt_pk_bf16_f32 v169, v138, v139
  v_exp_f32 v142, v142
  v_exp_f32 v143, v143
  v_cvt_pk_bf16_f32 v170, v140, v141
  v_exp_f32 v144, v144
  v_exp_f32 v145, v145
  v_cvt_pk_bf16_f32 v171, v142, v143
  v_exp_f32 v146, v146
  v_exp_f32 v147, v147
  v_cvt_pk_bf16_f32 v172, v144, v145
  v_exp_f32 v148, v148
  v_exp_f32 v149, v149
  v_cvt_pk_bf16_f32 v173, v146, v147
  v_exp_f32 v150, v150
  v_exp_f32 v151, v151
  v_cvt_pk_bf16_f32 v174, v148, v149
  v_cvt_pk_bf16_f32 v175, v150, v151
  v_mfma_f32_32x32x16_bf16 v[216:231], v[128:131], v[168:171], v[216:231]
  v_exp_f32 v152, v152
  v_exp_f32 v153, v153
  v_exp_f32 v154, v154
  v_exp_f32 v155, v155
  v_cvt_pk_bf16_f32 v176, v152, v153
  v_exp_f32 v156, v156
  v_exp_f32 v157, v157
  v_mfma_f32_32x32x16_bf16 v[216:231], v[132:135], v[172:175], v[216:231]
  v_cvt_pk_bf16_f32 v177, v154, v155
  v_exp_f32 v158, v158
  v_exp_f32 v159, v159
  v_cvt_pk_bf16_f32 v178, v156, v157
  v_exp_f32 v160, v160
  v_exp_f32 v161, v161
  v_cvt_pk_bf16_f32 v179, v158, v159
  v_exp_f32 v162, v162
  v_exp_f32 v163, v163
  v_cvt_pk_bf16_f32 v180, v160, v161
  v_exp_f32 v164, v164
  v_exp_f32 v165, v165
  v_cvt_pk_bf16_f32 v181, v162, v163
  v_exp_f32 v166, v166
  v_exp_f32 v167, v167
  v_cvt_pk_bf16_f32 v182, v164, v165
  v_cvt_pk_bf16_f32 v183, v166, v167
  s_setprio 3
  s_nop 1
  v_mfma_f32_32x32x16_bf16 v[232:247], v[128:131], v[176:179], v[232:247]
  v_mfma_f32_32x32x16_bf16 v[232:247], v[132:135], v[180:183], v[232:247]
  ds_write_b128 v5, v[184:187] offset:36864
  ds_write_b128 v5, v[188:191] offset:37888
  ds_write_b32 v6, v192 offset:38912
  ds_write_b128 v5, v[200:203] offset:39168
  ds_write_b128 v5, v[204:207] offset:40192
  ds_write_b32 v6, v208 offset:41216
  ds_write_b128 v5, v[216:219] offset:41472
  ds_write_b128 v5, v[220:223] offset:42496
  ds_write_b32 v6, v224 offset:43520
  s_nop 11
  ds_write_b128 v5, v[232:235] offset:43776
  ds_write_b128 v5, v[236:239] offset:44800
  ds_write_b32 v6, v240 offset:45824
  s_waitcnt lgkmcnt(0)
  s_mov_b64 exec, 1
  ds_add_u32 v2, v3 offset:64
  s_mov_b64 exec, -1
  ds_read_b32 v6, v2 offset:64
  s_waitcnt lgkmcnt(0)
  v_cmp_gt_u32 vcc, 4, v6
  s_cbranch_vccnz la_spin
la_ok:
  s_mul_i32 s58, s63, 2304
  s_add_u32 s57, s58, 102400
  v_add_u32 v174, s57, v1
  v_lshrrev_b32 v175, 2, v1
  v_add_u32 v175, s57, v175
  ds_read_b128 v[128:131], v174 offset:0
  ds_read_b128 v[132:135], v174 offset:1024
  ds_read_b32 v136, v175 offset:2048
  ds_read_b128 v[140:143], v174 offset:9216
  ds_read_b128 v[144:147], v174 offset:10240
  ds_read_b32 v148, v175 offset:11264
  ds_read_b128 v[152:155], v174 offset:18432
  ds_read_b128 v[156:159], v174 offset:19456
  ds_read_b32 v160, v175 offset:20480
  ds_read_b128 v[164:167], v174 offset:27648
  ds_read_b128 v[168:171], v174 offset:28672
  ds_read_b32 v172, v175 offset:29696
  s_mov_b32 s59, 0x53800000
  s_mov_b32 s60, 0x7b800000
  s_waitcnt lgkmcnt(0)
  v_add_f32 v128, v128, v140
  v_add_f32 v152, v152, v164
  v_add_f32 v129, v129, v141
  v_add_f32 v153, v153, v165
  v_add_f32 v130, v130, v142
  v_add_f32 v154, v154, v166
  v_add_f32 v131, v131, v143
  v_add_f32 v155, v155, v167
  v_add_f32 v132, v132, v144
  v_add_f32 v156, v156, v168
  v_add_f32 v133, v133, v145
  v_add_f32 v157, v157, v169
  v_add_f32 v134, v134, v146
  v_add_f32 v158, v158, v170
  v_add_f32 v135, v135, v147
  v_add_f32 v159, v159, v171
  v_add_f32 v136, v136, v148
  v_add_f32 v160, v160, v172
  v_add_f32 v128, v128, v152
  v_add_f32 v129, v129, v153
  v_add_f32 v130, v130, v154
  v_add_f32 v131, v131, v155
  v_add_f32 v132, v132, v156
  v_add_f32 v133, v133, v157
  v_add_f32 v134, v134, v158
  v_add_f32 v135, v135, v159
  v_add_f32 v136, v136, v160
  v_add_f32 v140, |v128|, |v129|
  v_add_f32 v141, |v130|, |v131|
  v_add_f32 v142, |v132|, |v133|
  v_add_f32 v143, |v134|, |v135|
  v_add_f32 v140, v140, v141
  v_add_f32 v142, v142, v143
  v_add_f32 v140, v140, v142
  v_cmp_le_f32 vcc, 0x30800000, v136
  v_cmp_ge_f32_e64 s[74:75], s59, v136
  v_cmp_gt_f32_e64 s[76:77], s60, v140
  s_nop 1
  s_and_b64 vcc, vcc, s[74:75]
  s_and_b64 vcc, vcc, s[76:77]
  s_cmp_lg_u64 vcc, -1
  s_cbranch_scc1 ry_slow
ry_norm:
  v_rcp_f32 v137, v136
  s_lshl_b32 s57, s63, 15
  s_lshl_b32 s58, s53, 17
  s_add_u32 s57, s57, s58
  s_lshl_b32 s58, s54, 11
  s_add_u32 s57, s57, s58
  s_add_u32 s57, s57, 4195328
  v_mul_f32 v128, v128, v137
  v_mul_f32 v129, v129, v137
  v_mul_f32 v130, v130, v137
  v_mul_f32 v131, v131, v137
  v_mul_f32 v132, v132, v137
  v_mul_f32 v133, v133, v137
  v_mul_f32 v134, v134, v137
  v_mul_f32 v135, v135, v137
  v_cvt_pk_bf16_f32 v140, v128, v129
  v_cvt_pk_bf16_f32 v141, v130, v131
  v_cvt_pk_bf16_f32 v142, v132, v133
  v_cvt_pk_bf16_f32 v143, v134, v135
  buffer_store_dwordx4 v[140:143], v1, s[32:35], s57 offen sc1
  s_lshl_b32 s60, s53, 11
  s_lshr_b32 s58, s63, 1
  s_lshl_b32 s58, s58, 10
  s_add_u32 s60, s60, s58
  s_lshl_b32 s58, s54, 2
  s_add_u32 s60, s60, s58
  s_and_b32 s58, s63, 1
  s_lshl_b32 s58, s58, 6
  s_add_u32 s60, s60, s58
  s_add_u32 s60, s60, 622592
  s_waitcnt vmcnt(0)
  v_lshlrev_b32 v5, 7, v0
  s_mov_b64 exec, 0xff
  buffer_atomic_swap v4, v5, s[32:35], s60 offen sc1
  s_mov_b64 exec, -1
  s_xor_b32 s57, s52, 7
  s_or_b32 s57, s57, s2
  s_cmp_lg_u32 s57, 0
  s_cbranch_scc1 a_nonl
  s_mov_b32 s57, 81920
  s_mov_b64 exec, 1
  buffer_store_dword v4, off, s[32:35], s57 offset:0 sc1
  s_mov_b64 exec, -1
a_nonl:
  s_endpgm
role_g:
  s_cmp_lg_u32 s52, 0
  s_cbranch_scc1 g_nz
  v_lshlrev_b32 v23, 2, v0
  v_add_u32 v23, 157184, v23
  v_mov_b32 v24, 0
  ds_write_b32 v23, v24
g_nz:
  v_lshrrev_b32 v24, 2, v0
  v_lshlrev_b32 v24, 10, v24
  v_and_b32 v25, 3, v0
  v_lshl_add_u32 v24, v25, 4, v24
  s_lshl_b32 s57, s54, 6
  v_add_u32 v13, s57, v24
  v_lshrrev_b32 v24, 3, v0
  v_lshrrev_b32 v25, 4, v0
  v_and_b32 v26, 7, v0
  v_xor_b32 v25, v25, v26
  v_lshlrev_b32 v25, 4, v25
  v_lshl_add_u32 v5, v24, 10, v25
  v_xor_b32 v6, 64, v5
  v_add_u32 v6, 8192, v6
  v_add_u32 v7, 16384, v5
  v_add_u32 v8, 16384, v6
  s_lshl_b32 s66, s53, 17
  s_lshl_b32 s57, s52, 15
  s_add_u32 s66, s66, s57
  s_mul_i32 s67, s52, 12288
  s_add_u32 s67, s67, 81920
  s_lshl_b32 s70, s7, 7
  s_lshl_b32 s58, s52, 13
  s_add_u32 s58, s58, 49152
  s_lshl_b32 s59, s52, 17
  s_lshl_b32 s60, s7, 16
  s_add_u32 s59, s59, s60
  s_waitcnt lgkmcnt(0)
  s_and_b32 s13, s13, 0xffff
  s_mov_b32 s14, 524288
  s_mov_b32 s15, 0x20000
  s_and_b32 s9, s9, 0xffff
  s_mov_b32 s10, 2097152
  s_mov_b32 s11, 0x20000
  s_barrier
  s_add_u32 m0, s58, 0
  s_add_u32 s57, s59, 0
  s_and_b32 s57, s57, 0x7ffff
  buffer_load_dwordx4 v13, s[12:15], s57 offen lds
  s_add_u32 m0, s58, 1024
  s_add_u32 s57, s59, 16384
  s_and_b32 s57, s57, 0x7ffff
  buffer_load_dwordx4 v13, s[12:15], s57 offen lds
  s_add_u32 m0, s58, 2048
  s_add_u32 s57, s59, 32768
  s_and_b32 s57, s57, 0x7ffff
  buffer_load_dwordx4 v13, s[12:15], s57 offen lds
  s_add_u32 m0, s58, 3072
  s_add_u32 s57, s59, 49152
  s_and_b32 s57, s57, 0x7ffff
  buffer_load_dwordx4 v13, s[12:15], s57 offen lds
  s_add_u32 m0, s58, 4096
  s_add_u32 s57, s59, 65536
  s_and_b32 s57, s57, 0x7ffff
  buffer_load_dwordx4 v13, s[12:15], s57 offen lds
  s_add_u32 m0, s58, 5120
  s_add_u32 s57, s59, 81920
  s_and_b32 s57, s57, 0x7ffff
  buffer_load_dwordx4 v13, s[12:15], s57 offen lds
  s_add_u32 m0, s58, 6144
  s_add_u32 s57, s59, 98304
  s_and_b32 s57, s57, 0x7ffff
  buffer_load_dwordx4 v13, s[12:15], s57 offen lds
  s_add_u32 m0, s58, 7168
  s_add_u32 s57, s59, 114688
  s_and_b32 s57, s57, 0x7ffff
  buffer_load_dwordx4 v13, s[12:15], s57 offen lds
  s_add_u32 s60, s66, s70
  s_add_u32 m0, s67, 0
  s_add_u32 s70, s70, 128
  buffer_load_dwordx4 v5, s[8:11], s60 offen lds
  s_add_u32 m0, s67, 1024
  s_and_b32 s70, s70, 1023
  buffer_load_dwordx4 v6, s[8:11], s60 offen lds
  s_add_u32 m0, s67, 2048
  s_nop 0
  buffer_load_dwordx4 v7, s[8:11], s60 offen lds
  s_add_u32 m0, s67, 3072
  s_nop 0
  buffer_load_dwordx4 v8, s[8:11], s60 offen lds
g_split:
  s_and_b32 s17, s17, 0xffff
  s_mov_b32 s18, 16384
  s_mov_b32 s19, 0x20000
  s_and_b32 s21, s21, 0xffff
  s_mov_b32 s22, 16384
  s_mov_b32 s23, 0x20000
  s_and_b32 s25, s25, 0xffff
  s_mov_b32 s26, 1835008
  s_mov_b32 s27, 0x20000
  s_and_b32 s29, s29, 0xffff
  s_mov_b32 s30, 1835008
  s_mov_b32 s31, 0x20000
  s_and_b32 s33, s33, 0xffff
  s_mov_b32 s34, 33554432
  s_mov_b32 s35, 0x20000
  s_and_b32 s37, s37, 0xffff
  s_mov_b32 s38, 1835008
  s_mov_b32 s39, 0x20000
  s_and_b32 s41, s41, 0xffff
  s_mov_b32 s42, 524288
  s_mov_b32 s43, 0x20000
  s_and_b32 s45, s45, 0xffff
  s_mov_b32 s46, 2097152
  s_mov_b32 s47, 0x20000
  s_and_b32 s57, s2, 7
  s_lshr_b32 s58, s2, 3
  s_lshr_b32 s55, s57, 1
  s_lshl_b32 s55, s55, 3
  s_and_b32 s59, s58, 7
  s_add_u32 s55, s55, s59
  s_and_b32 s56, s57, 1
  s_lshl_b32 s56, s56, 2
  s_lshr_b32 s59, s58, 3
  s_add_u32 s56, s56, s59
  s_mov_b32 s64, 0xffff0000
  s_mov_b32 s65, 0x3f803f80
  s_mov_b32 s79, 0xffff
  s_lshl_b32 s5, s53, 2
  s_lshr_b32 s58, s54, 2
  s_add_u32 s5, s5, s58
  v_and_b32 v24, 31, v0
  v_lshrrev_b32 v25, 1, v24
  v_and_b32 v25, 7, v25
  v_lshrrev_b32 v26, 5, v0
  v_xor_b32 v25, v25, v26
  v_lshlrev_b32 v25, 4, v25
  v_lshl_add_u32 v25, v24, 7, v25
  v_add_u32 v9, s67, v25
  v_xor_b32 v10, 32, v9
  v_xor_b32 v11, 64, v9
  v_xor_b32 v12, 96, v9
  v_and_b32 v24, 15, v0
  v_lshrrev_b32 v25, 2, v24
  v_lshl_add_u32 v25, v26, 3, v25
  v_lshlrev_b32 v25, 6, v25
  v_lshrrev_b32 v27, 4, v0
  v_and_b32 v27, 1, v27
  v_lshl_add_u32 v25, v27, 5, v25
  v_and_b32 v28, 3, v0
  v_lshl_add_u32 v25, v28, 3, v25
  v_add_u32 v13, 49152, v25
  v_mov_b32 v244, s65
  v_mov_b32 v245, s65
  v_mov_b32 v246, s65
  v_mov_b32 v247, s65
  v_lshrrev_b32 v24, 3, v0
  v_mul_u32_u24 v24, 3584, v24
  v_lshrrev_b32 v25, 4, v0
  v_and_b32 v25, 1, v25
  v_lshlrev_b32 v25, 1, v25
  v_and_b32 v26, 7, v0
  v_xor_b32 v25, v25, v26
  s_mul_i32 s57, s54, 224
  v_add_u32 v24, s57, v24
  s_and_b32 s58, s54, 3
  s_lshl_b32 s59, s58, 5
  v_add_u32 v27, s59, v24
  v_lshl_add_u32 v252, v25, 4, v27
  v_xor_b32 v26, 4, v25
  v_lshl_add_u32 v253, v26, 4, v27
  v_cmp_le_u32 vcc, 6, v25
  v_subrev_u32 v27, 2, v25
  s_nop 0
  v_cndmask_b32 v27, v25, v27, vcc
  v_lshrrev_b32 v28, 1, v27
  v_cmp_le_u32 vcc, s58, v28
  v_add_u32 v29, 8, v27
  s_nop 0
  v_cndmask_b32 v27, v27, v29, vcc
  v_lshl_add_u32 v254, v27, 4, v24
  v_cmp_le_u32 vcc, 6, v26
  v_subrev_u32 v27, 2, v26
  s_nop 0
  v_cndmask_b32 v27, v26, v27, vcc
  v_lshrrev_b32 v28, 1, v27
  v_cmp_le_u32 vcc, s58, v28
  v_add_u32 v29, 8, v27
  s_nop 0
  v_cndmask_b32 v27, v27, v29, vcc
  v_lshl_add_u32 v255, v27, 4, v24
  s_mul_i32 s68, s52, 57344
  s_lshl_b32 s6, s52, 11
  s_mul_i32 s71, s7, 229376
  s_lshl_b32 s57, s53, 11
  s_lshl_b32 s58, s52, 9
  s_add_u32 s57, s57, s58
  s_add_u32 s57, s57, 98304
  v_and_b32 v15, 31, v0
  v_lshlrev_b32 v15, 4, v15
  v_add_u32 v15, s57, v15
  s_waitcnt vmcnt(4)
  s_add_u32 s60, s66, s70
  s_add_u32 m0, s67, 4096
  s_add_u32 s70, s70, 128
  buffer_load_dwordx4 v5, s[8:11], s60 offen lds
  s_add_u32 m0, s67, 5120
  s_and_b32 s70, s70, 1023
  buffer_load_dwordx4 v6, s[8:11], s60 offen lds
  s_add_u32 m0, s67, 6144
  s_nop 0
  buffer_load_dwordx4 v7, s[8:11], s60 offen lds
  s_add_u32 m0, s67, 7168
  s_nop 0
  buffer_load_dwordx4 v8, s[8:11], s60 offen lds
  s_add_u32 s60, s66, s70
  s_add_u32 m0, s67, 8192
  s_add_u32 s70, s70, 128
  buffer_load_dwordx4 v5, s[8:11], s60 offen lds
  s_add_u32 m0, s67, 9216
  s_and_b32 s70, s70, 1023
  buffer_load_dwordx4 v6, s[8:11], s60 offen lds
  s_add_u32 m0, s67, 10240
  s_nop 0
  buffer_load_dwordx4 v7, s[8:11], s60 offen lds
  s_add_u32 m0, s67, 11264
  s_nop 0
  buffer_load_dwordx4 v8, s[8:11], s60 offen lds
  s_mov_b64 exec, 1
  ds_add_u32 v2, v3 offset:0
  s_mov_b64 exec, -1
  ds_read_b32 v14, v2 offset:0
  s_waitcnt lgkmcnt(0)
  v_cmp_gt_u32 vcc, 4, v14
  s_cbranch_vccnz gwq_spin
gwq_ok:
  s_waitcnt vmcnt(8)
  ds_read_b128 v[16:19], v9 offset:0
  ds_read_b64_tr_b16 v[208:209], v13 offset:0
  ds_read_b64_tr_b16 v[210:211], v13 offset:256
  ds_read_b128 v[20:23], v10 offset:0
  ds_read_b64_tr_b16 v[212:213], v13 offset:1024
  ds_read_b64_tr_b16 v[214:215], v13 offset:1280
  ds_read_b128 v[24:27], v11 offset:0
  ds_read_b64_tr_b16 v[216:217], v13 offset:2048
  ds_read_b64_tr_b16 v[218:219], v13 offset:2304
  ds_read_b128 v[28:31], v12 offset:0
  ds_read_b64_tr_b16 v[220:221], v13 offset:3072
  ds_read_b64_tr_b16 v[222:223], v13 offset:3328
  s_waitcnt lgkmcnt(0)
  v_mfma_f32_32x32x16_bf16 v[144:159], v[208:211], v[16:19], 0
  s_add_u32 s60, s66, s70
  s_add_u32 m0, s67, 0
  s_add_u32 s70, s70, 128
  buffer_load_dwordx4 v5, s[8:11], s60 offen lds
  v_mfma_f32_32x32x16_bf16 v[160:175], v[208:211], v[244:247], 0
  s_add_u32 m0, s67, 1024
  s_and_b32 s70, s70, 1023
  buffer_load_dwordx4 v6, s[8:11], s60 offen lds
  v_mfma_f32_32x32x16_bf16 v[144:159], v[212:215], v[20:23], v[144:159]
  s_add_u32 m0, s67, 2048
  s_nop 0
  buffer_load_dwordx4 v7, s[8:11], s60 offen lds
  v_mfma_f32_32x32x16_bf16 v[160:175], v[212:215], v[244:247], v[160:175]
  s_add_u32 m0, s67, 3072
  s_nop 0
  buffer_load_dwordx4 v8, s[8:11], s60 offen lds
  s_waitcnt vmcnt(8)
  ds_read_b128 v[32:35], v9 offset:4096
  ds_read_b64_tr_b16 v[224:225], v13 offset:4096
  ds_read_b64_tr_b16 v[226:227], v13 offset:4352
  v_mfma_f32_32x32x16_bf16 v[144:159], v[216:219], v[24:27], v[144:159]
  ds_read_b128 v[36:39], v10 offset:4096
  ds_read_b64_tr_b16 v[228:229], v13 offset:5120
  ds_read_b64_tr_b16 v[230:231], v13 offset:5376
  v_mfma_f32_32x32x16_bf16 v[160:175], v[216:219], v[244:247], v[160:175]
  ds_read_b128 v[40:43], v11 offset:4096
  ds_read_b64_tr_b16 v[232:233], v13 offset:6144
  ds_read_b64_tr_b16 v[234:235], v13 offset:6400
  v_mfma_f32_32x32x16_bf16 v[144:159], v[220:223], v[28:31], v[144:159]
  ds_read_b128 v[44:47], v12 offset:4096
  ds_read_b64_tr_b16 v[236:237], v13 offset:7168
  ds_read_b64_tr_b16 v[238:239], v13 offset:7424
  v_mfma_f32_32x32x16_bf16 v[160:175], v[220:223], v[244:247], v[160:175]
  s_waitcnt lgkmcnt(0)
  v_mfma_f32_32x32x16_bf16 v[144:159], v[224:227], v[32:35], v[144:159]
  s_add_u32 s60, s66, s70
  s_add_u32 m0, s67, 4096
  s_add_u32 s70, s70, 128
  buffer_load_dwordx4 v5, s[8:11], s60 offen lds
  v_mfma_f32_32x32x16_bf16 v[160:175], v[224:227], v[244:247], v[160:175]
  s_add_u32 m0, s67, 5120
  s_and_b32 s70, s70, 1023
  buffer_load_dwordx4 v6, s[8:11], s60 offen lds
  v_mfma_f32_32x32x16_bf16 v[144:159], v[228:231], v[36:39], v[144:159]
  s_add_u32 m0, s67, 6144
  s_nop 0
  buffer_load_dwordx4 v7, s[8:11], s60 offen lds
  v_mfma_f32_32x32x16_bf16 v[160:175], v[228:231], v[244:247], v[160:175]
  s_add_u32 m0, s67, 7168
  s_nop 0
  buffer_load_dwordx4 v8, s[8:11], s60 offen lds
  s_waitcnt vmcnt(8)
  ds_read_b128 v[48:51], v9 offset:8192
  ds_read_b64_tr_b16 v[208:209], v13 offset:8192
  ds_read_b64_tr_b16 v[210:211], v13 offset:8448
  v_mfma_f32_32x32x16_bf16 v[144:159], v[232:235], v[40:43], v[144:159]
  ds_read_b128 v[52:55], v10 offset:8192
  ds_read_b64_tr_b16 v[212:213], v13 offset:9216
  ds_read_b64_tr_b16 v[214:215], v13 offset:9472
  v_mfma_f32_32x32x16_bf16 v[160:175], v[232:235], v[244:247], v[160:175]
  ds_read_b128 v[56:59], v11 offset:8192
  ds_read_b64_tr_b16 v[216:217], v13 offset:10240
  ds_read_b64_tr_b16 v[218:219], v13 offset:10496
  v_mfma_f32_32x32x16_bf16 v[144:159], v[236:239], v[44:47], v[144:159]
  ds_read_b128 v[60:63], v12 offset:8192
  ds_read_b64_tr_b16 v[220:221], v13 offset:11264
  ds_read_b64_tr_b16 v[222:223], v13 offset:11520
  v_mfma_f32_32x32x16_bf16 v[160:175], v[236:239], v[244:247], v[160:175]
  s_waitcnt lgkmcnt(0)
  v_mfma_f32_32x32x16_bf16 v[144:159], v[208:211], v[48:51], v[144:159]
  s_add_u32 s60, s66, s70
  s_add_u32 m0, s67, 8192
  s_add_u32 s70, s70, 128
  buffer_load_dwordx4 v5, s[8:11], s60 offen lds
  v_mfma_f32_32x32x16_bf16 v[160:175], v[208:211], v[244:247], v[160:175]
  s_add_u32 m0, s67, 9216
  s_and_b32 s70, s70, 1023
  buffer_load_dwordx4 v6, s[8:11], s60 offen lds
  v_mfma_f32_32x32x16_bf16 v[144:159], v[212:215], v[52:55], v[144:159]
  s_add_u32 m0, s67, 10240
  s_nop 0
  buffer_load_dwordx4 v7, s[8:11], s60 offen lds
  v_mfma_f32_32x32x16_bf16 v[160:175], v[212:215], v[244:247], v[160:175]
  s_add_u32 m0, s67, 11264
  s_nop 0
  buffer_load_dwordx4 v8, s[8:11], s60 offen lds
  s_waitcnt vmcnt(8)
  ds_read_b128 v[64:67], v9 offset:0
  ds_read_b64_tr_b16 v[224:225], v13 offset:12288
  ds_read_b64_tr_b16 v[226:227], v13 offset:12544
  v_mfma_f32_32x32x16_bf16 v[144:159], v[216:219], v[56:59], v[144:159]
  ds_read_b128 v[68:71], v10 offset:0
  ds_read_b64_tr_b16 v[228:229], v13 offset:13312
  ds_read_b64_tr_b16 v[230:231], v13 offset:13568
  v_mfma_f32_32x32x16_bf16 v[160:175], v[216:219], v[244:247], v[160:175]
  ds_read_b128 v[72:75], v11 offset:0
  ds_read_b64_tr_b16 v[232:233], v13 offset:14336
  ds_read_b64_tr_b16 v[234:235], v13 offset:14592
  v_mfma_f32_32x32x16_bf16 v[144:159], v[220:223], v[60:63], v[144:159]
  ds_read_b128 v[76:79], v12 offset:0
  ds_read_b64_tr_b16 v[236:237], v13 offset:15360
  ds_read_b64_tr_b16 v[238:239], v13 offset:15616
  v_mfma_f32_32x32x16_bf16 v[160:175], v[220:223], v[244:247], v[160:175]
  s_waitcnt lgkmcnt(0)
  v_mfma_f32_32x32x16_bf16 v[144:159], v[224:227], v[64:67], v[144:159]
  s_add_u32 s60, s66, s70
  s_add_u32 m0, s67, 0
  s_add_u32 s70, s70, 128
  buffer_load_dwordx4 v5, s[8:11], s60 offen lds
  v_mfma_f32_32x32x16_bf16 v[160:175], v[224:227], v[244:247], v[160:175]
  s_add_u32 m0, s67, 1024
  s_and_b32 s70, s70, 1023
  buffer_load_dwordx4 v6, s[8:11], s60 offen lds
  v_mfma_f32_32x32x16_bf16 v[144:159], v[228:231], v[68:71], v[144:159]
  s_add_u32 m0, s67, 2048
  s_nop 0
  buffer_load_dwordx4 v7, s[8:11], s60 offen lds
  v_mfma_f32_32x32x16_bf16 v[160:175], v[228:231], v[244:247], v[160:175]
  s_add_u32 m0, s67, 3072
  s_nop 0
  buffer_load_dwordx4 v8, s[8:11], s60 offen lds
  s_waitcnt vmcnt(8)
  ds_read_b128 v[80:83], v9 offset:4096
  ds_read_b64_tr_b16 v[208:209], v13 offset:16384
  ds_read_b64_tr_b16 v[210:211], v13 offset:16640
  v_mfma_f32_32x32x16_bf16 v[144:159], v[232:235], v[72:75], v[144:159]
  ds_read_b128 v[84:87], v10 offset:4096
  ds_read_b64_tr_b16 v[212:213], v13 offset:17408
  ds_read_b64_tr_b16 v[214:215], v13 offset:17664
  v_mfma_f32_32x32x16_bf16 v[160:175], v[232:235], v[244:247], v[160:175]
  ds_read_b128 v[88:91], v11 offset:4096
  ds_read_b64_tr_b16 v[216:217], v13 offset:18432
  ds_read_b64_tr_b16 v[218:219], v13 offset:18688
  v_mfma_f32_32x32x16_bf16 v[144:159], v[236:239], v[76:79], v[144:159]
  ds_read_b128 v[92:95], v12 offset:4096
  ds_read_b64_tr_b16 v[220:221], v13 offset:19456
  ds_read_b64_tr_b16 v[222:223], v13 offset:19712
  v_mfma_f32_32x32x16_bf16 v[160:175], v[236:239], v[244:247], v[160:175]
  s_waitcnt lgkmcnt(0)
  v_mfma_f32_32x32x16_bf16 v[144:159], v[208:211], v[80:83], v[144:159]
  s_add_u32 s60, s66, s70
  s_add_u32 m0, s67, 4096
  s_add_u32 s70, s70, 128
  buffer_load_dwordx4 v5, s[8:11], s60 offen lds
  s_add_u32 m0, s67, 5120
  s_and_b32 s70, s70, 1023
  buffer_load_dwordx4 v6, s[8:11], s60 offen lds
  s_add_u32 m0, s67, 6144
  v_mfma_f32_32x32x16_bf16 v[160:175], v[208:211], v[244:247], v[160:175]
  s_nop 0
  buffer_load_dwordx4 v7, s[8:11], s60 offen lds
  s_add_u32 m0, s67, 7168
  s_nop 0
  buffer_load_dwordx4 v8, s[8:11], s60 offen lds
  buffer_load_dwordx4 v[248:251], v15, s[32:35], 0 offen sc1
  s_add_u32 s59, s68, s71
  s_add_u32 m0, s6, 0
  v_mfma_f32_32x32x16_bf16 v[144:159], v[212:215], v[84:87], v[144:159]
  s_add_u32 s60, s59, 0
  buffer_load_dwordx4 v252, s[24:27], s60 offen lds
  s_add_u32 m0, s6, 1024
  s_add_u32 s60, s59, 28672
  buffer_load_dwordx4 v252, s[24:27], s60 offen lds
  s_add_u32 m0, s6, 8192
  s_add_u32 s60, s59, 0
  v_mfma_f32_32x32x16_bf16 v[160:175], v[212:215], v[244:247], v[160:175]
  buffer_load_dwordx4 v253, s[28:31], s60 offen lds
  s_add_u32 m0, s6, 9216
  s_add_u32 s60, s59, 28672
  buffer_load_dwordx4 v253, s[28:31], s60 offen lds
  s_add_u32 s71, s71, 229376
  s_cmp_eq_u32 s71, 1835008
  s_cselect_b32 s71, 0, s71
  s_waitcnt vmcnt(13)
  ds_read_b128 v[96:99], v9 offset:8192
  ds_read_b64_tr_b16 v[224:225], v13 offset:20480
  ds_read_b64_tr_b16 v[226:227], v13 offset:20736
  v_mfma_f32_32x32x16_bf16 v[144:159], v[216:219], v[88:91], v[144:159]
  ds_read_b128 v[100:103], v10 offset:8192
  ds_read_b64_tr_b16 v[228:229], v13 offset:21504
  ds_read_b64_tr_b16 v[230:231], v13 offset:21760
  v_mfma_f32_32x32x16_bf16 v[160:175], v[216:219], v[244:247], v[160:175]
  ds_read_b128 v[104:107], v11 offset:8192
  ds_read_b64_tr_b16 v[232:233], v13 offset:22528
  ds_read_b64_tr_b16 v[234:235], v13 offset:22784
  v_mfma_f32_32x32x16_bf16 v[144:159], v[220:223], v[92:95], v[144:159]
  ds_read_b128 v[108:111], v12 offset:8192
  ds_read_b64_tr_b16 v[236:237], v13 offset:23552
  ds_read_b64_tr_b16 v[238:239], v13 offset:23808
  v_mfma_f32_32x32x16_bf16 v[160:175], v[220:223], v[244:247], v[160:175]
  s_waitcnt lgkmcnt(0)
  v_mfma_f32_32x32x16_bf16 v[144:159], v[224:227], v[96:99], v[144:159]
  ds_read_b32 v14, v2 offset:32
  v_mfma_f32_32x32x16_bf16 v[160:175], v[224:227], v[244:247], v[160:175]
  v_mfma_f32_32x32x16_bf16 v[144:159], v[228:231], v[100:103], v[144:159]
  v_mfma_f32_32x32x16_bf16 v[160:175], v[228:231], v[244:247], v[160:175]
  s_waitcnt vmcnt(9)
  ds_read_b128 v[112:115], v9 offset:0
  ds_read_b64_tr_b16 v[208:209], v13 offset:24576
  ds_read_b64_tr_b16 v[210:211], v13 offset:24832
  v_mfma_f32_32x32x16_bf16 v[144:159], v[232:235], v[104:107], v[144:159]
  ds_read_b128 v[116:119], v10 offset:0
  ds_read_b64_tr_b16 v[212:213], v13 offset:25600
  ds_read_b64_tr_b16 v[214:215], v13 offset:25856
  v_mfma_f32_32x32x16_bf16 v[160:175], v[232:235], v[244:247], v[160:175]
  ds_read_b128 v[120:123], v11 offset:0
  ds_read_b64_tr_b16 v[216:217], v13 offset:26624
  ds_read_b64_tr_b16 v[218:219], v13 offset:26880
  v_mfma_f32_32x32x16_bf16 v[144:159], v[236:239], v[108:111], v[144:159]
  ds_read_b128 v[124:127], v12 offset:0
  ds_read_b64_tr_b16 v[220:221], v13 offset:27648
  ds_read_b64_tr_b16 v[222:223], v13 offset:27904
  v_mfma_f32_32x32x16_bf16 v[160:175], v[236:239], v[244:247], v[160:175]
  s_waitcnt lgkmcnt(0)
  v_mfma_f32_32x32x16_bf16 v[144:159], v[208:211], v[112:115], v[144:159]
  v_mfma_f32_32x32x16_bf16 v[160:175], v[208:211], v[244:247], v[160:175]
  v_mfma_f32_32x32x16_bf16 v[144:159], v[212:215], v[116:119], v[144:159]
  v_mfma_f32_32x32x16_bf16 v[160:175], v[212:215], v[244:247], v[160:175]
  s_waitcnt lgkmcnt(0)
  v_cmp_gt_u32 vcc, 2, v14
  s_cbranch_vccnz gkv_spin
gkv_ok:
  ds_read_b32 v4, v2 offset:112
  s_waitcnt lgkmcnt(0)
  v_readfirstlane_b32 s61, v4
  s_add_u32 s59, s68, s71
  s_add_u32 m0, s6, 16384
  s_add_u32 s60, s59, 0
  buffer_load_dwordx4 v252, s[24:27], s60 offen lds
  s_add_u32 m0, s6, 17408
  s_add_u32 s60, s59, 28672
  buffer_load_dwordx4 v252, s[24:27], s60 offen lds
  s_add_u32 m0, s6, 24576
  s_add_u32 s60, s59, 0
  buffer_load_dwordx4 v253, s[28:31], s60 offen lds
  s_add_u32 m0, s6, 25600
  s_add_u32 s60, s59, 28672
  buffer_load_dwordx4 v253, s[28:31], s60 offen lds
  s_add_u32 s71, s71, 229376
  s_cmp_eq_u32 s71, 1835008
  s_cselect_b32 s71, 0, s71
  s_add_u32 s59, s68, s71
  s_add_u32 m0, s6, 32768
  s_add_u32 s60, s59, 0
  buffer_load_dwordx4 v252, s[24:27], s60 offen lds
  s_add_u32 m0, s6, 33792
  s_add_u32 s60, s59, 28672
  buffer_load_dwordx4 v252, s[24:27], s60 offen lds
  s_add_u32 m0, s6, 40960
  s_add_u32 s60, s59, 0
  buffer_load_dwordx4 v253, s[28:31], s60 offen lds
  s_add_u32 m0, s6, 41984
  s_add_u32 s60, s59, 28672
  buffer_load_dwordx4 v253, s[28:31], s60 offen lds
  s_add_u32 s71, s71, 229376
  s_cmp_eq_u32 s71, 1835008
  s_cselect_b32 s71, 0, s71
  s_waitcnt vmcnt(13)
  ds_read_b128 v[128:131], v9 offset:4096
  ds_read_b64_tr_b16 v[224:225], v13 offset:28672
  ds_read_b64_tr_b16 v[226:227], v13 offset:28928
  v_mfma_f32_32x32x16_bf16 v[144:159], v[216:219], v[120:123], v[144:159]
  ds_read_b128 v[132:135], v10 offset:4096
  ds_read_b64_tr_b16 v[228:229], v13 offset:29696
  ds_read_b64_tr_b16 v[230:231], v13 offset:29952
  v_mfma_f32_32x32x16_bf16 v[160:175], v[216:219], v[244:247], v[160:175]
  ds_read_b128 v[136:139], v11 offset:4096
  ds_read_b64_tr_b16 v[232:233], v13 offset:30720
  ds_read_b64_tr_b16 v[234:235], v13 offset:30976
  v_mfma_f32_32x32x16_bf16 v[144:159], v[220:223], v[124:127], v[144:159]
  ds_read_b128 v[140:143], v12 offset:4096
  ds_read_b64_tr_b16 v[236:237], v13 offset:31744
  ds_read_b64_tr_b16 v[238:239], v13 offset:32000
  v_mfma_f32_32x32x16_bf16 v[160:175], v[220:223], v[244:247], v[160:175]
  s_waitcnt lgkmcnt(0)
  v_mfma_f32_32x32x16_bf16 v[144:159], v[224:227], v[128:131], v[144:159]
  v_mfma_f32_32x32x16_bf16 v[160:175], v[224:227], v[244:247], v[160:175]
  v_mfma_f32_32x32x16_bf16 v[144:159], v[228:231], v[132:135], v[144:159]
  v_mfma_f32_32x32x16_bf16 v[160:175], v[228:231], v[244:247], v[160:175]
  v_mfma_f32_32x32x16_bf16 v[144:159], v[232:235], v[136:139], v[144:159]
  v_mfma_f32_32x32x16_bf16 v[160:175], v[232:235], v[244:247], v[160:175]
  v_mfma_f32_32x32x16_bf16 v[144:159], v[236:239], v[140:143], v[144:159]
  v_mfma_f32_32x32x16_bf16 v[160:175], v[236:239], v[244:247], v[160:175]
  s_waitcnt vmcnt(12)
  v_xor_b32 v208, s61, v249
  v_xor_b32 v251, s61, v251
  v_or_b32 v208, v208, v251
  v_cmp_ne_u32 vcc, 0, v208
  s_cbranch_vccnz gst_spin
gst_ok:
  v_mov_b32 v240, v248
  v_mul_f32 v15, v250, v250
  v_mul_f32 v242, 0x3eb8aa3b, v250
  s_lshl_b32 s57, s52, 10
  s_add_u32 s57, s57, 139264
  v_add_u32 v214, s57, v1
  s_nop 5
  v_pk_fma_f32 v[144:145], v[160:161], v[240:241], v[144:145] op_sel_hi:[1,0,1]
  v_pk_fma_f32 v[146:147], v[162:163], v[240:241], v[146:147] op_sel_hi:[1,0,1]
  v_pk_fma_f32 v[148:149], v[164:165], v[240:241], v[148:149] op_sel_hi:[1,0,1]
  v_pk_fma_f32 v[150:151], v[166:167], v[240:241], v[150:151] op_sel_hi:[1,0,1]
  v_pk_fma_f32 v[152:153], v[168:169], v[240:241], v[152:153] op_sel_hi:[1,0,1]
  v_pk_fma_f32 v[154:155], v[170:171], v[240:241], v[154:155] op_sel_hi:[1,0,1]
  v_pk_fma_f32 v[156:157], v[172:173], v[240:241], v[156:157] op_sel_hi:[1,0,1]
  v_pk_fma_f32 v[158:159], v[174:175], v[240:241], v[158:159] op_sel_hi:[1,0,1]
  v_pk_mul_f32 v[144:145], v[144:145], v[242:243] op_sel_hi:[1,0]
  v_pk_mul_f32 v[146:147], v[146:147], v[242:243] op_sel_hi:[1,0]
  v_pk_mul_f32 v[148:149], v[148:149], v[242:243] op_sel_hi:[1,0]
  v_pk_mul_f32 v[150:151], v[150:151], v[242:243] op_sel_hi:[1,0]
  v_pk_mul_f32 v[152:153], v[152:153], v[242:243] op_sel_hi:[1,0]
  v_pk_mul_f32 v[154:155], v[154:155], v[242:243] op_sel_hi:[1,0]
  v_pk_mul_f32 v[156:157], v[156:157], v[242:243] op_sel_hi:[1,0]
  v_pk_mul_f32 v[158:159], v[158:159], v[242:243] op_sel_hi:[1,0]
  v_cvt_pk_bf16_f32 v144, v144, v145
  v_cvt_pk_bf16_f32 v145, v146, v147
  v_cvt_pk_bf16_f32 v146, v148, v149
  v_cvt_pk_bf16_f32 v147, v150, v151
  v_cvt_pk_bf16_f32 v148, v152, v153
  v_cvt_pk_bf16_f32 v149, v154, v155
  v_cvt_pk_bf16_f32 v150, v156, v157
  v_cvt_pk_bf16_f32 v151, v158, v159
  ds_write_b128 v214, v[144:147]
  ds_write_b128 v214, v[148:151] offset:4096
  s_waitcnt lgkmcnt(0)
  s_mov_b64 exec, 1
  ds_add_u32 v2, v3 offset:16
  s_mov_b64 exec, -1
  v_cvt_pk_bf16_f32 v216, v240, v240
  v_and_b32 v219, s64, v216
  v_sub_f32 v240, v240, v219
  v_cvt_pk_bf16_f32 v217, v240, v240
  v_and_b32 v219, s64, v217
  v_sub_f32 v240, v240, v219
  v_cvt_pk_bf16_f32 v218, v240, v240
  v_bfi_b32 v219, s79, v216, v217
  v_bfi_b32 v220, s79, v218, v216
  v_bfi_b32 v221, s79, v217, v218
  v_cmp_gt_u32 vcc, 32, v0
  s_nop 1
  v_cndmask_b32 v240, 0, v219, vcc
  v_cndmask_b32 v241, 0, v220, vcc
  v_cndmask_b32 v242, 0, v221, vcc
  v_cndmask_b32 v243, 0, v219, vcc
  v_and_b32 v208, 15, v0
  v_lshrrev_b32 v209, 2, v208
  v_lshrrev_b32 v210, 5, v0
  v_lshl_add_u32 v209, v210, 3, v209
  v_lshlrev_b32 v209, 7, v209
  v_lshrrev_b32 v211, 4, v0
  v_and_b32 v211, 1, v211
  v_lshl_add_u32 v209, v211, 13, v209
  v_lshrrev_b32 v212, 1, v0
  v_and_b32 v212, 1, v212
  v_lshrrev_b32 v213, 3, v208
  v_lshlrev_b32 v213, 1, v213
  v_xor_b32 v212, v212, v213
  v_lshlrev_b32 v211, 2, v211
  v_xor_b32 v212, v212, v211
  v_lshl_add_u32 v209, v212, 4, v209
  v_and_b32 v212, 1, v0
  v_lshl_add_u32 v9, v212, 3, v209
  v_xor_b32 v10, 32, v9
  v_xor_b32 v11, 64, v9
  v_xor_b32 v12, 96, v9
  v_and_b32 v208, 31, v0
  v_lshrrev_b32 v209, 4, v208
  v_mul_u32_u24 v209, 1776, v209
  v_add_u32 v208, v208, v209
  s_mul_i32 s57, s54, 112
  v_add_u32 v208, s57, v208
  v_lshlrev_b32 v208, 5, v208
  v_lshl_add_u32 v208, v210, 4, v208
  s_and_b32 s58, s54, 3
  s_add_u32 s59, s58, s52
  s_lshl_b32 s59, s59, 9
  v_add_u32 v5, s59, v208
  s_add_u32 s59, s52, 4
  s_cmp_ge_u32 s52, s58
  s_cselect_b32 s59, s59, s52
  s_min_u32 s59, s59, 6
  s_lshl_b32 s59, s59, 9
  v_add_u32 v6, s59, v208
  s_lshl_b32 s69, s53, 2
  s_add_u32 s69, s69, s52
  s_mul_i32 s69, s69, 112
  s_mul_i32 s57, s54, 7
  s_add_u32 s69, s69, s57
  s_lshl_b32 s69, s69, 10
  s_add_u32 s69, s69, 8388608
  s_waitcnt vmcnt(8)
  s_mov_b64 exec, 1
  ds_add_u32 v2, v3 offset:0
  s_mov_b64 exec, -1
  ds_read_b32 v14, v2 offset:0
  s_waitcnt lgkmcnt(0)
  v_cmp_gt_u32 vcc, 8, v14
  s_cbranch_vccnz gq2_spin
gq2_ok:
  s_setprio 0
  s_add_u32 s59, s68, s71
  s_add_u32 m0, s6, 49152
  s_add_u32 s60, s59, 0
  buffer_load_dwordx4 v252, s[24:27], s60 offen lds
  s_add_u32 m0, s6, 50176
  s_add_u32 s60, s59, 28672
  buffer_load_dwordx4 v252, s[24:27], s60 offen lds
  s_add_u32 m0, s6, 57344
  s_add_u32 s60, s59, 0
  buffer_load_dwordx4 v253, s[28:31], s60 offen lds
  s_add_u32 m0, s6, 58368
  s_add_u32 s60, s59, 28672
  buffer_load_dwordx4 v253, s[28:31], s60 offen lds
  s_add_u32 s71, s71, 229376
  s_cmp_eq_u32 s71, 1835008
  s_cselect_b32 s71, 0, s71
  ds_read_b64_tr_b16 v[208:209], v9 offset:0
  ds_read_b64_tr_b16 v[210:211], v9 offset:512
  ds_read_b64_tr_b16 v[212:213], v10 offset:0
  ds_read_b64_tr_b16 v[214:215], v10 offset:512
  ds_read_b64_tr_b16 v[216:217], v11 offset:0
  ds_read_b64_tr_b16 v[218:219], v11 offset:512
  ds_read_b64_tr_b16 v[220:221], v12 offset:0
  ds_read_b64_tr_b16 v[222:223], v12 offset:512
  s_waitcnt lgkmcnt(0)
  v_mfma_f32_32x32x16_bf16 v[144:159], v[208:211], v[16:19], 0
  ds_read_b64_tr_b16 v[224:225], v9 offset:2048
  ds_read_b64_tr_b16 v[226:227], v9 offset:2560
  v_mfma_f32_32x32x16_bf16 v[160:175], v[212:215], v[16:19], 0
  ds_read_b64_tr_b16 v[228:229], v10 offset:2048
  ds_read_b64_tr_b16 v[230:231], v10 offset:2560
  v_mfma_f32_32x32x16_bf16 v[176:191], v[216:219], v[16:19], 0
  ds_read_b64_tr_b16 v[232:233], v11 offset:2048
  ds_read_b64_tr_b16 v[234:235], v11 offset:2560
  v_mfma_f32_32x32x16_bf16 v[192:207], v[220:223], v[16:19], 0
  ds_read_b64_tr_b16 v[236:237], v12 offset:2048
  ds_read_b64_tr_b16 v[238:239], v12 offset:2560
  s_waitcnt lgkmcnt(0)
  v_mfma_f32_32x32x16_bf16 v[144:159], v[224:227], v[20:23], v[144:159]
  s_waitcnt vmcnt(8)
  s_mov_b64 exec, 1
  ds_add_u32 v2, v3 offset:0
  s_mov_b64 exec, -1
  ds_read_b64_tr_b16 v[208:209], v9 offset:4096
  ds_read_b64_tr_b16 v[210:211], v9 offset:4608
  v_mfma_f32_32x32x16_bf16 v[160:175], v[228:231], v[20:23], v[160:175]
  ds_read_b64_tr_b16 v[212:213], v10 offset:4096
  ds_read_b64_tr_b16 v[214:215], v10 offset:4608
  v_mfma_f32_32x32x16_bf16 v[176:191], v[232:235], v[20:23], v[176:191]
  ds_read_b64_tr_b16 v[216:217], v11 offset:4096
  ds_read_b64_tr_b16 v[218:219], v11 offset:4608
  v_mfma_f32_32x32x16_bf16 v[192:207], v[236:239], v[20:23], v[192:207]
  ds_read_b64_tr_b16 v[220:221], v12 offset:4096
  ds_read_b64_tr_b16 v[222:223], v12 offset:4608
  s_waitcnt lgkmcnt(0)
  v_mfma_f32_32x32x16_bf16 v[144:159], v[208:211], v[24:27], v[144:159]
  ds_read_b64_tr_b16 v[224:225], v9 offset:6144
  ds_read_b64_tr_b16 v[226:227], v9 offset:6656
  ds_read_b64_tr_b16 v[228:229], v10 offset:6144
  v_mfma_f32_32x32x16_bf16 v[160:175], v[212:215], v[24:27], v[160:175]
  ds_read_b64_tr_b16 v[230:231], v10 offset:6656
  ds_read_b64_tr_b16 v[232:233], v11 offset:6144
  v_mfma_f32_32x32x16_bf16 v[176:191], v[216:219], v[24:27], v[176:191]
  ds_read_b64_tr_b16 v[234:235], v11 offset:6656
  ds_read_b64_tr_b16 v[236:237], v12 offset:6144
  v_mfma_f32_32x32x16_bf16 v[192:207], v[220:223], v[24:27], v[192:207]
  ds_read_b64_tr_b16 v[238:239], v12 offset:6656
  ds_read_b32 v14, v2 offset:0
  s_waitcnt lgkmcnt(0)
  s_setprio 2
  v_cmp_gt_u32 vcc, 12, v14
  s_setprio 0
  s_cbranch_vccnz gs0_spin
gs0_ok:
  v_mfma_f32_32x32x16_bf16 v[144:159], v[224:227], v[28:31], v[144:159]
  ds_read_b64_tr_b16 v[208:209], v9 offset:16384
  ds_read_b64_tr_b16 v[210:211], v9 offset:16896
  v_mfma_f32_32x32x16_bf16 v[160:175], v[228:231], v[28:31], v[160:175]
  ds_read_b64_tr_b16 v[212:213], v10 offset:16384
  ds_read_b64_tr_b16 v[214:215], v10 offset:16896
  v_mfma_f32_32x32x16_bf16 v[176:191], v[232:235], v[28:31], v[176:191]
  ds_read_b64_tr_b16 v[216:217], v11 offset:16384
  ds_read_b64_tr_b16 v[218:219], v11 offset:16896
  v_mfma_f32_32x32x16_bf16 v[192:207], v[236:239], v[28:31], v[192:207]
  ds_read_b64_tr_b16 v[220:221], v12 offset:16384
  ds_read_b64_tr_b16 v[222:223], v12 offset:16896
  s_waitcnt lgkmcnt(0)
  v_mfma_f32_32x32x16_bf16 v[144:159], v[208:211], v[32:35], v[144:159]
  ds_read_b64_tr_b16 v[224:225], v9 offset:18432
  ds_read_b64_tr_b16 v[226:227], v9 offset:18944
  v_mfma_f32_32x32x16_bf16 v[160:175], v[212:215], v[32:35], v[160:175]
  ds_read_b64_tr_b16 v[228:229], v10 offset:18432
  ds_read_b64_tr_b16 v[230:231], v10 offset:18944
  v_mfma_f32_32x32x16_bf16 v[176:191], v[216:219], v[32:35], v[176:191]
  ds_read_b64_tr_b16 v[232:233], v11 offset:18432
  ds_read_b64_tr_b16 v[234:235], v11 offset:18944
  v_mfma_f32_32x32x16_bf16 v[192:207], v[220:223], v[32:35], v[192:207]
  ds_read_b64_tr_b16 v[236:237], v12 offset:18432
  ds_read_b64_tr_b16 v[238:239], v12 offset:18944
  s_waitcnt lgkmcnt(0)
  v_mfma_f32_32x32x16_bf16 v[144:159], v[224:227], v[36:39], v[144:159]
  s_waitcnt vmcnt(4)
  s_mov_b64 exec, 1
  ds_add_u32 v2, v3 offset:0
  s_mov_b64 exec, -1
  s_mov_b32 s74, 131072
  buffer_load_dwordx4 v[244:247], v5, s[32:35], s74 offen sc1
  buffer_load_dwordx4 v[248:251], v6, s[32:35], s74 offen sc1
  v_mfma_f32_32x32x16_bf16 v[160:175], v[228:231], v[36:39], v[160:175]
  ds_read_b64_tr_b16 v[208:209], v9 offset:20480
  ds_read_b64_tr_b16 v[210:211], v9 offset:20992
  ds_read_b64_tr_b16 v[212:213], v10 offset:20480
  v_mfma_f32_32x32x16_bf16 v[176:191], v[232:235], v[36:39], v[176:191]
  ds_read_b64_tr_b16 v[214:215], v10 offset:20992
  ds_read_b64_tr_b16 v[216:217], v11 offset:20480
  ds_read_b64_tr_b16 v[218:219], v11 offset:20992
  v_mfma_f32_32x32x16_bf16 v[192:207], v[236:239], v[36:39], v[192:207]
  ds_read_b64_tr_b16 v[220:221], v12 offset:20480
  ds_read_b64_tr_b16 v[222:223], v12 offset:20992
  s_waitcnt lgkmcnt(0)
  v_mfma_f32_32x32x16_bf16 v[144:159], v[208:211], v[40:43], v[144:159]
  ds_read_b64_tr_b16 v[224:225], v9 offset:22528
  ds_read_b64_tr_b16 v[226:227], v9 offset:23040
  ds_read_b64_tr_b16 v[228:229], v10 offset:22528
  v_mfma_f32_32x32x16_bf16 v[160:175], v[212:215], v[40:43], v[160:175]
  ds_read_b64_tr_b16 v[230:231], v10 offset:23040
  ds_read_b64_tr_b16 v[232:233], v11 offset:22528
  v_mfma_f32_32x32x16_bf16 v[176:191], v[216:219], v[40:43], v[176:191]
  ds_read_b64_tr_b16 v[234:235], v11 offset:23040
  ds_read_b64_tr_b16 v[236:237], v12 offset:22528
  v_mfma_f32_32x32x16_bf16 v[192:207], v[220:223], v[40:43], v[192:207]
  ds_read_b64_tr_b16 v[238:239], v12 offset:23040
  ds_read_b32 v14, v2 offset:0
  s_waitcnt lgkmcnt(0)
  s_setprio 2
  v_cmp_gt_u32 vcc, 16, v14
  s_setprio 0
  s_cbranch_vccnz gs1_spin
gs1_ok:
  v_mfma_f32_32x32x16_bf16 v[144:159], v[224:227], v[44:47], v[144:159]
  ds_read_b64_tr_b16 v[208:209], v9 offset:32768
  ds_read_b64_tr_b16 v[210:211], v9 offset:33280
  v_mfma_f32_32x32x16_bf16 v[160:175], v[228:231], v[44:47], v[160:175]
  ds_read_b64_tr_b16 v[212:213], v10 offset:32768
  ds_read_b64_tr_b16 v[214:215], v10 offset:33280
  v_mfma_f32_32x32x16_bf16 v[176:191], v[232:235], v[44:47], v[176:191]
  ds_read_b64_tr_b16 v[216:217], v11 offset:32768
  ds_read_b64_tr_b16 v[218:219], v11 offset:33280
  v_mfma_f32_32x32x16_bf16 v[192:207], v[236:239], v[44:47], v[192:207]
  ds_read_b64_tr_b16 v[220:221], v12 offset:32768
  ds_read_b64_tr_b16 v[222:223], v12 offset:33280
  s_waitcnt lgkmcnt(0)
  v_mfma_f32_32x32x16_bf16 v[144:159], v[208:211], v[48:51], v[144:159]
  s_add_u32 s59, s68, s71
  s_add_u32 m0, s6, 0
  s_add_u32 s60, s59, 0
  buffer_load_dwordx4 v252, s[24:27], s60 offen lds
  s_add_u32 m0, s6, 1024
  s_add_u32 s60, s59, 28672
  v_mfma_f32_32x32x16_bf16 v[160:175], v[212:215], v[48:51], v[160:175]
  buffer_load_dwordx4 v252, s[24:27], s60 offen lds
  s_add_u32 m0, s6, 8192
  s_add_u32 s60, s59, 0
  buffer_load_dwordx4 v253, s[28:31], s60 offen lds
  s_add_u32 m0, s6, 9216
  s_add_u32 s60, s59, 28672
  v_mfma_f32_32x32x16_bf16 v[176:191], v[216:219], v[48:51], v[176:191]
  buffer_load_dwordx4 v253, s[28:31], s60 offen lds
  s_add_u32 s71, s71, 229376
  s_cmp_eq_u32 s71, 1835008
  s_cselect_b32 s71, 0, s71
  ds_read_b64_tr_b16 v[224:225], v9 offset:34816
  ds_read_b64_tr_b16 v[226:227], v9 offset:35328
  v_mfma_f32_32x32x16_bf16 v[192:207], v[220:223], v[48:51], v[192:207]
  ds_read_b64_tr_b16 v[228:229], v10 offset:34816
  ds_read_b64_tr_b16 v[230:231], v10 offset:35328
  ds_read_b64_tr_b16 v[232:233], v11 offset:34816
  ds_read_b64_tr_b16 v[234:235], v11 offset:35328
  ds_read_b64_tr_b16 v[236:237], v12 offset:34816
  ds_read_b64_tr_b16 v[238:239], v12 offset:35328
  s_waitcnt lgkmcnt(0)
  v_mfma_f32_32x32x16_bf16 v[144:159], v[224:227], v[52:55], v[144:159]
  s_waitcnt vmcnt(6)
  s_mov_b64 exec, 1
  ds_add_u32 v2, v3 offset:0
  s_mov_b64 exec, -1
  ds_read_b64_tr_b16 v[208:209], v9 offset:36864
  ds_read_b64_tr_b16 v[210:211], v9 offset:37376
  v_mfma_f32_32x32x16_bf16 v[160:175], v[228:231], v[52:55], v[160:175]
  ds_read_b64_tr_b16 v[212:213], v10 offset:36864
  ds_read_b64_tr_b16 v[214:215], v10 offset:37376
  v_mfma_f32_32x32x16_bf16 v[176:191], v[232:235], v[52:55], v[176:191]
  ds_read_b64_tr_b16 v[216:217], v11 offset:36864
  ds_read_b64_tr_b16 v[218:219], v11 offset:37376
  v_mfma_f32_32x32x16_bf16 v[192:207], v[236:239], v[52:55], v[192:207]
  ds_read_b64_tr_b16 v[220:221], v12 offset:36864
  ds_read_b64_tr_b16 v[222:223], v12 offset:37376
  s_waitcnt lgkmcnt(0)
  v_mfma_f32_32x32x16_bf16 v[144:159], v[208:211], v[56:59], v[144:159]
  ds_read_b64_tr_b16 v[224:225], v9 offset:38912
  ds_read_b64_tr_b16 v[226:227], v9 offset:39424
  ds_read_b64_tr_b16 v[228:229], v10 offset:38912
  v_mfma_f32_32x32x16_bf16 v[160:175], v[212:215], v[56:59], v[160:175]
  ds_read_b64_tr_b16 v[230:231], v10 offset:39424
  ds_read_b64_tr_b16 v[232:233], v11 offset:38912
  v_mfma_f32_32x32x16_bf16 v[176:191], v[216:219], v[56:59], v[176:191]
  ds_read_b64_tr_b16 v[234:235], v11 offset:39424
  ds_read_b64_tr_b16 v[236:237], v12 offset:38912
  v_mfma_f32_32x32x16_bf16 v[192:207], v[220:223], v[56:59], v[192:207]
  ds_read_b64_tr_b16 v[238:239], v12 offset:39424
  ds_read_b32 v14, v2 offset:0
  s_waitcnt lgkmcnt(0)
  s_setprio 2
  v_cmp_gt_u32 vcc, 20, v14
  s_setprio 0
  s_cbranch_vccnz gs2_spin
gs2_ok:
  v_mfma_f32_32x32x16_bf16 v[144:159], v[224:227], v[60:63], v[144:159]
  ds_read_b64_tr_b16 v[208:209], v9 offset:49152
  ds_read_b64_tr_b16 v[210:211], v9 offset:49664
  v_mfma_f32_32x32x16_bf16 v[160:175], v[228:231], v[60:63], v[160:175]
  ds_read_b64_tr_b16 v[212:213], v10 offset:49152
  ds_read_b64_tr_b16 v[214:215], v10 offset:49664
  v_mfma_f32_32x32x16_bf16 v[176:191], v[232:235], v[60:63], v[176:191]
  ds_read_b64_tr_b16 v[216:217], v11 offset:49152
  ds_read_b64_tr_b16 v[218:219], v11 offset:49664
  v_mfma_f32_32x32x16_bf16 v[192:207], v[236:239], v[60:63], v[192:207]
  ds_read_b64_tr_b16 v[220:221], v12 offset:49152
  ds_read_b64_tr_b16 v[222:223], v12 offset:49664
  s_waitcnt lgkmcnt(0)
  v_mfma_f32_32x32x16_bf16 v[144:159], v[208:211], v[64:67], v[144:159]
  s_add_u32 s59, s68, s71
  s_add_u32 m0, s6, 16384
  s_add_u32 s60, s59, 0
  buffer_load_dwordx4 v252, s[24:27], s60 offen lds
  s_add_u32 m0, s6, 17408
  s_add_u32 s60, s59, 28672
  v_mfma_f32_32x32x16_bf16 v[160:175], v[212:215], v[64:67], v[160:175]
  buffer_load_dwordx4 v252, s[24:27], s60 offen lds
  s_add_u32 m0, s6, 24576
  s_add_u32 s60, s59, 0
  buffer_load_dwordx4 v253, s[28:31], s60 offen lds
  s_add_u32 m0, s6, 25600
  s_add_u32 s60, s59, 28672
  v_mfma_f32_32x32x16_bf16 v[176:191], v[216:219], v[64:67], v[176:191]
  buffer_load_dwordx4 v253, s[28:31], s60 offen lds
  s_add_u32 s71, s71, 229376
  s_cmp_eq_u32 s71, 1835008
  s_cselect_b32 s71, 0, s71
  ds_read_b64_tr_b16 v[224:225], v9 offset:51200
  ds_read_b64_tr_b16 v[226:227], v9 offset:51712
  v_mfma_f32_32x32x16_bf16 v[192:207], v[220:223], v[64:67], v[192:207]
  ds_read_b64_tr_b16 v[228:229], v10 offset:51200
  ds_read_b64_tr_b16 v[230:231], v10 offset:51712
  ds_read_b64_tr_b16 v[232:233], v11 offset:51200
  ds_read_b64_tr_b16 v[234:235], v11 offset:51712
  ds_read_b64_tr_b16 v[236:237], v12 offset:51200
  ds_read_b64_tr_b16 v[238:239], v12 offset:51712
  s_waitcnt lgkmcnt(0)
  v_mfma_f32_32x32x16_bf16 v[144:159], v[224:227], v[68:71], v[144:159]
  s_waitcnt vmcnt(4)
  s_mov_b64 exec, 1
  ds_add_u32 v2, v3 offset:0
  s_mov_b64 exec, -1
  ds_read_b64_tr_b16 v[208:209], v9 offset:53248
  ds_read_b64_tr_b16 v[210:211], v9 offset:53760
  v_mfma_f32_32x32x16_bf16 v[160:175], v[228:231], v[68:71], v[160:175]
  ds_read_b64_tr_b16 v[212:213], v10 offset:53248
  ds_read_b64_tr_b16 v[214:215], v10 offset:53760
  v_mfma_f32_32x32x16_bf16 v[176:191], v[232:235], v[68:71], v[176:191]
  ds_read_b64_tr_b16 v[216:217], v11 offset:53248
  ds_read_b64_tr_b16 v[218:219], v11 offset:53760
  v_mfma_f32_32x32x16_bf16 v[192:207], v[236:239], v[68:71], v[192:207]
  ds_read_b64_tr_b16 v[220:221], v12 offset:53248
  ds_read_b64_tr_b16 v[222:223], v12 offset:53760
  s_waitcnt lgkmcnt(0)
  v_mfma_f32_32x32x16_bf16 v[144:159], v[208:211], v[72:75], v[144:159]
  ds_read_b64_tr_b16 v[224:225], v9 offset:55296
  ds_read_b64_tr_b16 v[226:227], v9 offset:55808
  ds_read_b64_tr_b16 v[228:229], v10 offset:55296
  v_mfma_f32_32x32x16_bf16 v[160:175], v[212:215], v[72:75], v[160:175]
  ds_read_b64_tr_b16 v[230:231], v10 offset:55808
  ds_read_b64_tr_b16 v[232:233], v11 offset:55296
  v_mfma_f32_32x32x16_bf16 v[176:191], v[216:219], v[72:75], v[176:191]
  ds_read_b64_tr_b16 v[234:235], v11 offset:55808
  ds_read_b64_tr_b16 v[236:237], v12 offset:55296
  v_mfma_f32_32x32x16_bf16 v[192:207], v[220:223], v[72:75], v[192:207]
  ds_read_b64_tr_b16 v[238:239], v12 offset:55808
  ds_read_b32 v14, v2 offset:0
  s_waitcnt lgkmcnt(0)
  s_setprio 2
  v_cmp_gt_u32 vcc, 24, v14
  s_setprio 0
  s_cbranch_vccnz gs3_spin
gs3_ok:
  v_mfma_f32_32x32x16_bf16 v[144:159], v[224:227], v[76:79], v[144:159]
  ds_read_b64_tr_b16 v[208:209], v9 offset:0
  ds_read_b64_tr_b16 v[210:211], v9 offset:512
  v_mfma_f32_32x32x16_bf16 v[160:175], v[228:231], v[76:79], v[160:175]
  ds_read_b64_tr_b16 v[212:213], v10 offset:0
  ds_read_b64_tr_b16 v[214:215], v10 offset:512
  v_mfma_f32_32x32x16_bf16 v[176:191], v[232:235], v[76:79], v[176:191]
  ds_read_b64_tr_b16 v[216:217], v11 offset:0
  ds_read_b64_tr_b16 v[218:219], v11 offset:512
  v_mfma_f32_32x32x16_bf16 v[192:207], v[236:239], v[76:79], v[192:207]
  ds_read_b64_tr_b16 v[220:221], v12 offset:0
  ds_read_b64_tr_b16 v[222:223], v12 offset:512
  s_waitcnt lgkmcnt(0)
  v_mfma_f32_32x32x16_bf16 v[144:159], v[208:211], v[80:83], v[144:159]
  s_add_u32 s59, s68, s71
  s_add_u32 m0, s6, 32768
  s_add_u32 s60, s59, 0
  buffer_load_dwordx4 v252, s[24:27], s60 offen lds
  s_add_u32 m0, s6, 33792
  s_add_u32 s60, s59, 28672
  v_mfma_f32_32x32x16_bf16 v[160:175], v[212:215], v[80:83], v[160:175]
  buffer_load_dwordx4 v252, s[24:27], s60 offen lds
  s_add_u32 m0, s6, 40960
  s_add_u32 s60, s59, 0
  buffer_load_dwordx4 v253, s[28:31], s60 offen lds
  s_add_u32 m0, s6, 41984
  s_add_u32 s60, s59, 28672
  v_mfma_f32_32x32x16_bf16 v[176:191], v[216:219], v[80:83], v[176:191]
  buffer_load_dwordx4 v253, s[28:31], s60 offen lds
  s_add_u32 s71, s71, 229376
  s_cmp_eq_u32 s71, 1835008
  s_cselect_b32 s71, 0, s71
  ds_read_b64_tr_b16 v[224:225], v9 offset:2048
  ds_read_b64_tr_b16 v[226:227], v9 offset:2560
  v_mfma_f32_32x32x16_bf16 v[192:207], v[220:223], v[80:83], v[192:207]
  ds_read_b64_tr_b16 v[228:229], v10 offset:2048
  ds_read_b64_tr_b16 v[230:231], v10 offset:2560
  ds_read_b64_tr_b16 v[232:233], v11 offset:2048
  ds_read_b64_tr_b16 v[234:235], v11 offset:2560
  ds_read_b64_tr_b16 v[236:237], v12 offset:2048
  ds_read_b64_tr_b16 v[238:239], v12 offset:2560
  s_waitcnt lgkmcnt(0)
  v_mfma_f32_32x32x16_bf16 v[144:159], v[224:227], v[84:87], v[144:159]
  s_waitcnt vmcnt(4)
  s_mov_b64 exec, 1
  ds_add_u32 v2, v3 offset:0
  s_mov_b64 exec, -1
  ds_read_b64_tr_b16 v[208:209], v9 offset:4096
  ds_read_b64_tr_b16 v[210:211], v9 offset:4608
  v_mfma_f32_32x32x16_bf16 v[160:175], v[228:231], v[84:87], v[160:175]
  ds_read_b64_tr_b16 v[212:213], v10 offset:4096
  ds_read_b64_tr_b16 v[214:215], v10 offset:4608
  v_mfma_f32_32x32x16_bf16 v[176:191], v[232:235], v[84:87], v[176:191]
  ds_read_b64_tr_b16 v[216:217], v11 offset:4096
  ds_read_b64_tr_b16 v[218:219], v11 offset:4608
  v_mfma_f32_32x32x16_bf16 v[192:207], v[236:239], v[84:87], v[192:207]
  ds_read_b64_tr_b16 v[220:221], v12 offset:4096
  ds_read_b64_tr_b16 v[222:223], v12 offset:4608
  s_setprio 2
  v_xor_b32 v7, s61, v245
  v_xor_b32 v247, s61, v247
  v_or_b32 v7, v7, v247
  v_xor_b32 v249, s61, v249
  v_or_b32 v7, v7, v249
  v_xor_b32 v251, s61, v251
  v_or_b32 v7, v7, v251
  v_cmp_ne_u32 vcc, 0, v7
  s_cbranch_vccnz gcs_spin
gcs_ok:
  v_add_f32 v244, v244, v246
  v_add_f32 v248, v248, v250
  v_mov_b32 v245, v244
  v_mov_b32 v249, v248
  s_lshl_b32 s57, s52, 10
  s_add_u32 s57, s57, 147456
  v_add_u32 v7, s57, v1
  v_permlane32_swap_b32 v244, v245
  v_permlane32_swap_b32 v248, v249
  v_cmp_gt_u32 vcc, 32, v0
  v_add_f32 v5, v244, v245
  v_add_f32 v6, v248, v249
  v_cvt_pk_bf16_f32 v244, v5, v5
  v_and_b32 v247, s64, v244
  v_sub_f32 v5, v5, v247
  v_cvt_pk_bf16_f32 v245, v5, v5
  v_and_b32 v247, s64, v245
  v_sub_f32 v5, v5, v247
  v_cvt_pk_bf16_f32 v246, v5, v5
  v_bfi_b32 v249, s79, v244, v245
  v_cndmask_b32 v248, 0, v244, vcc
  v_cndmask_b32 v249, 0, v249, vcc
  v_cndmask_b32 v250, 0, v245, vcc
  v_cndmask_b32 v251, 0, v246, vcc
  ds_write_b128 v7, v[248:251] offset:0
  s_waitcnt lgkmcnt(0)
  v_cvt_pk_bf16_f32 v244, v6, v6
  v_and_b32 v247, s64, v244
  v_sub_f32 v6, v6, v247
  v_cvt_pk_bf16_f32 v245, v6, v6
  v_and_b32 v247, s64, v245
  v_sub_f32 v6, v6, v247
  v_cvt_pk_bf16_f32 v246, v6, v6
  v_bfi_b32 v249, s79, v244, v245
  v_cndmask_b32 v248, 0, v244, vcc
  v_cndmask_b32 v249, 0, v249, vcc
  v_cndmask_b32 v250, 0, v245, vcc
  v_cndmask_b32 v251, 0, v246, vcc
  ds_write_b128 v7, v[248:251] offset:4096
  s_setprio 0
  v_mfma_f32_32x32x16_bf16 v[144:159], v[208:211], v[88:91], v[144:159]
  ds_read_b64_tr_b16 v[224:225], v9 offset:6144
  ds_read_b64_tr_b16 v[226:227], v9 offset:6656
  ds_read_b64_tr_b16 v[228:229], v10 offset:6144
  v_mfma_f32_32x32x16_bf16 v[160:175], v[212:215], v[88:91], v[160:175]
  ds_read_b64_tr_b16 v[230:231], v10 offset:6656
  ds_read_b64_tr_b16 v[232:233], v11 offset:6144
  v_mfma_f32_32x32x16_bf16 v[176:191], v[216:219], v[88:91], v[176:191]
  ds_read_b64_tr_b16 v[234:235], v11 offset:6656
  ds_read_b64_tr_b16 v[236:237], v12 offset:6144
  v_mfma_f32_32x32x16_bf16 v[192:207], v[220:223], v[88:91], v[192:207]
  ds_read_b64_tr_b16 v[238:239], v12 offset:6656
  ds_read_b32 v14, v2 offset:0
  s_waitcnt lgkmcnt(0)
  s_setprio 2
  v_cmp_gt_u32 vcc, 28, v14
  s_setprio 0
  s_cbranch_vccnz gs4_spin
gs4_ok:
  v_mfma_f32_32x32x16_bf16 v[144:159], v[224:227], v[92:95], v[144:159]
  ds_read_b64_tr_b16 v[208:209], v9 offset:16384
  ds_read_b64_tr_b16 v[210:211], v9 offset:16896
  v_mfma_f32_32x32x16_bf16 v[160:175], v[228:231], v[92:95], v[160:175]
  ds_read_b64_tr_b16 v[212:213], v10 offset:16384
  ds_read_b64_tr_b16 v[214:215], v10 offset:16896
  v_mfma_f32_32x32x16_bf16 v[176:191], v[232:235], v[92:95], v[176:191]
  ds_read_b64_tr_b16 v[216:217], v11 offset:16384
  ds_read_b64_tr_b16 v[218:219], v11 offset:16896
  v_mfma_f32_32x32x16_bf16 v[192:207], v[236:239], v[92:95], v[192:207]
  ds_read_b64_tr_b16 v[220:221], v12 offset:16384
  ds_read_b64_tr_b16 v[222:223], v12 offset:16896
  s_waitcnt lgkmcnt(0)
  v_mfma_f32_32x32x16_bf16 v[144:159], v[208:211], v[96:99], v[144:159]
  s_add_u32 s59, s68, s71
  s_add_u32 m0, s6, 49152
  s_add_u32 s60, s59, 0
  buffer_load_dwordx4 v252, s[24:27], s60 offen lds
  s_add_u32 m0, s6, 50176
  s_add_u32 s60, s59, 28672
  v_mfma_f32_32x32x16_bf16 v[160:175], v[212:215], v[96:99], v[160:175]
  buffer_load_dwordx4 v252, s[24:27], s60 offen lds
  s_add_u32 m0, s6, 57344
  s_add_u32 s60, s59, 0
  buffer_load_dwordx4 v253, s[28:31], s60 offen lds
  s_add_u32 m0, s6, 58368
  s_add_u32 s60, s59, 28672
  v_mfma_f32_32x32x16_bf16 v[176:191], v[216:219], v[96:99], v[176:191]
  buffer_load_dwordx4 v253, s[28:31], s60 offen lds
  s_add_u32 s71, s71, 229376
  s_cmp_eq_u32 s71, 1835008
  s_cselect_b32 s71, 0, s71
  ds_read_b64_tr_b16 v[224:225], v9 offset:18432
  ds_read_b64_tr_b16 v[226:227], v9 offset:18944
  v_mfma_f32_32x32x16_bf16 v[192:207], v[220:223], v[96:99], v[192:207]
  ds_read_b64_tr_b16 v[228:229], v10 offset:18432
  ds_read_b64_tr_b16 v[230:231], v10 offset:18944
  ds_read_b64_tr_b16 v[232:233], v11 offset:18432
  ds_read_b64_tr_b16 v[234:235], v11 offset:18944
  ds_read_b64_tr_b16 v[236:237], v12 offset:18432
  ds_read_b64_tr_b16 v[238:239], v12 offset:18944
  s_waitcnt lgkmcnt(0)
  v_mfma_f32_32x32x16_bf16 v[144:159], v[224:227], v[100:103], v[144:159]
  s_waitcnt vmcnt(4)
  s_mov_b64 exec, 1
  ds_add_u32 v2, v3 offset:0
  s_mov_b64 exec, -1
  ds_read_b64_tr_b16 v[208:209], v9 offset:20480
  ds_read_b64_tr_b16 v[210:211], v9 offset:20992
  v_mfma_f32_32x32x16_bf16 v[160:175], v[228:231], v[100:103], v[160:175]
  ds_read_b64_tr_b16 v[212:213], v10 offset:20480
  ds_read_b64_tr_b16 v[214:215], v10 offset:20992
  v_mfma_f32_32x32x16_bf16 v[176:191], v[232:235], v[100:103], v[176:191]
  ds_read_b64_tr_b16 v[216:217], v11 offset:20480
  ds_read_b64_tr_b16 v[218:219], v11 offset:20992
  v_mfma_f32_32x32x16_bf16 v[192:207], v[236:239], v[100:103], v[192:207]
  ds_read_b64_tr_b16 v[220:221], v12 offset:20480
  ds_read_b64_tr_b16 v[222:223], v12 offset:20992
  s_waitcnt lgkmcnt(0)
  v_mfma_f32_32x32x16_bf16 v[144:159], v[208:211], v[104:107], v[144:159]
  ds_read_b64_tr_b16 v[224:225], v9 offset:22528
  ds_read_b64_tr_b16 v[226:227], v9 offset:23040
  ds_read_b64_tr_b16 v[228:229], v10 offset:22528
  v_mfma_f32_32x32x16_bf16 v[160:175], v[212:215], v[104:107], v[160:175]
  ds_read_b64_tr_b16 v[230:231], v10 offset:23040
  ds_read_b64_tr_b16 v[232:233], v11 offset:22528
  v_mfma_f32_32x32x16_bf16 v[176:191], v[216:219], v[104:107], v[176:191]
  ds_read_b64_tr_b16 v[234:235], v11 offset:23040
  ds_read_b64_tr_b16 v[236:237], v12 offset:22528
  v_mfma_f32_32x32x16_bf16 v[192:207], v[220:223], v[104:107], v[192:207]
  ds_read_b64_tr_b16 v[238:239], v12 offset:23040
  ds_read_b32 v14, v2 offset:0
  s_cmp_lg_u32 s52, 0
  s_cbranch_scc1 g_tw5_0
  s_and_b32 s57, s55, 7
  s_mul_i32 s57, s57, 229376
  s_add_u32 s57, s57, 0
  s_lshl_b32 s58, s56, 7
  s_add_u32 s57, s57, s58
  s_setprio 2
  v_lshlrev_b32 v7, 10, v0
  s_setprio 0
  buffer_load_dword v8, v7, s[36:39], s57 offen
g_tw5_0:
  s_cmp_lg_u32 s52, 1
  s_cbranch_scc1 g_tw5_1
  s_and_b32 s57, s55, 7
  s_mul_i32 s57, s57, 229376
  s_add_u32 s57, s57, 65536
  s_lshl_b32 s58, s56, 7
  s_add_u32 s57, s57, s58
  s_setprio 2
  v_lshlrev_b32 v7, 10, v0
  s_setprio 0
  buffer_load_dword v8, v7, s[36:39], s57 offen
g_tw5_1:
  s_cmp_lg_u32 s52, 2
  s_cbranch_scc1 g_tw5_2
  s_and_b32 s57, s55, 7
  s_mul_i32 s57, s57, 229376
  s_add_u32 s57, s57, 131072
  s_lshl_b32 s58, s56, 7
  s_add_u32 s57, s57, s58
  s_setprio 2
  v_lshlrev_b32 v7, 10, v0
  s_setprio 0
  buffer_load_dword v8, v7, s[36:39], s57 offen
g_tw5_2:
  s_cmp_lg_u32 s52, 3
  s_cbranch_scc1 g_tw5_3
  s_and_b32 s57, s55, 7
  s_mul_i32 s57, s57, 229376
  s_add_u32 s57, s57, 196608
  s_lshl_b32 s58, s56, 7
  s_add_u32 s57, s57, s58
  s_setprio 2
  v_lshlrev_b32 v7, 10, v0
  s_setprio 0
  s_mov_b32 exec_lo, 0xffffffff
  s_mov_b32 exec_hi, 0x0
  buffer_load_dword v8, v7, s[36:39], s57 offen
  s_mov_b64 exec, -1
g_tw5_3:
  s_cmp_lg_u32 s52, 0
  s_cbranch_scc1 g_tw5_4
  s_and_b32 s57, s55, 7
  s_mul_i32 s57, s57, 65536
  s_add_u32 s57, s57, 0
  s_lshl_b32 s58, s56, 7
  s_add_u32 s57, s57, s58
  s_setprio 2
  v_lshlrev_b32 v7, 10, v0
  s_setprio 0
  buffer_load_dword v8, v7, s[40:43], s57 offen
g_tw5_4:
  s_waitcnt lgkmcnt(0)
  s_setprio 2
  v_cmp_gt_u32 vcc, 32, v14
  s_setprio 0
  s_cbranch_vccnz gs5_spin
gs5_ok:
  v_mfma_f32_32x32x16_bf16 v[144:159], v[224:227], v[108:111], v[144:159]
  ds_read_b64_tr_b16 v[208:209], v9 offset:32768
  ds_read_b64_tr_b16 v[210:211], v9 offset:33280
  v_mfma_f32_32x32x16_bf16 v[160:175], v[228:231], v[108:111], v[160:175]
  ds_read_b64_tr_b16 v[212:213], v10 offset:32768
  ds_read_b64_tr_b16 v[214:215], v10 offset:33280
  v_mfma_f32_32x32x16_bf16 v[176:191], v[232:235], v[108:111], v[176:191]
  ds_read_b64_tr_b16 v[216:217], v11 offset:32768
  ds_read_b64_tr_b16 v[218:219], v11 offset:33280
  v_mfma_f32_32x32x16_bf16 v[192:207], v[236:239], v[108:111], v[192:207]
  ds_read_b64_tr_b16 v[220:221], v12 offset:32768
  ds_read_b64_tr_b16 v[222:223], v12 offset:33280
  s_waitcnt lgkmcnt(0)
  v_mfma_f32_32x32x16_bf16 v[144:159], v[208:211], v[112:115], v[144:159]
  s_add_u32 s59, s68, s71
  s_add_u32 m0, s6, 0
  s_add_u32 s60, s59, 0
  buffer_load_dwordx4 v254, s[24:27], s60 offen lds
  s_add_u32 m0, s6, 1024
  s_add_u32 s60, s59, 28672
  v_mfma_f32_32x32x16_bf16 v[160:175], v[212:215], v[112:115], v[160:175]
  buffer_load_dwordx4 v254, s[24:27], s60 offen lds
  s_add_u32 m0, s6, 8192
  s_add_u32 s60, s59, 0
  buffer_load_dwordx4 v255, s[28:31], s60 offen lds
  s_add_u32 m0, s6, 9216
  s_add_u32 s60, s59, 28672
  v_mfma_f32_32x32x16_bf16 v[176:191], v[216:219], v[112:115], v[176:191]
  buffer_load_dwordx4 v255, s[28:31], s60 offen lds
  s_add_u32 s71, s71, 229376
  s_cmp_eq_u32 s71, 1835008
  s_cselect_b32 s71, 0, s71
  ds_read_b64_tr_b16 v[224:225], v9 offset:34816
  ds_read_b64_tr_b16 v[226:227], v9 offset:35328
  v_mfma_f32_32x32x16_bf16 v[192:207], v[220:223], v[112:115], v[192:207]
  ds_read_b64_tr_b16 v[228:229], v10 offset:34816
  ds_read_b64_tr_b16 v[230:231], v10 offset:35328
  ds_read_b64_tr_b16 v[232:233], v11 offset:34816
  ds_read_b64_tr_b16 v[234:235], v11 offset:35328
  ds_read_b64_tr_b16 v[236:237], v12 offset:34816
  ds_read_b64_tr_b16 v[238:239], v12 offset:35328
  s_waitcnt lgkmcnt(0)
  v_mfma_f32_32x32x16_bf16 v[144:159], v[224:227], v[116:119], v[144:159]
  s_waitcnt vmcnt(4)
  s_mov_b64 exec, 1
  ds_add_u32 v2, v3 offset:0
  s_mov_b64 exec, -1
  ds_read_b64_tr_b16 v[208:209], v9 offset:36864
  ds_read_b64_tr_b16 v[210:211], v9 offset:37376
  v_mfma_f32_32x32x16_bf16 v[160:175], v[228:231], v[116:119], v[160:175]
  ds_read_b64_tr_b16 v[212:213], v10 offset:36864
  ds_read_b64_tr_b16 v[214:215], v10 offset:37376
  v_mfma_f32_32x32x16_bf16 v[176:191], v[232:235], v[116:119], v[176:191]
  ds_read_b64_tr_b16 v[216:217], v11 offset:36864
  ds_read_b64_tr_b16 v[218:219], v11 offset:37376
  v_mfma_f32_32x32x16_bf16 v[192:207], v[236:239], v[116:119], v[192:207]
  ds_read_b64_tr_b16 v[220:221], v12 offset:36864
  ds_read_b64_tr_b16 v[222:223], v12 offset:37376
  s_waitcnt lgkmcnt(0)
  v_mfma_f32_32x32x16_bf16 v[144:159], v[208:211], v[120:123], v[144:159]
  ds_read_b64_tr_b16 v[224:225], v9 offset:38912
  ds_read_b64_tr_b16 v[226:227], v9 offset:39424
  ds_read_b64_tr_b16 v[228:229], v10 offset:38912
  v_mfma_f32_32x32x16_bf16 v[160:175], v[212:215], v[120:123], v[160:175]
  ds_read_b64_tr_b16 v[230:231], v10 offset:39424
  ds_read_b64_tr_b16 v[232:233], v11 offset:38912
  v_mfma_f32_32x32x16_bf16 v[176:191], v[216:219], v[120:123], v[176:191]
  ds_read_b64_tr_b16 v[234:235], v11 offset:39424
  ds_read_b64_tr_b16 v[236:237], v12 offset:38912
  v_mfma_f32_32x32x16_bf16 v[192:207], v[220:223], v[120:123], v[192:207]
  ds_read_b64_tr_b16 v[238:239], v12 offset:39424
  ds_read_b32 v14, v2 offset:0
  s_waitcnt lgkmcnt(0)
  s_setprio 2
  v_cmp_gt_u32 vcc, 36, v14
  s_setprio 0
  s_cbranch_vccnz gs6_spin
gs6_ok:
  v_mfma_f32_32x32x16_bf16 v[144:159], v[224:227], v[124:127], v[144:159]
  ds_read_b64_tr_b16 v[208:209], v9 offset:49152
  ds_read_b64_tr_b16 v[210:211], v9 offset:49664
  v_mfma_f32_32x32x16_bf16 v[160:175], v[228:231], v[124:127], v[160:175]
  ds_read_b64_tr_b16 v[212:213], v10 offset:49152
  ds_read_b64_tr_b16 v[214:215], v10 offset:49664
  v_mfma_f32_32x32x16_bf16 v[176:191], v[232:235], v[124:127], v[176:191]
  ds_read_b64_tr_b16 v[216:217], v11 offset:49152
  ds_read_b64_tr_b16 v[218:219], v11 offset:49664
  v_mfma_f32_32x32x16_bf16 v[192:207], v[236:239], v[124:127], v[192:207]
  ds_read_b64_tr_b16 v[220:221], v12 offset:49152
  ds_read_b64_tr_b16 v[222:223], v12 offset:49664
  s_waitcnt lgkmcnt(0)
  v_mfma_f32_32x32x16_bf16 v[144:159], v[208:211], v[128:131], v[144:159]
  s_add_u32 s59, s68, s71
  s_add_u32 m0, s6, 16384
  s_add_u32 s60, s59, 0
  buffer_load_dwordx4 v254, s[24:27], s60 offen lds
  s_add_u32 m0, s6, 17408
  s_add_u32 s60, s59, 28672
  v_mfma_f32_32x32x16_bf16 v[160:175], v[212:215], v[128:131], v[160:175]
  buffer_load_dwordx4 v254, s[24:27], s60 offen lds
  s_add_u32 m0, s6, 24576
  s_add_u32 s60, s59, 0
  buffer_load_dwordx4 v255, s[28:31], s60 offen lds
  s_add_u32 m0, s6, 25600
  s_add_u32 s60, s59, 28672
  v_mfma_f32_32x32x16_bf16 v[176:191], v[216:219], v[128:131], v[176:191]
  buffer_load_dwordx4 v255, s[28:31], s60 offen lds
  s_add_u32 s71, s71, 229376
  s_cmp_eq_u32 s71, 1835008
  s_cselect_b32 s71, 0, s71
  ds_read_b64_tr_b16 v[224:225], v9 offset:51200
  ds_read_b64_tr_b16 v[226:227], v9 offset:51712
  v_mfma_f32_32x32x16_bf16 v[192:207], v[220:223], v[128:131], v[192:207]
  ds_read_b64_tr_b16 v[228:229], v10 offset:51200
  ds_read_b64_tr_b16 v[230:231], v10 offset:51712
  ds_read_b64_tr_b16 v[232:233], v11 offset:51200
  ds_read_b64_tr_b16 v[234:235], v11 offset:51712
  ds_read_b64_tr_b16 v[236:237], v12 offset:51200
  ds_read_b64_tr_b16 v[238:239], v12 offset:51712
  s_waitcnt lgkmcnt(0)
  v_mfma_f32_32x32x16_bf16 v[144:159], v[224:227], v[132:135], v[144:159]
  s_waitcnt vmcnt(4)
  s_mov_b64 exec, 1
  ds_add_u32 v2, v3 offset:0
  s_mov_b64 exec, -1
  ds_read_b64_tr_b16 v[208:209], v9 offset:53248
  ds_read_b64_tr_b16 v[210:211], v9 offset:53760
  v_mfma_f32_32x32x16_bf16 v[160:175], v[228:231], v[132:135], v[160:175]
  ds_read_b64_tr_b16 v[212:213], v10 offset:53248
  ds_read_b64_tr_b16 v[214:215], v10 offset:53760
  v_mfma_f32_32x32x16_bf16 v[176:191], v[232:235], v[132:135], v[176:191]
  ds_read_b64_tr_b16 v[216:217], v11 offset:53248
  ds_read_b64_tr_b16 v[218:219], v11 offset:53760
  v_mfma_f32_32x32x16_bf16 v[192:207], v[236:239], v[132:135], v[192:207]
  ds_read_b64_tr_b16 v[220:221], v12 offset:53248
  ds_read_b64_tr_b16 v[222:223], v12 offset:53760
  s_waitcnt lgkmcnt(0)
  v_mfma_f32_32x32x16_bf16 v[144:159], v[208:211], v[136:139], v[144:159]
  ds_read_b64_tr_b16 v[224:225], v9 offset:55296
  ds_read_b64_tr_b16 v[226:227], v9 offset:55808
  ds_read_b64_tr_b16 v[228:229], v10 offset:55296
  v_mfma_f32_32x32x16_bf16 v[160:175], v[212:215], v[136:139], v[160:175]
  ds_read_b64_tr_b16 v[230:231], v10 offset:55808
  ds_read_b64_tr_b16 v[232:233], v11 offset:55296
  v_mfma_f32_32x32x16_bf16 v[176:191], v[216:219], v[136:139], v[176:191]
  ds_read_b64_tr_b16 v[234:235], v11 offset:55808
  ds_read_b64_tr_b16 v[236:237], v12 offset:55296
  v_mfma_f32_32x32x16_bf16 v[192:207], v[220:223], v[136:139], v[192:207]
  ds_read_b64_tr_b16 v[238:239], v12 offset:55808
  ds_read_b32 v14, v2 offset:0
  s_waitcnt lgkmcnt(0)
  s_setprio 2
  v_cmp_gt_u32 vcc, 40, v14
  s_setprio 0
  s_cbranch_vccnz gs7_spin
gs7_ok:
  v_mfma_f32_32x32x16_bf16 v[144:159], v[224:227], v[140:143], v[144:159]
  v_mfma_f32_32x32x16_bf16 v[160:175], v[228:231], v[140:143], v[160:175]
  v_mfma_f32_32x32x16_bf16 v[176:191], v[232:235], v[140:143], v[176:191]
  v_mfma_f32_32x32x16_bf16 v[192:207], v[236:239], v[140:143], v[192:207]
  s_add_u32 s59, s68, s71
  s_add_u32 m0, s6, 32768
  s_add_u32 s60, s59, 0
  buffer_load_dwordx4 v254, s[24:27], s60 offen lds
  s_add_u32 m0, s6, 33792
  s_add_u32 s60, s59, 28672
  buffer_load_dwordx4 v254, s[24:27], s60 offen lds
  s_add_u32 m0, s6, 40960
  s_add_u32 s60, s59, 0
  buffer_load_dwordx4 v255, s[28:31], s60 offen lds
  s_add_u32 m0, s6, 41984
  s_add_u32 s60, s59, 28672
  buffer_load_dwordx4 v255, s[28:31], s60 offen lds
  s_add_u32 s71, s71, 229376
  s_cmp_eq_u32 s71, 1835008
  s_cselect_b32 s71, 0, s71
  s_setprio 2
  v_add_u32 v7, 147456, v1
  ds_read_b128 v[208:211], v7 offset:0
  ds_read_b128 v[212:215], v7 offset:1024
  ds_read_b128 v[216:219], v7 offset:2048
  ds_read_b128 v[220:223], v7 offset:3072
  s_waitcnt lgkmcnt(3)
  v_mfma_f32_32x32x16_bf16 v[144:159], v[208:211], v[240:243], v[144:159]
  s_waitcnt lgkmcnt(2)
  v_mfma_f32_32x32x16_bf16 v[160:175], v[212:215], v[240:243], v[160:175]
  s_waitcnt lgkmcnt(1)
  v_mfma_f32_32x32x16_bf16 v[176:191], v[216:219], v[240:243], v[176:191]
  s_waitcnt lgkmcnt(0)
  v_mfma_f32_32x32x16_bf16 v[192:207], v[220:223], v[240:243], v[192:207]
  s_and_b32 s58, s54, 3
  s_add_u32 s58, s58, 0
  s_lshl_b32 s58, s58, 10
  s_add_u32 s58, s58, s69
  s_nop 7
  v_max_f32 v144, 0, v144
  v_max_f32 v145, 0, v145
  v_max_f32 v146, 0, v146
  v_max_f32 v147, 0, v147
  v_max_f32 v148, 0, v148
  v_max_f32 v149, 0, v149
  v_max_f32 v150, 0, v150
  v_max_f32 v151, 0, v151
  v_pk_mul_f32 v[144:145], v[144:145], v[152:153]
  v_pk_mul_f32 v[146:147], v[146:147], v[154:155]
  v_pk_mul_f32 v[148:149], v[148:149], v[156:157]
  v_pk_mul_f32 v[150:151], v[150:151], v[158:159]
  v_cvt_pk_bf16_f32 v144, v144, v145
  v_cvt_pk_bf16_f32 v145, v146, v147
  v_cvt_pk_bf16_f32 v146, v148, v149
  v_cvt_pk_bf16_f32 v147, v150, v151
  buffer_store_dwordx4 v[144:147], v1, s[32:35], s58 offen sc1
  s_and_b32 s58, s54, 3
  s_add_u32 s58, s58, 1
  s_lshl_b32 s58, s58, 10
  s_add_u32 s58, s58, s69
  v_max_f32 v160, 0, v160
  v_max_f32 v161, 0, v161
  v_max_f32 v162, 0, v162
  v_max_f32 v163, 0, v163
  v_max_f32 v164, 0, v164
  v_max_f32 v165, 0, v165
  v_max_f32 v166, 0, v166
  v_max_f32 v167, 0, v167
  v_pk_mul_f32 v[160:161], v[160:161], v[168:169]
  v_pk_mul_f32 v[162:163], v[162:163], v[170:171]
  v_pk_mul_f32 v[164:165], v[164:165], v[172:173]
  v_pk_mul_f32 v[166:167], v[166:167], v[174:175]
  v_cvt_pk_bf16_f32 v160, v160, v161
  v_cvt_pk_bf16_f32 v161, v162, v163
  v_cvt_pk_bf16_f32 v162, v164, v165
  v_cvt_pk_bf16_f32 v163, v166, v167
  buffer_store_dwordx4 v[160:163], v1, s[32:35], s58 offen sc1
  s_and_b32 s58, s54, 3
  s_add_u32 s58, s58, 2
  s_lshl_b32 s58, s58, 10
  s_add_u32 s58, s58, s69
  v_max_f32 v176, 0, v176
  v_max_f32 v177, 0, v177
  v_max_f32 v178, 0, v178
  v_max_f32 v179, 0, v179
  v_max_f32 v180, 0, v180
  v_max_f32 v181, 0, v181
  v_max_f32 v182, 0, v182
  v_max_f32 v183, 0, v183
  v_pk_mul_f32 v[176:177], v[176:177], v[184:185]
  v_pk_mul_f32 v[178:179], v[178:179], v[186:187]
  v_pk_mul_f32 v[180:181], v[180:181], v[188:189]
  v_pk_mul_f32 v[182:183], v[182:183], v[190:191]
  v_cvt_pk_bf16_f32 v176, v176, v177
  v_cvt_pk_bf16_f32 v177, v178, v179
  v_cvt_pk_bf16_f32 v178, v180, v181
  v_cvt_pk_bf16_f32 v179, v182, v183
  buffer_store_dwordx4 v[176:179], v1, s[32:35], s58 offen sc1
  s_and_b32 s58, s54, 3
  s_add_u32 s58, s58, 3
  s_lshl_b32 s58, s58, 10
  s_add_u32 s58, s58, s69
  v_max_f32 v192, 0, v192
  v_max_f32 v193, 0, v193
  v_max_f32 v194, 0, v194
  v_max_f32 v195, 0, v195
  v_max_f32 v196, 0, v196
  v_max_f32 v197, 0, v197
  v_max_f32 v198, 0, v198
  v_max_f32 v199, 0, v199
  v_pk_mul_f32 v[192:193], v[192:193], v[200:201]
  v_pk_mul_f32 v[194:195], v[194:195], v[202:203]
  v_pk_mul_f32 v[196:197], v[196:197], v[204:205]
  v_pk_mul_f32 v[198:199], v[198:199], v[206:207]
  v_cvt_pk_bf16_f32 v192, v192, v193
  v_cvt_pk_bf16_f32 v193, v194, v195
  v_cvt_pk_bf16_f32 v194, v196, v197
  v_cvt_pk_bf16_f32 v195, v198, v199
  buffer_store_dwordx4 v[192:195], v1, s[32:35], s58 offen sc1
  s_setprio 0
  ds_read_b64_tr_b16 v[208:209], v9 offset:0
  ds_read_b64_tr_b16 v[210:211], v9 offset:512
  ds_read_b64_tr_b16 v[212:213], v10 offset:0
  ds_read_b64_tr_b16 v[214:215], v10 offset:512
  ds_read_b64_tr_b16 v[216:217], v11 offset:0
  ds_read_b64_tr_b16 v[218:219], v11 offset:512
  s_waitcnt lgkmcnt(0)
  v_mfma_f32_32x32x16_bf16 v[144:159], v[208:211], v[16:19], 0
  ds_read_b64_tr_b16 v[224:225], v9 offset:2048
  ds_read_b64_tr_b16 v[226:227], v9 offset:2560
  v_mfma_f32_32x32x16_bf16 v[160:175], v[212:215], v[16:19], 0
  ds_read_b64_tr_b16 v[228:229], v10 offset:2048
  ds_read_b64_tr_b16 v[230:231], v10 offset:2560
  v_mfma_f32_32x32x16_bf16 v[176:191], v[216:219], v[16:19], 0
  ds_read_b64_tr_b16 v[232:233], v11 offset:2048
  ds_read_b64_tr_b16 v[234:235], v11 offset:2560
  s_waitcnt lgkmcnt(0)
  v_mfma_f32_32x32x16_bf16 v[144:159], v[224:227], v[20:23], v[144:159]
  s_waitcnt vmcnt(8)
  s_mov_b64 exec, 1
  ds_add_u32 v2, v3 offset:0
  s_mov_b64 exec, -1
  ds_read_b64_tr_b16 v[208:209], v9 offset:4096
  ds_read_b64_tr_b16 v[210:211], v9 offset:4608
  v_mfma_f32_32x32x16_bf16 v[160:175], v[228:231], v[20:23], v[160:175]
  ds_read_b64_tr_b16 v[212:213], v10 offset:4096
  ds_read_b64_tr_b16 v[214:215], v10 offset:4608
  v_mfma_f32_32x32x16_bf16 v[176:191], v[232:235], v[20:23], v[176:191]
  ds_read_b64_tr_b16 v[216:217], v11 offset:4096
  ds_read_b64_tr_b16 v[218:219], v11 offset:4608
  s_waitcnt lgkmcnt(0)
  v_mfma_f32_32x32x16_bf16 v[144:159], v[208:211], v[24:27], v[144:159]
  ds_read_b64_tr_b16 v[224:225], v9 offset:6144
  ds_read_b64_tr_b16 v[226:227], v9 offset:6656
  ds_read_b64_tr_b16 v[228:229], v10 offset:6144
  v_mfma_f32_32x32x16_bf16 v[160:175], v[212:215], v[24:27], v[160:175]
  ds_read_b64_tr_b16 v[230:231], v10 offset:6656
  ds_read_b64_tr_b16 v[232:233], v11 offset:6144
  v_mfma_f32_32x32x16_bf16 v[176:191], v[216:219], v[24:27], v[176:191]
  ds_read_b64_tr_b16 v[234:235], v11 offset:6656
  ds_read_b32 v14, v2 offset:0
  s_waitcnt lgkmcnt(0)
  s_setprio 2
  v_cmp_gt_u32 vcc, 44, v14
  s_setprio 0
  s_cbranch_vccnz gs8_spin
gs8_ok:
  v_mfma_f32_32x32x16_bf16 v[144:159], v[224:227], v[28:31], v[144:159]
  ds_read_b64_tr_b16 v[208:209], v9 offset:16384
  ds_read_b64_tr_b16 v[210:211], v9 offset:16896
  v_mfma_f32_32x32x16_bf16 v[160:175], v[228:231], v[28:31], v[160:175]
  ds_read_b64_tr_b16 v[212:213], v10 offset:16384
  ds_read_b64_tr_b16 v[214:215], v10 offset:16896
  v_mfma_f32_32x32x16_bf16 v[176:191], v[232:235], v[28:31], v[176:191]
  ds_read_b64_tr_b16 v[216:217], v11 offset:16384
  ds_read_b64_tr_b16 v[218:219], v11 offset:16896
  s_waitcnt lgkmcnt(0)
  v_mfma_f32_32x32x16_bf16 v[144:159], v[208:211], v[32:35], v[144:159]
  s_add_u32 s59, s68, s71
  s_add_u32 m0, s6, 49152
  s_add_u32 s60, s59, 0
  buffer_load_dwordx4 v254, s[24:27], s60 offen lds
  s_add_u32 m0, s6, 50176
  s_add_u32 s60, s59, 28672
  buffer_load_dwordx4 v254, s[24:27], s60 offen lds
  s_add_u32 m0, s6, 57344
  v_mfma_f32_32x32x16_bf16 v[160:175], v[212:215], v[32:35], v[160:175]
  s_add_u32 s60, s59, 0
  buffer_load_dwordx4 v255, s[28:31], s60 offen lds
  s_add_u32 m0, s6, 58368
  s_add_u32 s60, s59, 28672
  buffer_load_dwordx4 v255, s[28:31], s60 offen lds
  s_add_u32 s71, s71, 229376
  s_cmp_eq_u32 s71, 1835008
  v_mfma_f32_32x32x16_bf16 v[176:191], v[216:219], v[32:35], v[176:191]
  s_cselect_b32 s71, 0, s71
  ds_read_b64_tr_b16 v[224:225], v9 offset:18432
  ds_read_b64_tr_b16 v[226:227], v9 offset:18944
  ds_read_b64_tr_b16 v[228:229], v10 offset:18432
  ds_read_b64_tr_b16 v[230:231], v10 offset:18944
  ds_read_b64_tr_b16 v[232:233], v11 offset:18432
  ds_read_b64_tr_b16 v[234:235], v11 offset:18944
  s_waitcnt lgkmcnt(0)
  v_mfma_f32_32x32x16_bf16 v[144:159], v[224:227], v[36:39], v[144:159]
  s_waitcnt vmcnt(8)
  s_mov_b64 exec, 1
  ds_add_u32 v2, v3 offset:0
  s_mov_b64 exec, -1
  ds_read_b64_tr_b16 v[208:209], v9 offset:20480
  ds_read_b64_tr_b16 v[210:211], v9 offset:20992
  v_mfma_f32_32x32x16_bf16 v[160:175], v[228:231], v[36:39], v[160:175]
  ds_read_b64_tr_b16 v[212:213], v10 offset:20480
  ds_read_b64_tr_b16 v[214:215], v10 offset:20992
  v_mfma_f32_32x32x16_bf16 v[176:191], v[232:235], v[36:39], v[176:191]
  ds_read_b64_tr_b16 v[216:217], v11 offset:20480
  ds_read_b64_tr_b16 v[218:219], v11 offset:20992
  s_waitcnt lgkmcnt(0)
  v_mfma_f32_32x32x16_bf16 v[144:159], v[208:211], v[40:43], v[144:159]
  ds_read_b64_tr_b16 v[224:225], v9 offset:22528
  ds_read_b64_tr_b16 v[226:227], v9 offset:23040
  ds_read_b64_tr_b16 v[228:229], v10 offset:22528
  v_mfma_f32_32x32x16_bf16 v[160:175], v[212:215], v[40:43], v[160:175]
  ds_read_b64_tr_b16 v[230:231], v10 offset:23040
  ds_read_b64_tr_b16 v[232:233], v11 offset:22528
  v_mfma_f32_32x32x16_bf16 v[176:191], v[216:219], v[40:43], v[176:191]
  ds_read_b64_tr_b16 v[234:235], v11 offset:23040
  ds_read_b32 v14, v2 offset:0
  s_waitcnt lgkmcnt(0)
  s_setprio 2
  v_cmp_gt_u32 vcc, 48, v14
  s_setprio 0
  s_cbranch_vccnz gs9_spin
gs9_ok:
  v_mfma_f32_32x32x16_bf16 v[144:159], v[224:227], v[44:47], v[144:159]
  ds_read_b64_tr_b16 v[208:209], v9 offset:32768
  ds_read_b64_tr_b16 v[210:211], v9 offset:33280
  v_mfma_f32_32x32x16_bf16 v[160:175], v[228:231], v[44:47], v[160:175]
  ds_read_b64_tr_b16 v[212:213], v10 offset:32768
  ds_read_b64_tr_b16 v[214:215], v10 offset:33280
  v_mfma_f32_32x32x16_bf16 v[176:191], v[232:235], v[44:47], v[176:191]
  ds_read_b64_tr_b16 v[216:217], v11 offset:32768
  ds_read_b64_tr_b16 v[218:219], v11 offset:33280
  s_waitcnt lgkmcnt(0)
  v_mfma_f32_32x32x16_bf16 v[144:159], v[208:211], v[48:51], v[144:159]
  s_add_u32 s59, s68, s71
  s_add_u32 m0, s6, 0
  s_add_u32 s60, s59, 0
  buffer_load_dwordx4 v254, s[24:27], s60 offen lds
  s_add_u32 m0, s6, 1024
  s_add_u32 s60, s59, 28672
  buffer_load_dwordx4 v254, s[24:27], s60 offen lds
  s_add_u32 m0, s6, 8192
  v_mfma_f32_32x32x16_bf16 v[160:175], v[212:215], v[48:51], v[160:175]
  s_add_u32 s60, s59, 0
  buffer_load_dwordx4 v255, s[28:31], s60 offen lds
  s_add_u32 m0, s6, 9216
  s_add_u32 s60, s59, 28672
  buffer_load_dwordx4 v255, s[28:31], s60 offen lds
  s_add_u32 s71, s71, 229376
  s_cmp_eq_u32 s71, 1835008
  v_mfma_f32_32x32x16_bf16 v[176:191], v[216:219], v[48:51], v[176:191]
  s_cselect_b32 s71, 0, s71
  ds_read_b64_tr_b16 v[224:225], v9 offset:34816
  ds_read_b64_tr_b16 v[226:227], v9 offset:35328
  ds_read_b64_tr_b16 v[228:229], v10 offset:34816
  ds_read_b64_tr_b16 v[230:231], v10 offset:35328
  ds_read_b64_tr_b16 v[232:233], v11 offset:34816
  ds_read_b64_tr_b16 v[234:235], v11 offset:35328
  s_waitcnt lgkmcnt(0)
  v_mfma_f32_32x32x16_bf16 v[144:159], v[224:227], v[52:55], v[144:159]
  s_waitcnt vmcnt(4)
  s_mov_b64 exec, 1
  ds_add_u32 v2, v3 offset:0
  s_mov_b64 exec, -1
  s_lshl_b32 s57, s53, 11
  s_lshr_b32 s58, s52, 1
  s_lshl_b32 s58, s58, 10
  s_add_u32 s57, s57, s58
  s_and_b32 s58, s52, 1
  s_lshl_b32 s58, s58, 6
  s_add_u32 s57, s57, s58
  s_lshl_b32 s58, s54, 2
  s_add_u32 s57, s57, s58
  s_add_u32 s57, s57, 524288
  s_setprio 2
  v_lshlrev_b32 v7, 7, v0
  s_mov_b64 exec, 0xff
  buffer_atomic_swap v4, v7, s[32:35], s57 offen sc1
  s_mov_b64 exec, -1
  s_setprio 0
  ds_read_b64_tr_b16 v[208:209], v9 offset:36864
  ds_read_b64_tr_b16 v[210:211], v9 offset:37376
  v_mfma_f32_32x32x16_bf16 v[160:175], v[228:231], v[52:55], v[160:175]
  ds_read_b64_tr_b16 v[212:213], v10 offset:36864
  ds_read_b64_tr_b16 v[214:215], v10 offset:37376
  v_mfma_f32_32x32x16_bf16 v[176:191], v[232:235], v[52:55], v[176:191]
  ds_read_b64_tr_b16 v[216:217], v11 offset:36864
  ds_read_b64_tr_b16 v[218:219], v11 offset:37376
  s_waitcnt lgkmcnt(0)
  v_mfma_f32_32x32x16_bf16 v[144:159], v[208:211], v[56:59], v[144:159]
  ds_read_b64_tr_b16 v[224:225], v9 offset:38912
  ds_read_b64_tr_b16 v[226:227], v9 offset:39424
  ds_read_b64_tr_b16 v[228:229], v10 offset:38912
  v_mfma_f32_32x32x16_bf16 v[160:175], v[212:215], v[56:59], v[160:175]
  ds_read_b64_tr_b16 v[230:231], v10 offset:39424
  ds_read_b64_tr_b16 v[232:233], v11 offset:38912
  v_mfma_f32_32x32x16_bf16 v[176:191], v[216:219], v[56:59], v[176:191]
  ds_read_b64_tr_b16 v[234:235], v11 offset:39424
  ds_read_b32 v14, v2 offset:0
  s_waitcnt lgkmcnt(0)
  s_setprio 2
  v_cmp_gt_u32 vcc, 52, v14
  s_setprio 0
  s_cbranch_vccnz gs10_spin
gs10_ok:
  v_mfma_f32_32x32x16_bf16 v[144:159], v[224:227], v[60:63], v[144:159]
  ds_read_b64_tr_b16 v[208:209], v9 offset:49152
  ds_read_b64_tr_b16 v[210:211], v9 offset:49664
  v_mfma_f32_32x32x16_bf16 v[160:175], v[228:231], v[60:63], v[160:175]
  ds_read_b64_tr_b16 v[212:213], v10 offset:49152
  ds_read_b64_tr_b16 v[214:215], v10 offset:49664
  v_mfma_f32_32x32x16_bf16 v[176:191], v[232:235], v[60:63], v[176:191]
  ds_read_b64_tr_b16 v[216:217], v11 offset:49152
  ds_read_b64_tr_b16 v[218:219], v11 offset:49664
  s_waitcnt lgkmcnt(0)
  v_mfma_f32_32x32x16_bf16 v[144:159], v[208:211], v[64:67], v[144:159]
  s_add_u32 s59, s68, s71
  s_add_u32 m0, s6, 16384
  s_add_u32 s60, s59, 0
  buffer_load_dwordx4 v254, s[24:27], s60 offen lds
  s_add_u32 m0, s6, 17408
  s_add_u32 s60, s59, 28672
  buffer_load_dwordx4 v254, s[24:27], s60 offen lds
  s_add_u32 m0, s6, 24576
  v_mfma_f32_32x32x16_bf16 v[160:175], v[212:215], v[64:67], v[160:175]
  s_add_u32 s60, s59, 0
  buffer_load_dwordx4 v255, s[28:31], s60 offen lds
  s_add_u32 m0, s6, 25600
  s_add_u32 s60, s59, 28672
  buffer_load_dwordx4 v255, s[28:31], s60 offen lds
  s_add_u32 s71, s71, 229376
  s_cmp_eq_u32 s71, 1835008
  v_mfma_f32_32x32x16_bf16 v[176:191], v[216:219], v[64:67], v[176:191]
  s_cselect_b32 s71, 0, s71
  ds_read_b64_tr_b16 v[224:225], v9 offset:51200
  ds_read_b64_tr_b16 v[226:227], v9 offset:51712
  ds_read_b64_tr_b16 v[228:229], v10 offset:51200
  ds_read_b64_tr_b16 v[230:231], v10 offset:51712
  ds_read_b64_tr_b16 v[232:233], v11 offset:51200
  ds_read_b64_tr_b16 v[234:235], v11 offset:51712
  s_waitcnt lgkmcnt(0)
  v_mfma_f32_32x32x16_bf16 v[144:159], v[224:227], v[68:71], v[144:159]
  s_waitcnt vmcnt(5)
  s_mov_b64 exec, 1
  ds_add_u32 v2, v3 offset:0
  s_mov_b64 exec, -1
  ds_read_b64_tr_b16 v[208:209], v9 offset:53248
  ds_read_b64_tr_b16 v[210:211], v9 offset:53760
  v_mfma_f32_32x32x16_bf16 v[160:175], v[228:231], v[68:71], v[160:175]
  ds_read_b64_tr_b16 v[212:213], v10 offset:53248
  ds_read_b64_tr_b16 v[214:215], v10 offset:53760
  v_mfma_f32_32x32x16_bf16 v[176:191], v[232:235], v[68:71], v[176:191]
  ds_read_b64_tr_b16 v[216:217], v11 offset:53248
  ds_read_b64_tr_b16 v[218:219], v11 offset:53760
  s_waitcnt lgkmcnt(0)
  v_mfma_f32_32x32x16_bf16 v[144:159], v[208:211], v[72:75], v[144:159]
  ds_read_b64_tr_b16 v[224:225], v9 offset:55296
  ds_read_b64_tr_b16 v[226:227], v9 offset:55808
  ds_read_b64_tr_b16 v[228:229], v10 offset:55296
  v_mfma_f32_32x32x16_bf16 v[160:175], v[212:215], v[72:75], v[160:175]
  ds_read_b64_tr_b16 v[230:231], v10 offset:55808
  ds_read_b64_tr_b16 v[232:233], v11 offset:55296
  v_mfma_f32_32x32x16_bf16 v[176:191], v[216:219], v[72:75], v[176:191]
  ds_read_b64_tr_b16 v[234:235], v11 offset:55808
  ds_read_b32 v14, v2 offset:0
  s_waitcnt lgkmcnt(0)
  s_setprio 2
  v_cmp_gt_u32 vcc, 56, v14
  s_setprio 0
  s_cbranch_vccnz gs11_spin
gs11_ok:
  v_mfma_f32_32x32x16_bf16 v[144:159], v[224:227], v[76:79], v[144:159]
  ds_read_b64_tr_b16 v[208:209], v9 offset:0
  ds_read_b64_tr_b16 v[210:211], v9 offset:512
  v_mfma_f32_32x32x16_bf16 v[160:175], v[228:231], v[76:79], v[160:175]
  ds_read_b64_tr_b16 v[212:213], v10 offset:0
  ds_read_b64_tr_b16 v[214:215], v10 offset:512
  v_mfma_f32_32x32x16_bf16 v[176:191], v[232:235], v[76:79], v[176:191]
  ds_read_b64_tr_b16 v[216:217], v11 offset:0
  ds_read_b64_tr_b16 v[218:219], v11 offset:512
  s_waitcnt lgkmcnt(0)
  v_mfma_f32_32x32x16_bf16 v[144:159], v[208:211], v[80:83], v[144:159]
  s_add_u32 s59, s68, s71
  s_add_u32 m0, s6, 32768
  s_add_u32 s60, s59, 0
  buffer_load_dwordx4 v254, s[24:27], s60 offen lds
  s_add_u32 m0, s6, 33792
  s_add_u32 s60, s59, 28672
  buffer_load_dwordx4 v254, s[24:27], s60 offen lds
  s_add_u32 m0, s6, 40960
  v_mfma_f32_32x32x16_bf16 v[160:175], v[212:215], v[80:83], v[160:175]
  s_add_u32 s60, s59, 0
  buffer_load_dwordx4 v255, s[28:31], s60 offen lds
  s_add_u32 m0, s6, 41984
  s_add_u32 s60, s59, 28672
  buffer_load_dwordx4 v255, s[28:31], s60 offen lds
  s_add_u32 s71, s71, 229376
  s_cmp_eq_u32 s71, 1835008
  v_mfma_f32_32x32x16_bf16 v[176:191], v[216:219], v[80:83], v[176:191]
  s_cselect_b32 s71, 0, s71
  ds_read_b64_tr_b16 v[224:225], v9 offset:2048
  ds_read_b64_tr_b16 v[226:227], v9 offset:2560
  ds_read_b64_tr_b16 v[228:229], v10 offset:2048
  ds_read_b64_tr_b16 v[230:231], v10 offset:2560
  ds_read_b64_tr_b16 v[232:233], v11 offset:2048
  ds_read_b64_tr_b16 v[234:235], v11 offset:2560
  s_waitcnt lgkmcnt(0)
  v_mfma_f32_32x32x16_bf16 v[144:159], v[224:227], v[84:87], v[144:159]
  s_waitcnt vmcnt(4)
  s_mov_b64 exec, 1
  ds_add_u32 v2, v3 offset:0
  s_mov_b64 exec, -1
  ds_read_b64_tr_b16 v[208:209], v9 offset:4096
  ds_read_b64_tr_b16 v[210:211], v9 offset:4608
  v_mfma_f32_32x32x16_bf16 v[160:175], v[228:231], v[84:87], v[160:175]
  ds_read_b64_tr_b16 v[212:213], v10 offset:4096
  ds_read_b64_tr_b16 v[214:215], v10 offset:4608
  v_mfma_f32_32x32x16_bf16 v[176:191], v[232:235], v[84:87], v[176:191]
  ds_read_b64_tr_b16 v[216:217], v11 offset:4096
  ds_read_b64_tr_b16 v[218:219], v11 offset:4608
  s_waitcnt lgkmcnt(0)
  v_mfma_f32_32x32x16_bf16 v[144:159], v[208:211], v[88:91], v[144:159]
  ds_read_b64_tr_b16 v[224:225], v9 offset:6144
  ds_read_b64_tr_b16 v[226:227], v9 offset:6656
  ds_read_b64_tr_b16 v[228:229], v10 offset:6144
  v_mfma_f32_32x32x16_bf16 v[160:175], v[212:215], v[88:91], v[160:175]
  ds_read_b64_tr_b16 v[230:231], v10 offset:6656
  ds_read_b64_tr_b16 v[232:233], v11 offset:6144
  v_mfma_f32_32x32x16_bf16 v[176:191], v[216:219], v[88:91], v[176:191]
  ds_read_b64_tr_b16 v[234:235], v11 offset:6656
  ds_read_b32 v14, v2 offset:0
  s_waitcnt lgkmcnt(0)
  s_setprio 2
  v_cmp_gt_u32 vcc, 60, v14
  s_setprio 0
  s_cbranch_vccnz gs12_spin
gs12_ok:
  v_mfma_f32_32x32x16_bf16 v[144:159], v[224:227], v[92:95], v[144:159]
  ds_read_b64_tr_b16 v[208:209], v9 offset:16384
  ds_read_b64_tr_b16 v[210:211], v9 offset:16896
  v_mfma_f32_32x32x16_bf16 v[160:175], v[228:231], v[92:95], v[160:175]
  ds_read_b64_tr_b16 v[212:213], v10 offset:16384
  ds_read_b64_tr_b16 v[214:215], v10 offset:16896
  v_mfma_f32_32x32x16_bf16 v[176:191], v[232:235], v[92:95], v[176:191]
  ds_read_b64_tr_b16 v[216:217], v11 offset:16384
  ds_read_b64_tr_b16 v[218:219], v11 offset:16896
  s_waitcnt lgkmcnt(0)
  v_mfma_f32_32x32x16_bf16 v[144:159], v[208:211], v[96:99], v[144:159]
  s_add_u32 s59, s68, s71
  s_add_u32 m0, s6, 49152
  s_add_u32 s60, s59, 0
  buffer_load_dwordx4 v254, s[24:27], s60 offen lds
  s_add_u32 m0, s6, 50176
  s_add_u32 s60, s59, 28672
  buffer_load_dwordx4 v254, s[24:27], s60 offen lds
  s_add_u32 m0, s6, 57344
  v_mfma_f32_32x32x16_bf16 v[160:175], v[212:215], v[96:99], v[160:175]
  s_add_u32 s60, s59, 0
  buffer_load_dwordx4 v255, s[28:31], s60 offen lds
  s_add_u32 m0, s6, 58368
  s_add_u32 s60, s59, 28672
  buffer_load_dwordx4 v255, s[28:31], s60 offen lds
  s_add_u32 s71, s71, 229376
  s_cmp_eq_u32 s71, 1835008
  v_mfma_f32_32x32x16_bf16 v[176:191], v[216:219], v[96:99], v[176:191]
  s_cselect_b32 s71, 0, s71
  ds_read_b64_tr_b16 v[224:225], v9 offset:18432
  ds_read_b64_tr_b16 v[226:227], v9 offset:18944
  ds_read_b64_tr_b16 v[228:229], v10 offset:18432
  ds_read_b64_tr_b16 v[230:231], v10 offset:18944
  ds_read_b64_tr_b16 v[232:233], v11 offset:18432
  ds_read_b64_tr_b16 v[234:235], v11 offset:18944
  s_waitcnt lgkmcnt(0)
  v_mfma_f32_32x32x16_bf16 v[144:159], v[224:227], v[100:103], v[144:159]
  s_waitcnt vmcnt(4)
  s_mov_b64 exec, 1
  ds_add_u32 v2, v3 offset:0
  s_mov_b64 exec, -1
  ds_read_b64_tr_b16 v[208:209], v9 offset:20480
  ds_read_b64_tr_b16 v[210:211], v9 offset:20992
  v_mfma_f32_32x32x16_bf16 v[160:175], v[228:231], v[100:103], v[160:175]
  ds_read_b64_tr_b16 v[212:213], v10 offset:20480
  ds_read_b64_tr_b16 v[214:215], v10 offset:20992
  v_mfma_f32_32x32x16_bf16 v[176:191], v[232:235], v[100:103], v[176:191]
  ds_read_b64_tr_b16 v[216:217], v11 offset:20480
  ds_read_b64_tr_b16 v[218:219], v11 offset:20992
  s_waitcnt lgkmcnt(0)
  v_mfma_f32_32x32x16_bf16 v[144:159], v[208:211], v[104:107], v[144:159]
  ds_read_b64_tr_b16 v[224:225], v9 offset:22528
  ds_read_b64_tr_b16 v[226:227], v9 offset:23040
  ds_read_b64_tr_b16 v[228:229], v10 offset:22528
  v_mfma_f32_32x32x16_bf16 v[160:175], v[212:215], v[104:107], v[160:175]
  ds_read_b64_tr_b16 v[230:231], v10 offset:23040
  ds_read_b64_tr_b16 v[232:233], v11 offset:22528
  v_mfma_f32_32x32x16_bf16 v[176:191], v[216:219], v[104:107], v[176:191]
  ds_read_b64_tr_b16 v[234:235], v11 offset:23040
  ds_read_b32 v14, v2 offset:0
  s_setprio 2
  v_lshrrev_b32 v7, 3, v0
  v_lshlrev_b32 v7, 10, v7
  v_lshrrev_b32 v6, 4, v0
  v_and_b32 v6, 1, v6
  v_lshlrev_b32 v6, 2, v6
  v_and_b32 v5, 7, v0
  v_xor_b32 v5, v5, v6
  v_lshl_add_u32 v5, v5, 4, v7
  s_lshl_b32 s57, s56, 7
  v_add_u32 v5, s57, v5
  v_add_u32 v6, 7168, v5
  s_lshl_b32 s72, s52, 13
  s_mul_i32 s70, s52, 458752
  s_setprio 0
  s_waitcnt lgkmcnt(0)
  s_setprio 2
  v_cmp_gt_u32 vcc, 64, v14
  s_setprio 0
  s_cbranch_vccnz gs13_spin
gs13_ok:
  v_mfma_f32_32x32x16_bf16 v[144:159], v[224:227], v[108:111], v[144:159]
  ds_read_b64_tr_b16 v[208:209], v9 offset:32768
  ds_read_b64_tr_b16 v[210:211], v9 offset:33280
  v_mfma_f32_32x32x16_bf16 v[160:175], v[228:231], v[108:111], v[160:175]
  ds_read_b64_tr_b16 v[212:213], v10 offset:32768
  ds_read_b64_tr_b16 v[214:215], v10 offset:33280
  v_mfma_f32_32x32x16_bf16 v[176:191], v[232:235], v[108:111], v[176:191]
  ds_read_b64_tr_b16 v[216:217], v11 offset:32768
  ds_read_b64_tr_b16 v[218:219], v11 offset:33280
  s_waitcnt lgkmcnt(0)
  v_mfma_f32_32x32x16_bf16 v[144:159], v[208:211], v[112:115], v[144:159]
  ds_read_b64_tr_b16 v[224:225], v9 offset:34816
  ds_read_b64_tr_b16 v[226:227], v9 offset:35328
  v_mfma_f32_32x32x16_bf16 v[160:175], v[212:215], v[112:115], v[160:175]
  ds_read_b64_tr_b16 v[228:229], v10 offset:34816
  ds_read_b64_tr_b16 v[230:231], v10 offset:35328
  v_mfma_f32_32x32x16_bf16 v[176:191], v[216:219], v[112:115], v[176:191]
  ds_read_b64_tr_b16 v[232:233], v11 offset:34816
  ds_read_b64_tr_b16 v[234:235], v11 offset:35328
  s_waitcnt lgkmcnt(0)
  v_mfma_f32_32x32x16_bf16 v[144:159], v[224:227], v[116:119], v[144:159]
  s_waitcnt vmcnt(0)
  s_mov_b64 exec, 1
  ds_add_u32 v2, v3 offset:0
  s_mov_b64 exec, -1
  ds_read_b64_tr_b16 v[208:209], v9 offset:36864
  ds_read_b64_tr_b16 v[210:211], v9 offset:37376
  v_mfma_f32_32x32x16_bf16 v[160:175], v[228:231], v[116:119], v[160:175]
  ds_read_b64_tr_b16 v[212:213], v10 offset:36864
  ds_read_b64_tr_b16 v[214:215], v10 offset:37376
  v_mfma_f32_32x32x16_bf16 v[176:191], v[232:235], v[116:119], v[176:191]
  ds_read_b64_tr_b16 v[216:217], v11 offset:36864
  ds_read_b64_tr_b16 v[218:219], v11 offset:37376
  s_setprio 2
  v_and_b32 v13, 31, v0
  v_lshlrev_b32 v13, 2, v13
  v_add_u32 v244, 114688, v1
  s_setprio 0
  s_lshl_b32 s73, s55, 3
  s_add_u32 s73, s73, s56
  s_lshl_b32 s73, s73, 7
  s_add_u32 s73, s73, 524288
  s_mul_i32 s71, s55, 229376
  s_mul_i32 s57, s52, 28672
  s_add_u32 s71, s71, s57
  s_add_u32 s71, s71, 8388608
  buffer_load_dword v245, v13, s[32:35], s73 offen sc1
  s_waitcnt lgkmcnt(0)
  v_mfma_f32_32x32x16_bf16 v[144:159], v[208:211], v[120:123], v[144:159]
  ds_read_b64_tr_b16 v[224:225], v9 offset:38912
  ds_read_b64_tr_b16 v[226:227], v9 offset:39424
  ds_read_b64_tr_b16 v[228:229], v10 offset:38912
  v_mfma_f32_32x32x16_bf16 v[160:175], v[212:215], v[120:123], v[160:175]
  ds_read_b64_tr_b16 v[230:231], v10 offset:39424
  ds_read_b64_tr_b16 v[232:233], v11 offset:38912
  v_mfma_f32_32x32x16_bf16 v[176:191], v[216:219], v[120:123], v[176:191]
  ds_read_b64_tr_b16 v[234:235], v11 offset:39424
  ds_read_b32 v14, v2 offset:0
  s_waitcnt lgkmcnt(0)
  s_setprio 2
  v_cmp_gt_u32 vcc, 68, v14
  s_setprio 0
  s_cbranch_vccnz gs14_spin
gs14_ok:
  v_mfma_f32_32x32x16_bf16 v[144:159], v[224:227], v[124:127], v[144:159]
  ds_read_b64_tr_b16 v[208:209], v9 offset:49152
  ds_read_b64_tr_b16 v[210:211], v9 offset:49664
  v_mfma_f32_32x32x16_bf16 v[160:175], v[228:231], v[124:127], v[160:175]
  ds_read_b64_tr_b16 v[212:213], v10 offset:49152
  ds_read_b64_tr_b16 v[214:215], v10 offset:49664
  v_mfma_f32_32x32x16_bf16 v[176:191], v[232:235], v[124:127], v[176:191]
  ds_read_b64_tr_b16 v[216:217], v11 offset:49152
  ds_read_b64_tr_b16 v[218:219], v11 offset:49664
  s_waitcnt lgkmcnt(0)
  v_mfma_f32_32x32x16_bf16 v[144:159], v[208:211], v[128:131], v[144:159]
  s_add_u32 m0, s72, 0
  s_add_u32 s60, s70, 0
  buffer_load_dwordx4 v5, s[36:39], s60 offen lds
  buffer_load_dwordx4 v6, s[36:39], s60 offen offset:1024 lds
  s_add_u32 m0, s72, 2048
  s_add_u32 s60, s70, 16384
  buffer_load_dwordx4 v5, s[36:39], s60 offen lds
  buffer_load_dwordx4 v6, s[36:39], s60 offen offset:1024 lds
  v_mfma_f32_32x32x16_bf16 v[160:175], v[212:215], v[128:131], v[160:175]
  s_add_u32 m0, s72, 4096
  s_add_u32 s60, s70, 32768
  buffer_load_dwordx4 v5, s[36:39], s60 offen lds
  buffer_load_dwordx4 v6, s[36:39], s60 offen offset:1024 lds
  s_add_u32 m0, s72, 6144
  s_add_u32 s60, s70, 49152
  buffer_load_dwordx4 v5, s[36:39], s60 offen lds
  v_mfma_f32_32x32x16_bf16 v[176:191], v[216:219], v[128:131], v[176:191]
  buffer_load_dwordx4 v6, s[36:39], s60 offen offset:1024 lds
  ds_read_b64_tr_b16 v[224:225], v9 offset:51200
  ds_read_b64_tr_b16 v[226:227], v9 offset:51712
  ds_read_b64_tr_b16 v[228:229], v10 offset:51200
  ds_read_b64_tr_b16 v[230:231], v10 offset:51712
  ds_read_b64_tr_b16 v[232:233], v11 offset:51200
  ds_read_b64_tr_b16 v[234:235], v11 offset:51712
  s_waitcnt lgkmcnt(0)
  v_mfma_f32_32x32x16_bf16 v[144:159], v[224:227], v[132:135], v[144:159]
  s_mov_b64 exec, 1
  ds_add_u32 v2, v3 offset:0
  s_mov_b64 exec, -1
  ds_read_b64_tr_b16 v[208:209], v9 offset:53248
  ds_read_b64_tr_b16 v[210:211], v9 offset:53760
  v_mfma_f32_32x32x16_bf16 v[160:175], v[228:231], v[132:135], v[160:175]
  ds_read_b64_tr_b16 v[212:213], v10 offset:53248
  ds_read_b64_tr_b16 v[214:215], v10 offset:53760
  v_mfma_f32_32x32x16_bf16 v[176:191], v[232:235], v[132:135], v[176:191]
  ds_read_b64_tr_b16 v[216:217], v11 offset:53248
  ds_read_b64_tr_b16 v[218:219], v11 offset:53760
  s_waitcnt vmcnt(8)
  s_setprio 2
  v_cmp_ne_u32 vcc, s61, v245
  s_cbranch_vccnz pha_spin
pha_ok:
  s_setprio 0
  s_add_u32 s59, s71, 0
  buffer_load_dwordx4 v[16:19], v1, s[32:35], s59 offen
  buffer_load_dwordx4 v[20:23], v244, s[32:35], s59 offen
  s_add_u32 s59, s71, 1024
  buffer_load_dwordx4 v[24:27], v1, s[32:35], s59 offen
  buffer_load_dwordx4 v[28:31], v244, s[32:35], s59 offen
  s_add_u32 s59, s71, 2048
  buffer_load_dwordx4 v[32:35], v1, s[32:35], s59 offen
  buffer_load_dwordx4 v[36:39], v244, s[32:35], s59 offen
  s_add_u32 s59, s71, 3072
  buffer_load_dwordx4 v[40:43], v1, s[32:35], s59 offen
  buffer_load_dwordx4 v[44:47], v244, s[32:35], s59 offen
  s_add_u32 s59, s71, 8192
  buffer_load_dwordx4 v[48:51], v1, s[32:35], s59 offen
  buffer_load_dwordx4 v[52:55], v244, s[32:35], s59 offen
  s_waitcnt lgkmcnt(0)
  v_mfma_f32_32x32x16_bf16 v[144:159], v[208:211], v[136:139], v[144:159]
  ds_read_b64_tr_b16 v[224:225], v9 offset:55296
  ds_read_b64_tr_b16 v[226:227], v9 offset:55808
  ds_read_b64_tr_b16 v[228:229], v10 offset:55296
  v_mfma_f32_32x32x16_bf16 v[160:175], v[212:215], v[136:139], v[160:175]
  ds_read_b64_tr_b16 v[230:231], v10 offset:55808
  ds_read_b64_tr_b16 v[232:233], v11 offset:55296
  v_mfma_f32_32x32x16_bf16 v[176:191], v[216:219], v[136:139], v[176:191]
  ds_read_b64_tr_b16 v[234:235], v11 offset:55808
  ds_read_b32 v14, v2 offset:0
  s_waitcnt lgkmcnt(0)
  s_setprio 2
  v_cmp_gt_u32 vcc, 72, v14
  s_setprio 0
  s_cbranch_vccnz gs15_spin
gs15_ok:
  v_mfma_f32_32x32x16_bf16 v[144:159], v[224:227], v[140:143], v[144:159]
  v_mfma_f32_32x32x16_bf16 v[160:175], v[228:231], v[140:143], v[160:175]
  v_mfma_f32_32x32x16_bf16 v[176:191], v[232:235], v[140:143], v[176:191]
  s_setprio 2
  v_add_u32 v7, 151552, v1
  ds_read_b128 v[208:211], v7 offset:0
  ds_read_b128 v[212:215], v7 offset:1024
  ds_read_b128 v[216:219], v7 offset:2048
  s_waitcnt lgkmcnt(2)
  v_mfma_f32_32x32x16_bf16 v[144:159], v[208:211], v[240:243], v[144:159]
  s_waitcnt lgkmcnt(1)
  v_mfma_f32_32x32x16_bf16 v[160:175], v[212:215], v[240:243], v[160:175]
  s_waitcnt lgkmcnt(0)
  v_mfma_f32_32x32x16_bf16 v[176:191], v[216:219], v[240:243], v[176:191]
  s_and_b32 s58, s54, 3
  s_cmp_le_u32 s58, 0
  s_cselect_b32 s58, 4096, 0
  s_add_u32 s58, s58, s69
  s_add_u32 s58, s58, 0
  s_nop 7
  v_max_f32 v144, 0, v144
  v_max_f32 v145, 0, v145
  v_max_f32 v146, 0, v146
  v_max_f32 v147, 0, v147
  v_max_f32 v148, 0, v148
  v_max_f32 v149, 0, v149
  v_max_f32 v150, 0, v150
  v_max_f32 v151, 0, v151
  v_pk_mul_f32 v[144:145], v[144:145], v[152:153]
  v_pk_mul_f32 v[146:147], v[146:147], v[154:155]
  v_pk_mul_f32 v[148:149], v[148:149], v[156:157]
  v_pk_mul_f32 v[150:151], v[150:151], v[158:159]
  v_cvt_pk_bf16_f32 v144, v144, v145
  v_cvt_pk_bf16_f32 v145, v146, v147
  v_cvt_pk_bf16_f32 v146, v148, v149
  v_cvt_pk_bf16_f32 v147, v150, v151
  buffer_store_dwordx4 v[144:147], v1, s[32:35], s58 offen sc1
  s_and_b32 s58, s54, 3
  s_cmp_le_u32 s58, 1
  s_cselect_b32 s58, 4096, 0
  s_add_u32 s58, s58, s69
  s_add_u32 s58, s58, 1024
  v_max_f32 v160, 0, v160
  v_max_f32 v161, 0, v161
  v_max_f32 v162, 0, v162
  v_max_f32 v163, 0, v163
  v_max_f32 v164, 0, v164
  v_max_f32 v165, 0, v165
  v_max_f32 v166, 0, v166
  v_max_f32 v167, 0, v167
  v_pk_mul_f32 v[160:161], v[160:161], v[168:169]
  v_pk_mul_f32 v[162:163], v[162:163], v[170:171]
  v_pk_mul_f32 v[164:165], v[164:165], v[172:173]
  v_pk_mul_f32 v[166:167], v[166:167], v[174:175]
  v_cvt_pk_bf16_f32 v160, v160, v161
  v_cvt_pk_bf16_f32 v161, v162, v163
  v_cvt_pk_bf16_f32 v162, v164, v165
  v_cvt_pk_bf16_f32 v163, v166, v167
  buffer_store_dwordx4 v[160:163], v1, s[32:35], s58 offen sc1
  s_and_b32 s58, s54, 3
  s_cmp_le_u32 s58, 2
  s_cselect_b32 s58, 4096, 0
  s_add_u32 s58, s58, s69
  s_add_u32 s58, s58, 2048
  v_max_f32 v176, 0, v176
  v_max_f32 v177, 0, v177
  v_max_f32 v178, 0, v178
  v_max_f32 v179, 0, v179
  v_max_f32 v180, 0, v180
  v_max_f32 v181, 0, v181
  v_max_f32 v182, 0, v182
  v_max_f32 v183, 0, v183
  v_pk_mul_f32 v[176:177], v[176:177], v[184:185]
  v_pk_mul_f32 v[178:179], v[178:179], v[186:187]
  v_pk_mul_f32 v[180:181], v[180:181], v[188:189]
  v_pk_mul_f32 v[182:183], v[182:183], v[190:191]
  v_cvt_pk_bf16_f32 v176, v176, v177
  v_cvt_pk_bf16_f32 v177, v178, v179
  v_cvt_pk_bf16_f32 v178, v180, v181
  v_cvt_pk_bf16_f32 v179, v182, v183
  buffer_store_dwordx4 v[176:179], v1, s[32:35], s58 offen sc1
  s_setprio 0
  s_setprio 2
  v_mov_b32 v11, v244
  v_add_u32 v8, 32768, v1
  v_and_b32 v56, 15, v0
  v_lshrrev_b32 v57, 2, v56
  v_lshrrev_b32 v58, 5, v0
  v_lshlrev_b32 v58, 2, v58
  v_add_u32 v57, v57, v58
  v_lshlrev_b32 v57, 7, v57
  v_lshrrev_b32 v58, 3, v56
  v_lshlrev_b32 v58, 6, v58
  v_add_u32 v57, v57, v58
  v_lshrrev_b32 v58, 4, v0
  v_and_b32 v58, 1, v58
  v_lshlrev_b32 v58, 5, v58
  v_add_u32 v57, v57, v58
  v_and_b32 v58, 3, v0
  v_lshlrev_b32 v58, 3, v58
  v_add_u32 v12, v57, v58
  v_add_u32 v9, s72, v12
  v_xor_b32 v10, 64, v9
  s_setprio 0
  s_waitcnt vmcnt(19)
  ds_read_b64_tr_b16 v[240:241], v9 offset:0
  ds_read_b64_tr_b16 v[242:243], v9 offset:1024
  ds_read_b64_tr_b16 v[244:245], v10 offset:0
  ds_read_b64_tr_b16 v[246:247], v10 offset:1024
  s_waitcnt lgkmcnt(0)
  s_waitcnt vmcnt(11)
  v_mfma_f32_32x32x16_bf16 v[144:159], v[240:243], v[16:19], 0
  s_lshl_b32 s57, s53, 11
  s_lshr_b32 s58, s52, 1
  s_lshl_b32 s58, s58, 10
  s_add_u32 s57, s57, s58
  s_and_b32 s58, s52, 1
  s_lshl_b32 s58, s58, 6
  s_add_u32 s57, s57, s58
  s_lshl_b32 s58, s54, 2
  s_add_u32 s57, s57, s58
  s_add_u32 s57, s57, 557056
  s_setprio 2
  v_lshlrev_b32 v14, 7, v0
  s_mov_b64 exec, 0xff
  buffer_atomic_swap v4, v14, s[32:35], s57 offen sc1
  s_mov_b64 exec, -1
  s_setprio 0
  ds_read_b64_tr_b16 v[248:249], v9 offset:2048
  ds_read_b64_tr_b16 v[250:251], v9 offset:3072
  v_mfma_f32_32x32x16_bf16 v[160:175], v[240:243], v[20:23], 0
  ds_read_b64_tr_b16 v[252:253], v10 offset:2048
  ds_read_b64_tr_b16 v[254:255], v10 offset:3072
  s_add_u32 m0, s72, 0
  s_add_u32 s60, s70, 131072
  buffer_load_dwordx4 v5, s[36:39], s60 offen lds
  buffer_load_dwordx4 v6, s[36:39], s60 offen offset:1024 lds
  v_mfma_f32_32x32x16_bf16 v[176:191], v[244:247], v[16:19], 0
  v_mfma_f32_32x32x16_bf16 v[192:207], v[244:247], v[20:23], 0
  s_add_u32 s59, s71, 9216
  buffer_load_dwordx4 v[16:19], v1, s[32:35], s59 offen
  buffer_load_dwordx4 v[20:23], v11, s[32:35], s59 offen
  s_waitcnt lgkmcnt(0)
  s_waitcnt vmcnt(14)
  v_mfma_f32_32x32x16_bf16 v[144:159], v[248:251], v[24:27], v[144:159]
  ds_read_b64_tr_b16 v[240:241], v9 offset:4096
  ds_read_b64_tr_b16 v[242:243], v9 offset:5120
  v_mfma_f32_32x32x16_bf16 v[160:175], v[248:251], v[28:31], v[160:175]
  ds_read_b64_tr_b16 v[244:245], v10 offset:4096
  ds_read_b64_tr_b16 v[246:247], v10 offset:5120
  s_add_u32 m0, s72, 2048
  s_add_u32 s60, s70, 147456
  buffer_load_dwordx4 v5, s[36:39], s60 offen lds
  buffer_load_dwordx4 v6, s[36:39], s60 offen offset:1024 lds
  v_mfma_f32_32x32x16_bf16 v[176:191], v[252:255], v[24:27], v[176:191]
  v_mfma_f32_32x32x16_bf16 v[192:207], v[252:255], v[28:31], v[192:207]
  s_add_u32 s59, s71, 10240
  buffer_load_dwordx4 v[24:27], v1, s[32:35], s59 offen
  buffer_load_dwordx4 v[28:31], v11, s[32:35], s59 offen
  s_waitcnt lgkmcnt(0)
  s_waitcnt vmcnt(16)
  v_mfma_f32_32x32x16_bf16 v[144:159], v[240:243], v[32:35], v[144:159]
  ds_read_b64_tr_b16 v[248:249], v9 offset:6144
  ds_read_b64_tr_b16 v[250:251], v9 offset:7168
  v_mfma_f32_32x32x16_bf16 v[160:175], v[240:243], v[36:39], v[160:175]
  ds_read_b64_tr_b16 v[252:253], v10 offset:6144
  ds_read_b64_tr_b16 v[254:255], v10 offset:7168
  s_add_u32 m0, s72, 4096
  s_add_u32 s60, s70, 163840
  buffer_load_dwordx4 v5, s[36:39], s60 offen lds
  buffer_load_dwordx4 v6, s[36:39], s60 offen offset:1024 lds
  v_mfma_f32_32x32x16_bf16 v[176:191], v[244:247], v[32:35], v[176:191]
  v_mfma_f32_32x32x16_bf16 v[192:207], v[244:247], v[36:39], v[192:207]
  s_add_u32 s59, s71, 11264
  buffer_load_dwordx4 v[32:35], v1, s[32:35], s59 offen
  buffer_load_dwordx4 v[36:39], v11, s[32:35], s59 offen
  s_waitcnt lgkmcnt(0)
  s_waitcnt vmcnt(18)
  v_mfma_f32_32x32x16_bf16 v[144:159], v[248:251], v[40:43], v[144:159]
  s_waitcnt vmcnt(10)
  ds_read_b64_tr_b16 v[240:241], v9 offset:0
  ds_read_b64_tr_b16 v[242:243], v9 offset:1024
  v_mfma_f32_32x32x16_bf16 v[160:175], v[248:251], v[44:47], v[160:175]
  ds_read_b64_tr_b16 v[244:245], v10 offset:0
  ds_read_b64_tr_b16 v[246:247], v10 offset:1024
  s_add_u32 m0, s72, 6144
  s_add_u32 s60, s70, 180224
  buffer_load_dwordx4 v5, s[36:39], s60 offen lds
  buffer_load_dwordx4 v6, s[36:39], s60 offen offset:1024 lds
  v_mfma_f32_32x32x16_bf16 v[176:191], v[252:255], v[40:43], v[176:191]
  v_mfma_f32_32x32x16_bf16 v[192:207], v[252:255], v[44:47], v[192:207]
  s_add_u32 s59, s71, 16384
  buffer_load_dwordx4 v[40:43], v1, s[32:35], s59 offen
  buffer_load_dwordx4 v[44:47], v11, s[32:35], s59 offen
  s_waitcnt lgkmcnt(0)
  v_mfma_f32_32x32x16_bf16 v[144:159], v[240:243], v[48:51], v[144:159]
  s_waitcnt vmcnt(10)
  ds_read_b64_tr_b16 v[248:249], v9 offset:2048
  ds_read_b64_tr_b16 v[250:251], v9 offset:3072
  v_mfma_f32_32x32x16_bf16 v[160:175], v[240:243], v[52:55], v[160:175]
  ds_read_b64_tr_b16 v[252:253], v10 offset:2048
  ds_read_b64_tr_b16 v[254:255], v10 offset:3072
  s_add_u32 m0, s72, 0
  s_add_u32 s60, s70, 262144
  buffer_load_dwordx4 v5, s[36:39], s60 offen lds
  buffer_load_dwordx4 v6, s[36:39], s60 offen offset:1024 lds
  v_mfma_f32_32x32x16_bf16 v[176:191], v[244:247], v[48:51], v[176:191]
  v_mfma_f32_32x32x16_bf16 v[192:207], v[244:247], v[52:55], v[192:207]
  s_add_u32 s59, s71, 17408
  buffer_load_dwordx4 v[48:51], v1, s[32:35], s59 offen
  buffer_load_dwordx4 v[52:55], v11, s[32:35], s59 offen
  s_waitcnt lgkmcnt(0)
  v_mfma_f32_32x32x16_bf16 v[144:159], v[248:251], v[16:19], v[144:159]
  s_waitcnt vmcnt(10)
  ds_read_b64_tr_b16 v[240:241], v9 offset:4096
  ds_read_b64_tr_b16 v[242:243], v9 offset:5120
  v_mfma_f32_32x32x16_bf16 v[160:175], v[248:251], v[20:23], v[160:175]
  ds_read_b64_tr_b16 v[244:245], v10 offset:4096
  ds_read_b64_tr_b16 v[246:247], v10 offset:5120
  s_add_u32 m0, s72, 2048
  s_add_u32 s60, s70, 278528
  buffer_load_dwordx4 v5, s[36:39], s60 offen lds
  buffer_load_dwordx4 v6, s[36:39], s60 offen offset:1024 lds
  v_mfma_f32_32x32x16_bf16 v[176:191], v[252:255], v[16:19], v[176:191]
  v_mfma_f32_32x32x16_bf16 v[192:207], v[252:255], v[20:23], v[192:207]
  s_add_u32 s59, s71, 18432
  buffer_load_dwordx4 v[16:19], v1, s[32:35], s59 offen
  buffer_load_dwordx4 v[20:23], v11, s[32:35], s59 offen
  s_waitcnt lgkmcnt(0)
  v_mfma_f32_32x32x16_bf16 v[144:159], v[240:243], v[24:27], v[144:159]
  s_waitcnt vmcnt(10)
  ds_read_b64_tr_b16 v[248:249], v9 offset:6144
  ds_read_b64_tr_b16 v[250:251], v9 offset:7168
  v_mfma_f32_32x32x16_bf16 v[160:175], v[240:243], v[28:31], v[160:175]
  ds_read_b64_tr_b16 v[252:253], v10 offset:6144
  ds_read_b64_tr_b16 v[254:255], v10 offset:7168
  s_add_u32 m0, s72, 4096
  s_add_u32 s60, s70, 294912
  buffer_load_dwordx4 v5, s[36:39], s60 offen lds
  buffer_load_dwordx4 v6, s[36:39], s60 offen offset:1024 lds
  v_mfma_f32_32x32x16_bf16 v[176:191], v[244:247], v[24:27], v[176:191]
  v_mfma_f32_32x32x16_bf16 v[192:207], v[244:247], v[28:31], v[192:207]
  s_add_u32 s59, s71, 19456
  buffer_load_dwordx4 v[24:27], v1, s[32:35], s59 offen
  buffer_load_dwordx4 v[28:31], v11, s[32:35], s59 offen
  s_waitcnt lgkmcnt(0)
  v_mfma_f32_32x32x16_bf16 v[144:159], v[248:251], v[32:35], v[144:159]
  s_waitcnt vmcnt(10)
  ds_read_b64_tr_b16 v[240:241], v9 offset:0
  ds_read_b64_tr_b16 v[242:243], v9 offset:1024
  v_mfma_f32_32x32x16_bf16 v[160:175], v[248:251], v[36:39], v[160:175]
  ds_read_b64_tr_b16 v[244:245], v10 offset:0
  ds_read_b64_tr_b16 v[246:247], v10 offset:1024
  s_add_u32 m0, s72, 6144
  s_add_u32 s60, s70, 311296
  buffer_load_dwordx4 v5, s[36:39], s60 offen lds
  buffer_load_dwordx4 v6, s[36:39], s60 offen offset:1024 lds
  v_mfma_f32_32x32x16_bf16 v[176:191], v[252:255], v[32:35], v[176:191]
  v_mfma_f32_32x32x16_bf16 v[192:207], v[252:255], v[36:39], v[192:207]
  s_add_u32 s59, s71, 24576
  buffer_load_dwordx4 v[32:35], v1, s[32:35], s59 offen
  buffer_load_dwordx4 v[36:39], v11, s[32:35], s59 offen
  s_waitcnt lgkmcnt(0)
  v_mfma_f32_32x32x16_bf16 v[144:159], v[240:243], v[40:43], v[144:159]
  s_waitcnt vmcnt(10)
  ds_read_b64_tr_b16 v[248:249], v9 offset:2048
  ds_read_b64_tr_b16 v[250:251], v9 offset:3072
  v_mfma_f32_32x32x16_bf16 v[160:175], v[240:243], v[44:47], v[160:175]
  ds_read_b64_tr_b16 v[252:253], v10 offset:2048
  ds_read_b64_tr_b16 v[254:255], v10 offset:3072
  s_add_u32 m0, s72, 0
  s_add_u32 s60, s70, 393216
  buffer_load_dwordx4 v5, s[36:39], s60 offen lds
  buffer_load_dwordx4 v6, s[36:39], s60 offen offset:1024 lds
  v_mfma_f32_32x32x16_bf16 v[176:191], v[244:247], v[40:43], v[176:191]
  v_mfma_f32_32x32x16_bf16 v[192:207], v[244:247], v[44:47], v[192:207]
  s_add_u32 s59, s71, 25600
  buffer_load_dwordx4 v[40:43], v1, s[32:35], s59 offen
  buffer_load_dwordx4 v[44:47], v11, s[32:35], s59 offen
  s_waitcnt lgkmcnt(0)
  v_mfma_f32_32x32x16_bf16 v[144:159], v[248:251], v[48:51], v[144:159]
  s_waitcnt vmcnt(10)
  ds_read_b64_tr_b16 v[240:241], v9 offset:4096
  ds_read_b64_tr_b16 v[242:243], v9 offset:5120
  v_mfma_f32_32x32x16_bf16 v[160:175], v[248:251], v[52:55], v[160:175]
  ds_read_b64_tr_b16 v[244:245], v10 offset:4096
  ds_read_b64_tr_b16 v[246:247], v10 offset:5120
  s_add_u32 m0, s72, 2048
  s_add_u32 s60, s70, 409600
  buffer_load_dwordx4 v5, s[36:39], s60 offen lds
  buffer_load_dwordx4 v6, s[36:39], s60 offen offset:1024 lds
  v_mfma_f32_32x32x16_bf16 v[176:191], v[252:255], v[48:51], v[176:191]
  v_mfma_f32_32x32x16_bf16 v[192:207], v[252:255], v[52:55], v[192:207]
  s_add_u32 s76, s73, 32768
  buffer_load_dword v14, v13, s[32:35], s76 offen sc1
  s_add_u32 s59, s71, 26624
  buffer_load_dwordx4 v[48:51], v1, s[32:35], s59 offen
  buffer_load_dwordx4 v[52:55], v11, s[32:35], s59 offen
  s_waitcnt lgkmcnt(0)
  v_mfma_f32_32x32x16_bf16 v[144:159], v[240:243], v[16:19], v[144:159]
  s_waitcnt vmcnt(11)
  ds_read_b64_tr_b16 v[248:249], v9 offset:6144
  ds_read_b64_tr_b16 v[250:251], v9 offset:7168
  v_mfma_f32_32x32x16_bf16 v[160:175], v[240:243], v[20:23], v[160:175]
  ds_read_b64_tr_b16 v[252:253], v10 offset:6144
  ds_read_b64_tr_b16 v[254:255], v10 offset:7168
  s_add_u32 m0, s72, 4096
  s_add_u32 s60, s70, 425984
  buffer_load_dwordx4 v5, s[36:39], s60 offen lds
  buffer_load_dwordx4 v6, s[36:39], s60 offen offset:1024 lds
  v_mfma_f32_32x32x16_bf16 v[176:191], v[244:247], v[16:19], v[176:191]
  v_mfma_f32_32x32x16_bf16 v[192:207], v[244:247], v[20:23], v[192:207]
  s_add_u32 s59, s71, 27648
  buffer_load_dwordx4 v[16:19], v1, s[32:35], s59 offen
  buffer_load_dwordx4 v[20:23], v11, s[32:35], s59 offen
  s_waitcnt lgkmcnt(0)
  v_mfma_f32_32x32x16_bf16 v[144:159], v[248:251], v[24:27], v[144:159]
  s_waitcnt vmcnt(11)
  ds_read_b64_tr_b16 v[240:241], v9 offset:0
  ds_read_b64_tr_b16 v[242:243], v9 offset:1024
  v_mfma_f32_32x32x16_bf16 v[160:175], v[248:251], v[28:31], v[160:175]
  ds_read_b64_tr_b16 v[244:245], v10 offset:0
  ds_read_b64_tr_b16 v[246:247], v10 offset:1024
  s_add_u32 m0, s72, 6144
  s_add_u32 s60, s70, 442368
  buffer_load_dwordx4 v5, s[36:39], s60 offen lds
  buffer_load_dwordx4 v6, s[36:39], s60 offen offset:1024 lds
  v_mfma_f32_32x32x16_bf16 v[176:191], v[252:255], v[24:27], v[176:191]
  v_mfma_f32_32x32x16_bf16 v[192:207], v[252:255], v[28:31], v[192:207]
  s_waitcnt vmcnt(8)
  s_setprio 2
  v_cmp_ne_u32 vcc, s61, v14
  s_cbranch_vccnz phb_spin
phb_ok:
  s_setprio 0
  s_add_u32 s59, s71, 4096
  buffer_load_dwordx4 v[24:27], v1, s[32:35], s59 offen
  buffer_load_dwordx4 v[28:31], v11, s[32:35], s59 offen
  s_waitcnt lgkmcnt(0)
  v_mfma_f32_32x32x16_bf16 v[144:159], v[240:243], v[32:35], v[144:159]
  ds_read_b64_tr_b16 v[248:249], v9 offset:2048
  ds_read_b64_tr_b16 v[250:251], v9 offset:3072
  v_mfma_f32_32x32x16_bf16 v[160:175], v[240:243], v[36:39], v[160:175]
  ds_read_b64_tr_b16 v[252:253], v10 offset:2048
  ds_read_b64_tr_b16 v[254:255], v10 offset:3072
  s_add_u32 m0, s72, 0
  s_add_u32 s60, s70, 65536
  buffer_load_dwordx4 v5, s[36:39], s60 offen lds
  buffer_load_dwordx4 v6, s[36:39], s60 offen offset:1024 lds
  v_mfma_f32_32x32x16_bf16 v[176:191], v[244:247], v[32:35], v[176:191]
  v_mfma_f32_32x32x16_bf16 v[192:207], v[244:247], v[36:39], v[192:207]
  s_add_u32 s59, s71, 5120
  buffer_load_dwordx4 v[32:35], v1, s[32:35], s59 offen
  buffer_load_dwordx4 v[36:39], v11, s[32:35], s59 offen
  s_waitcnt lgkmcnt(0)
  v_mfma_f32_32x32x16_bf16 v[144:159], v[248:251], v[40:43], v[144:159]
  s_waitcnt vmcnt(10)
  ds_read_b64_tr_b16 v[240:241], v9 offset:4096
  ds_read_b64_tr_b16 v[242:243], v9 offset:5120
  v_mfma_f32_32x32x16_bf16 v[160:175], v[248:251], v[44:47], v[160:175]
  ds_read_b64_tr_b16 v[244:245], v10 offset:4096
  ds_read_b64_tr_b16 v[246:247], v10 offset:5120
  s_add_u32 m0, s72, 2048
  s_add_u32 s60, s70, 81920
  buffer_load_dwordx4 v5, s[36:39], s60 offen lds
  buffer_load_dwordx4 v6, s[36:39], s60 offen offset:1024 lds
  v_mfma_f32_32x32x16_bf16 v[176:191], v[252:255], v[40:43], v[176:191]
  v_mfma_f32_32x32x16_bf16 v[192:207], v[252:255], v[44:47], v[192:207]
  s_add_u32 s59, s71, 6144
  buffer_load_dwordx4 v[40:43], v1, s[32:35], s59 offen
  buffer_load_dwordx4 v[44:47], v11, s[32:35], s59 offen
  s_waitcnt lgkmcnt(0)
  v_mfma_f32_32x32x16_bf16 v[144:159], v[240:243], v[48:51], v[144:159]
  s_waitcnt vmcnt(10)
  ds_read_b64_tr_b16 v[248:249], v9 offset:6144
  ds_read_b64_tr_b16 v[250:251], v9 offset:7168
  v_mfma_f32_32x32x16_bf16 v[160:175], v[240:243], v[52:55], v[160:175]
  ds_read_b64_tr_b16 v[252:253], v10 offset:6144
  ds_read_b64_tr_b16 v[254:255], v10 offset:7168
  s_add_u32 m0, s72, 4096
  s_add_u32 s60, s70, 98304
  buffer_load_dwordx4 v5, s[36:39], s60 offen lds
  buffer_load_dwordx4 v6, s[36:39], s60 offen offset:1024 lds
  v_mfma_f32_32x32x16_bf16 v[176:191], v[244:247], v[48:51], v[176:191]
  v_mfma_f32_32x32x16_bf16 v[192:207], v[244:247], v[52:55], v[192:207]
  s_add_u32 s59, s71, 7168
  buffer_load_dwordx4 v[48:51], v1, s[32:35], s59 offen
  buffer_load_dwordx4 v[52:55], v11, s[32:35], s59 offen
  s_waitcnt lgkmcnt(0)
  v_mfma_f32_32x32x16_bf16 v[144:159], v[248:251], v[16:19], v[144:159]
  s_waitcnt vmcnt(10)
  ds_read_b64_tr_b16 v[240:241], v9 offset:0
  ds_read_b64_tr_b16 v[242:243], v9 offset:1024
  v_mfma_f32_32x32x16_bf16 v[160:175], v[248:251], v[20:23], v[160:175]
  ds_read_b64_tr_b16 v[244:245], v10 offset:0
  ds_read_b64_tr_b16 v[246:247], v10 offset:1024
  s_add_u32 m0, s72, 6144
  s_add_u32 s60, s70, 114688
  buffer_load_dwordx4 v5, s[36:39], s60 offen lds
  buffer_load_dwordx4 v6, s[36:39], s60 offen offset:1024 lds
  v_mfma_f32_32x32x16_bf16 v[176:191], v[252:255], v[16:19], v[176:191]
  v_mfma_f32_32x32x16_bf16 v[192:207], v[252:255], v[20:23], v[192:207]
  s_add_u32 s59, s71, 12288
  buffer_load_dwordx4 v[16:19], v1, s[32:35], s59 offen
  buffer_load_dwordx4 v[20:23], v11, s[32:35], s59 offen
  ds_read_b32 v14, v2 offset:48
  s_waitcnt lgkmcnt(0)
  s_setprio 2
  v_cmp_gt_u32 vcc, 4, v14
  s_setprio 0
  s_cbranch_vccnz gp0_spin
gp0_ok:
  s_setprio 2
  s_mul_i32 s58, s63, 2304
  s_add_u32 s57, s58, 65536
  v_add_u32 v110, s57, v1
  v_lshrrev_b32 v111, 2, v1
  v_add_u32 v111, s57, v111
  ds_read_b128 v[64:67], v110 offset:0
  ds_read_b128 v[68:71], v110 offset:1024
  ds_read_b32 v72, v111 offset:2048
  ds_read_b128 v[76:79], v110 offset:9216
  ds_read_b128 v[80:83], v110 offset:10240
  ds_read_b32 v84, v111 offset:11264
  ds_read_b128 v[88:91], v110 offset:18432
  ds_read_b128 v[92:95], v110 offset:19456
  ds_read_b32 v96, v111 offset:20480
  ds_read_b128 v[100:103], v110 offset:27648
  ds_read_b128 v[104:107], v110 offset:28672
  ds_read_b32 v108, v111 offset:29696
  s_mov_b32 s59, 0x53800000
  s_mov_b32 s60, 0x7b800000
  s_waitcnt lgkmcnt(0)
  v_add_f32 v64, v64, v76
  v_add_f32 v88, v88, v100
  v_add_f32 v65, v65, v77
  v_add_f32 v89, v89, v101
  v_add_f32 v66, v66, v78
  v_add_f32 v90, v90, v102
  v_add_f32 v67, v67, v79
  v_add_f32 v91, v91, v103
  v_add_f32 v68, v68, v80
  v_add_f32 v92, v92, v104
  v_add_f32 v69, v69, v81
  v_add_f32 v93, v93, v105
  v_add_f32 v70, v70, v82
  v_add_f32 v94, v94, v106
  v_add_f32 v71, v71, v83
  v_add_f32 v95, v95, v107
  v_add_f32 v72, v72, v84
  v_add_f32 v96, v96, v108
  v_add_f32 v64, v64, v88
  v_add_f32 v65, v65, v89
  v_add_f32 v66, v66, v90
  v_add_f32 v67, v67, v91
  v_add_f32 v68, v68, v92
  v_add_f32 v69, v69, v93
  v_add_f32 v70, v70, v94
  v_add_f32 v71, v71, v95
  v_add_f32 v72, v72, v96
  v_add_f32 v76, |v64|, |v65|
  v_add_f32 v77, |v66|, |v67|
  v_add_f32 v78, |v68|, |v69|
  v_add_f32 v79, |v70|, |v71|
  v_add_f32 v76, v76, v77
  v_add_f32 v78, v78, v79
  v_add_f32 v76, v76, v78
  v_cmp_le_f32 vcc, 0x30800000, v72
  v_cmp_ge_f32_e64 s[74:75], s59, v72
  v_cmp_gt_f32_e64 s[76:77], s60, v76
  s_nop 1
  s_and_b64 vcc, vcc, s[74:75]
  s_and_b64 vcc, vcc, s[76:77]
  s_cmp_lg_u64 vcc, -1
  s_cbranch_scc1 ro_slow
ro_norm:
  v_mul_f32 v72, v72, v15
  s_nop 0
  v_rcp_f32 v73, v72
  s_lshl_b32 s57, s63, 15
  s_lshl_b32 s58, s53, 17
  s_add_u32 s57, s57, s58
  s_lshl_b32 s58, s54, 11
  s_add_u32 s57, s57, s58
  s_add_u32 s57, s57, 4194304
  v_mul_f32 v64, v64, v73
  v_mul_f32 v65, v65, v73
  v_mul_f32 v66, v66, v73
  v_mul_f32 v67, v67, v73
  v_mul_f32 v68, v68, v73
  v_mul_f32 v69, v69, v73
  v_mul_f32 v70, v70, v73
  v_mul_f32 v71, v71, v73
  v_cvt_pk_bf16_f32 v76, v64, v65
  v_cvt_pk_bf16_f32 v77, v66, v67
  v_cvt_pk_bf16_f32 v78, v68, v69
  v_cvt_pk_bf16_f32 v79, v70, v71
  buffer_store_dwordx4 v[76:79], v1, s[32:35], s57 offen sc1
  s_lshl_b32 s60, s53, 11
  s_lshr_b32 s58, s63, 1
  s_lshl_b32 s58, s58, 10
  s_add_u32 s60, s60, s58
  s_lshl_b32 s58, s54, 2
  s_add_u32 s60, s60, s58
  s_and_b32 s58, s63, 1
  s_lshl_b32 s58, s58, 6
  s_add_u32 s60, s60, s58
  s_add_u32 s60, s60, 589824
  s_mov_b64 exec, 1
  ds_add_u32 v2, v3 offset:0
  s_mov_b64 exec, -1
  s_mov_b32 s68, s60
  s_setprio 0
  s_waitcnt lgkmcnt(0)
  v_mfma_f32_32x32x16_bf16 v[144:159], v[240:243], v[24:27], v[144:159]
  s_waitcnt vmcnt(11)
  ds_read_b64_tr_b16 v[248:249], v9 offset:2048
  ds_read_b64_tr_b16 v[250:251], v9 offset:3072
  v_mfma_f32_32x32x16_bf16 v[160:175], v[240:243], v[28:31], v[160:175]
  ds_read_b64_tr_b16 v[252:253], v10 offset:2048
  ds_read_b64_tr_b16 v[254:255], v10 offset:3072
  s_add_u32 m0, s72, 0
  s_add_u32 s60, s70, 196608
  buffer_load_dwordx4 v5, s[36:39], s60 offen lds
  buffer_load_dwordx4 v6, s[36:39], s60 offen offset:1024 lds
  v_mfma_f32_32x32x16_bf16 v[176:191], v[244:247], v[24:27], v[176:191]
  v_mfma_f32_32x32x16_bf16 v[192:207], v[244:247], v[28:31], v[192:207]
  s_add_u32 s59, s71, 13312
  buffer_load_dwordx4 v[24:27], v1, s[32:35], s59 offen
  buffer_load_dwordx4 v[28:31], v11, s[32:35], s59 offen
  s_waitcnt lgkmcnt(0)
  v_mfma_f32_32x32x16_bf16 v[144:159], v[248:251], v[32:35], v[144:159]
  s_waitcnt vmcnt(11)
  ds_read_b64_tr_b16 v[240:241], v9 offset:4096
  ds_read_b64_tr_b16 v[242:243], v9 offset:5120
  v_mfma_f32_32x32x16_bf16 v[160:175], v[248:251], v[36:39], v[160:175]
  ds_read_b64_tr_b16 v[244:245], v10 offset:4096
  ds_read_b64_tr_b16 v[246:247], v10 offset:5120
  s_add_u32 m0, s72, 2048
  s_add_u32 s60, s70, 212992
  buffer_load_dwordx4 v5, s[36:39], s60 offen lds
  buffer_load_dwordx4 v6, s[36:39], s60 offen offset:1024 lds
  v_mfma_f32_32x32x16_bf16 v[176:191], v[252:255], v[32:35], v[176:191]
  v_mfma_f32_32x32x16_bf16 v[192:207], v[252:255], v[36:39], v[192:207]
  s_waitcnt vmcnt(6)
  s_setprio 2
  v_lshlrev_b32 v14, 7, v0
  s_mov_b64 exec, 0xff
  buffer_atomic_swap v4, v14, s[32:35], s68 offen sc1
  s_mov_b64 exec, -1
  s_setprio 0
  s_add_u32 s73, s73, 65536
  s_add_u32 s68, s73, 32768
  s_add_u32 s59, s71, 14336
  buffer_load_dwordx4 v[32:35], v1, s[32:35], s59 offen
  buffer_load_dwordx4 v[36:39], v11, s[32:35], s59 offen
  s_waitcnt lgkmcnt(0)
  v_mfma_f32_32x32x16_bf16 v[144:159], v[240:243], v[40:43], v[144:159]
  s_waitcnt vmcnt(12)
  ds_read_b64_tr_b16 v[248:249], v9 offset:6144
  ds_read_b64_tr_b16 v[250:251], v9 offset:7168
  v_mfma_f32_32x32x16_bf16 v[160:175], v[240:243], v[44:47], v[160:175]
  ds_read_b64_tr_b16 v[252:253], v10 offset:6144
  ds_read_b64_tr_b16 v[254:255], v10 offset:7168
  s_add_u32 m0, s72, 4096
  s_add_u32 s60, s70, 229376
  buffer_load_dwordx4 v5, s[36:39], s60 offen lds
  buffer_load_dwordx4 v6, s[36:39], s60 offen offset:1024 lds
  v_mfma_f32_32x32x16_bf16 v[176:191], v[244:247], v[40:43], v[176:191]
  v_mfma_f32_32x32x16_bf16 v[192:207], v[244:247], v[44:47], v[192:207]
  ds_read_b32 v14, v2 offset:0
  s_waitcnt lgkmcnt(0)
  s_setprio 2
  v_cmp_gt_u32 vcc, 76, v14
  s_setprio 0
  s_cbranch_vccnz gs19_spin
gs19_ok:
  s_lshl_b32 s57, s52, 13
  s_add_u32 m0, s57, 65536
  s_lshl_b32 s60, s52, 17
  s_add_u32 s60, s60, 16384
  buffer_load_dwordx4 v5, s[40:43], s60 offen lds
  buffer_load_dwordx4 v6, s[40:43], s60 offen offset:1024 lds
  s_lshl_b32 s57, s52, 13
  s_add_u32 m0, s57, 67584
  s_lshl_b32 s60, s52, 17
  s_add_u32 s60, s60, 49152
  buffer_load_dwordx4 v5, s[40:43], s60 offen lds
  buffer_load_dwordx4 v6, s[40:43], s60 offen offset:1024 lds
  s_lshl_b32 s57, s52, 13
  s_add_u32 m0, s57, 69632
  s_lshl_b32 s60, s52, 17
  s_add_u32 s60, s60, 81920
  buffer_load_dwordx4 v5, s[40:43], s60 offen lds
  buffer_load_dwordx4 v6, s[40:43], s60 offen offset:1024 lds
  s_lshl_b32 s57, s52, 13
  s_add_u32 m0, s57, 71680
  s_lshl_b32 s60, s52, 17
  s_add_u32 s60, s60, 114688
  buffer_load_dwordx4 v5, s[40:43], s60 offen lds
  buffer_load_dwordx4 v6, s[40:43], s60 offen offset:1024 lds
  s_add_u32 s59, s71, 15360
  buffer_load_dwordx4 v[40:43], v1, s[32:35], s59 offen
  buffer_load_dwordx4 v[44:47], v11, s[32:35], s59 offen
  s_waitcnt lgkmcnt(0)
  v_mfma_f32_32x32x16_bf16 v[144:159], v[248:251], v[48:51], v[144:159]
  s_waitcnt vmcnt(19)
  ds_read_b64_tr_b16 v[240:241], v9 offset:0
  ds_read_b64_tr_b16 v[242:243], v9 offset:1024
  v_mfma_f32_32x32x16_bf16 v[160:175], v[248:251], v[52:55], v[160:175]
  ds_read_b64_tr_b16 v[244:245], v10 offset:0
  ds_read_b64_tr_b16 v[246:247], v10 offset:1024
  s_add_u32 m0, s72, 6144
  s_add_u32 s60, s70, 245760
  buffer_load_dwordx4 v5, s[36:39], s60 offen lds
  buffer_load_dwordx4 v6, s[36:39], s60 offen offset:1024 lds
  v_mfma_f32_32x32x16_bf16 v[176:191], v[252:255], v[48:51], v[176:191]
  v_mfma_f32_32x32x16_bf16 v[192:207], v[252:255], v[52:55], v[192:207]
  s_setprio 2
  v_and_b32 v7, 31, v0
  v_lshlrev_b32 v124, 4, v7
  v_lshlrev_b32 v7, 10, v7
  v_lshrrev_b32 v125, 5, v0
  v_lshl_add_u32 v7, v125, 3, v7
  s_setprio 0
  s_lshl_b32 s57, s55, 16
  s_and_b32 s58, s52, 1
  s_lshl_b32 s58, s58, 15
  s_add_u32 s57, s57, s58
  s_lshr_b32 s59, s57, 6
  s_add_u32 s76, s59, 98304
  s_lshl_b32 s58, s56, 7
  s_add_u32 s57, s57, s58
  s_lshr_b32 s58, s52, 1
  s_lshl_b32 s58, s58, 6
  s_add_u32 s75, s57, s58
  buffer_load_dwordx2 v[112:113], v7, s[8:11], s75 offen offset:0
  buffer_load_dwordx2 v[114:115], v7, s[8:11], s75 offen offset:16
  buffer_load_dwordx2 v[116:117], v7, s[8:11], s75 offen offset:32
  buffer_load_dwordx2 v[118:119], v7, s[8:11], s75 offen offset:48
  buffer_load_dwordx4 v[120:123], v124, s[32:35], s76 offen sc1
  s_add_u32 s59, s71, 20480
  buffer_load_dwordx4 v[48:51], v1, s[32:35], s59 offen
  buffer_load_dwordx4 v[52:55], v11, s[32:35], s59 offen
  s_waitcnt lgkmcnt(0)
  v_mfma_f32_32x32x16_bf16 v[144:159], v[240:243], v[16:19], v[144:159]
  s_waitcnt vmcnt(24)
  ds_read_b64_tr_b16 v[248:249], v9 offset:2048
  ds_read_b64_tr_b16 v[250:251], v9 offset:3072
  v_mfma_f32_32x32x16_bf16 v[160:175], v[240:243], v[20:23], v[160:175]
  ds_read_b64_tr_b16 v[252:253], v10 offset:2048
  ds_read_b64_tr_b16 v[254:255], v10 offset:3072
  s_add_u32 m0, s72, 0
  s_add_u32 s60, s70, 327680
  buffer_load_dwordx4 v5, s[36:39], s60 offen lds
  buffer_load_dwordx4 v6, s[36:39], s60 offen offset:1024 lds
  v_mfma_f32_32x32x16_bf16 v[176:191], v[244:247], v[16:19], v[176:191]
  v_mfma_f32_32x32x16_bf16 v[192:207], v[244:247], v[20:23], v[192:207]
  s_add_u32 s59, s71, 21504
  buffer_load_dwordx4 v[16:19], v1, s[32:35], s59 offen
  buffer_load_dwordx4 v[20:23], v11, s[32:35], s59 offen
  s_waitcnt lgkmcnt(0)
  v_mfma_f32_32x32x16_bf16 v[144:159], v[248:251], v[24:27], v[144:159]
  s_waitcnt vmcnt(23)
  ds_read_b64_tr_b16 v[240:241], v9 offset:4096
  ds_read_b64_tr_b16 v[242:243], v9 offset:5120
  v_mfma_f32_32x32x16_bf16 v[160:175], v[248:251], v[28:31], v[160:175]
  ds_read_b64_tr_b16 v[244:245], v10 offset:4096
  ds_read_b64_tr_b16 v[246:247], v10 offset:5120
  s_add_u32 m0, s72, 2048
  s_add_u32 s60, s70, 344064
  buffer_load_dwordx4 v5, s[36:39], s60 offen lds
  buffer_load_dwordx4 v6, s[36:39], s60 offen offset:1024 lds
  v_mfma_f32_32x32x16_bf16 v[176:191], v[252:255], v[24:27], v[176:191]
  v_mfma_f32_32x32x16_bf16 v[192:207], v[252:255], v[28:31], v[192:207]
  s_waitcnt vmcnt(17)
  s_mov_b64 exec, 1
  ds_add_u32 v2, v3 offset:0
  s_mov_b64 exec, -1
  buffer_load_dword v14, v13, s[32:35], s73 offen sc1
  s_add_u32 s59, s71, 22528
  buffer_load_dwordx4 v[24:27], v1, s[32:35], s59 offen
  buffer_load_dwordx4 v[28:31], v11, s[32:35], s59 offen
  s_waitcnt lgkmcnt(0)
  v_mfma_f32_32x32x16_bf16 v[144:159], v[240:243], v[32:35], v[144:159]
  s_waitcnt vmcnt(16)
  ds_read_b64_tr_b16 v[248:249], v9 offset:6144
  ds_read_b64_tr_b16 v[250:251], v9 offset:7168
  v_mfma_f32_32x32x16_bf16 v[160:175], v[240:243], v[36:39], v[160:175]
  ds_read_b64_tr_b16 v[252:253], v10 offset:6144
  ds_read_b64_tr_b16 v[254:255], v10 offset:7168
  s_add_u32 m0, s72, 4096
  s_add_u32 s60, s70, 360448
  buffer_load_dwordx4 v5, s[36:39], s60 offen lds
  buffer_load_dwordx4 v6, s[36:39], s60 offen offset:1024 lds
  v_mfma_f32_32x32x16_bf16 v[176:191], v[244:247], v[32:35], v[176:191]
  v_mfma_f32_32x32x16_bf16 v[192:207], v[244:247], v[36:39], v[192:207]
  s_waitcnt vmcnt(13)
  s_setprio 2
  v_xor_b32 v125, s61, v121
  v_xor_b32 v123, s61, v123
  v_or_b32 v125, v125, v123
  v_cmp_ne_u32 vcc, 0, v125
  s_cbranch_vccnz gst2_spin
gst2_ok:
  s_setprio 0
  s_add_u32 s59, s71, 23552
  buffer_load_dwordx4 v[32:35], v1, s[32:35], s59 offen
  buffer_load_dwordx4 v[36:39], v11, s[32:35], s59 offen
  s_waitcnt lgkmcnt(0)
  v_mfma_f32_32x32x16_bf16 v[144:159], v[248:251], v[40:43], v[144:159]
  s_waitcnt vmcnt(11)
  ds_read_b64_tr_b16 v[240:241], v9 offset:0
  ds_read_b64_tr_b16 v[242:243], v9 offset:1024
  v_mfma_f32_32x32x16_bf16 v[160:175], v[248:251], v[44:47], v[160:175]
  ds_read_b64_tr_b16 v[244:245], v10 offset:0
  ds_read_b64_tr_b16 v[246:247], v10 offset:1024
  s_add_u32 m0, s72, 6144
  s_add_u32 s60, s70, 376832
  buffer_load_dwordx4 v5, s[36:39], s60 offen lds
  buffer_load_dwordx4 v6, s[36:39], s60 offen offset:1024 lds
  v_mfma_f32_32x32x16_bf16 v[176:191], v[252:255], v[40:43], v[176:191]
  v_mfma_f32_32x32x16_bf16 v[192:207], v[252:255], v[44:47], v[192:207]
  s_waitcnt vmcnt(8)
  s_setprio 2
  v_cmp_ne_u32 vcc, s61, v14
  s_cbranch_vccnz po0_spin
po0_ok:
  s_setprio 0
  s_lshl_b32 s59, s55, 16
  s_lshl_b32 s58, s52, 13
  s_add_u32 s59, s59, s58
  s_add_u32 s59, s59, 4194304
  buffer_load_dwordx4 v[40:43], v1, s[32:35], s59 offen
  buffer_load_dwordx4 v[44:47], v8, s[32:35], s59 offen
  s_waitcnt lgkmcnt(0)
  v_mfma_f32_32x32x16_bf16 v[144:159], v[240:243], v[48:51], v[144:159]
  ds_read_b64_tr_b16 v[248:249], v9 offset:2048
  ds_read_b64_tr_b16 v[250:251], v9 offset:3072
  v_mfma_f32_32x32x16_bf16 v[160:175], v[240:243], v[52:55], v[160:175]
  ds_read_b64_tr_b16 v[252:253], v10 offset:2048
  ds_read_b64_tr_b16 v[254:255], v10 offset:3072
  s_add_u32 m0, s72, 0
  s_lshl_b32 s60, s52, 17
  s_add_u32 s60, s60, 0
  buffer_load_dwordx4 v5, s[40:43], s60 offen lds
  buffer_load_dwordx4 v6, s[40:43], s60 offen offset:1024 lds
  v_mfma_f32_32x32x16_bf16 v[176:191], v[244:247], v[48:51], v[176:191]
  v_mfma_f32_32x32x16_bf16 v[192:207], v[244:247], v[52:55], v[192:207]
  ds_read_b32 v14, v2 offset:0
  s_waitcnt lgkmcnt(0)
  s_setprio 2
  v_cmp_gt_u32 vcc, 80, v14
  s_setprio 0
  s_cbranch_vccnz gsw_spin
gsw_ok:
  s_lshr_b32 s58, s52, 1
  s_lshl_b32 s58, s58, 6
  s_setprio 2
  v_xor_b32 v7, s58, v12
  v_add_u32 v7, 65536, v7
  s_setprio 0
  ds_read_b64_tr_b16 v[64:65], v7 offset:0
  ds_read_b64_tr_b16 v[66:67], v7 offset:1024
  ds_read_b64_tr_b16 v[68:69], v7 offset:2048
  ds_read_b64_tr_b16 v[70:71], v7 offset:3072
  s_lshl_b32 s59, s55, 16
  s_lshl_b32 s58, s52, 13
  s_add_u32 s59, s59, s58
  s_add_u32 s59, s59, 4196352
  buffer_load_dwordx4 v[48:51], v1, s[32:35], s59 offen
  buffer_load_dwordx4 v[52:55], v8, s[32:35], s59 offen
  s_waitcnt lgkmcnt(0)
  v_mfma_f32_32x32x16_bf16 v[144:159], v[248:251], v[16:19], v[144:159]
  s_waitcnt vmcnt(10)
  ds_read_b64_tr_b16 v[240:241], v9 offset:4096
  ds_read_b64_tr_b16 v[242:243], v9 offset:5120
  v_mfma_f32_32x32x16_bf16 v[160:175], v[248:251], v[20:23], v[160:175]
  ds_read_b64_tr_b16 v[244:245], v10 offset:4096
  ds_read_b64_tr_b16 v[246:247], v10 offset:5120
  s_add_u32 m0, s72, 2048
  s_lshl_b32 s60, s52, 17
  s_add_u32 s60, s60, 32768
  buffer_load_dwordx4 v5, s[40:43], s60 offen lds
  buffer_load_dwordx4 v6, s[40:43], s60 offen offset:1024 lds
  v_mfma_f32_32x32x16_bf16 v[176:191], v[252:255], v[16:19], v[176:191]
  v_mfma_f32_32x32x16_bf16 v[192:207], v[252:255], v[20:23], v[192:207]
  ds_read_b64_tr_b16 v[72:73], v7 offset:4096
  ds_read_b64_tr_b16 v[74:75], v7 offset:5120
  ds_read_b64_tr_b16 v[76:77], v7 offset:6144
  ds_read_b64_tr_b16 v[78:79], v7 offset:7168
  s_lshl_b32 s59, s55, 16
  s_lshl_b32 s58, s52, 13
  s_add_u32 s59, s59, s58
  s_add_u32 s59, s59, 4198400
  buffer_load_dwordx4 v[16:19], v1, s[32:35], s59 offen
  buffer_load_dwordx4 v[20:23], v8, s[32:35], s59 offen
  s_waitcnt lgkmcnt(0)
  v_mfma_f32_32x32x16_bf16 v[144:159], v[240:243], v[24:27], v[144:159]
  s_waitcnt vmcnt(10)
  ds_read_b64_tr_b16 v[248:249], v9 offset:6144
  ds_read_b64_tr_b16 v[250:251], v9 offset:7168
  v_mfma_f32_32x32x16_bf16 v[160:175], v[240:243], v[28:31], v[160:175]
  ds_read_b64_tr_b16 v[252:253], v10 offset:6144
  ds_read_b64_tr_b16 v[254:255], v10 offset:7168
  s_add_u32 m0, s72, 4096
  s_lshl_b32 s60, s52, 17
  s_add_u32 s60, s60, 65536
  buffer_load_dwordx4 v5, s[40:43], s60 offen lds
  buffer_load_dwordx4 v6, s[40:43], s60 offen offset:1024 lds
  v_mfma_f32_32x32x16_bf16 v[176:191], v[244:247], v[24:27], v[176:191]
  v_mfma_f32_32x32x16_bf16 v[192:207], v[244:247], v[28:31], v[192:207]
  ds_read_b64_tr_b16 v[80:81], v7 offset:8192
  ds_read_b64_tr_b16 v[82:83], v7 offset:9216
  ds_read_b64_tr_b16 v[84:85], v7 offset:10240
  ds_read_b64_tr_b16 v[86:87], v7 offset:11264
  s_lshl_b32 s59, s55, 16
  s_lshl_b32 s58, s52, 13
  s_add_u32 s59, s59, s58
  s_add_u32 s59, s59, 4200448
  buffer_load_dwordx4 v[24:27], v1, s[32:35], s59 offen
  buffer_load_dwordx4 v[28:31], v8, s[32:35], s59 offen
  s_waitcnt lgkmcnt(0)
  v_mfma_f32_32x32x16_bf16 v[144:159], v[248:251], v[32:35], v[144:159]
  s_waitcnt vmcnt(10)
  ds_read_b64_tr_b16 v[240:241], v9 offset:0
  ds_read_b64_tr_b16 v[242:243], v9 offset:1024
  v_mfma_f32_32x32x16_bf16 v[160:175], v[248:251], v[36:39], v[160:175]
  ds_read_b64_tr_b16 v[244:245], v10 offset:0
  ds_read_b64_tr_b16 v[246:247], v10 offset:1024
  s_add_u32 m0, s72, 6144
  s_lshl_b32 s60, s52, 17
  s_add_u32 s60, s60, 98304
  buffer_load_dwordx4 v5, s[40:43], s60 offen lds
  buffer_load_dwordx4 v6, s[40:43], s60 offen offset:1024 lds
  v_mfma_f32_32x32x16_bf16 v[176:191], v[252:255], v[32:35], v[176:191]
  v_mfma_f32_32x32x16_bf16 v[192:207], v[252:255], v[36:39], v[192:207]
  ds_read_b64_tr_b16 v[88:89], v7 offset:12288
  ds_read_b64_tr_b16 v[90:91], v7 offset:13312
  ds_read_b64_tr_b16 v[92:93], v7 offset:14336
  ds_read_b64_tr_b16 v[94:95], v7 offset:15360
  s_waitcnt lgkmcnt(0)
  v_mfma_f32_32x32x16_bf16 v[144:159], v[240:243], v[40:43], v[144:159]
  s_waitcnt vmcnt(8)
  ds_read_b64_tr_b16 v[248:249], v9 offset:2048
  ds_read_b64_tr_b16 v[250:251], v9 offset:3072
  v_mfma_f32_32x32x16_bf16 v[160:175], v[240:243], v[44:47], v[160:175]
  ds_read_b64_tr_b16 v[252:253], v10 offset:2048
  ds_read_b64_tr_b16 v[254:255], v10 offset:3072
  v_mfma_f32_32x32x16_bf16 v[176:191], v[244:247], v[40:43], v[176:191]
  v_mfma_f32_32x32x16_bf16 v[192:207], v[244:247], v[44:47], v[192:207]
  ds_read_b64_tr_b16 v[96:97], v7 offset:16384
  ds_read_b64_tr_b16 v[98:99], v7 offset:17408
  ds_read_b64_tr_b16 v[100:101], v7 offset:18432
  ds_read_b64_tr_b16 v[102:103], v7 offset:19456
  s_waitcnt lgkmcnt(0)
  v_mfma_f32_32x32x16_bf16 v[144:159], v[248:251], v[48:51], v[144:159]
  s_waitcnt vmcnt(4)
  ds_read_b64_tr_b16 v[240:241], v9 offset:4096
  ds_read_b64_tr_b16 v[242:243], v9 offset:5120
  v_mfma_f32_32x32x16_bf16 v[160:175], v[248:251], v[52:55], v[160:175]
  ds_read_b64_tr_b16 v[244:245], v10 offset:4096
  ds_read_b64_tr_b16 v[246:247], v10 offset:5120
  v_mfma_f32_32x32x16_bf16 v[176:191], v[252:255], v[48:51], v[176:191]
  v_mfma_f32_32x32x16_bf16 v[192:207], v[252:255], v[52:55], v[192:207]
  ds_read_b64_tr_b16 v[104:105], v7 offset:20480
  ds_read_b64_tr_b16 v[106:107], v7 offset:21504
  ds_read_b64_tr_b16 v[108:109], v7 offset:22528
  ds_read_b64_tr_b16 v[110:111], v7 offset:23552
  s_waitcnt lgkmcnt(0)
  v_mfma_f32_32x32x16_bf16 v[144:159], v[240:243], v[16:19], v[144:159]
  s_waitcnt vmcnt(0)
  ds_read_b64_tr_b16 v[248:249], v9 offset:6144
  ds_read_b64_tr_b16 v[250:251], v9 offset:7168
  v_mfma_f32_32x32x16_bf16 v[160:175], v[240:243], v[20:23], v[160:175]
  ds_read_b64_tr_b16 v[252:253], v10 offset:6144
  ds_read_b64_tr_b16 v[254:255], v10 offset:7168
  v_mfma_f32_32x32x16_bf16 v[176:191], v[244:247], v[16:19], v[176:191]
  v_mfma_f32_32x32x16_bf16 v[192:207], v[244:247], v[20:23], v[192:207]
  ds_read_b64_tr_b16 v[208:209], v7 offset:24576
  ds_read_b64_tr_b16 v[210:211], v7 offset:25600
  ds_read_b64_tr_b16 v[212:213], v7 offset:26624
  ds_read_b64_tr_b16 v[214:215], v7 offset:27648
  s_waitcnt lgkmcnt(0)
  v_mfma_f32_32x32x16_bf16 v[144:159], v[248:251], v[24:27], v[144:159]
  v_mfma_f32_32x32x16_bf16 v[160:175], v[248:251], v[28:31], v[160:175]
  v_mfma_f32_32x32x16_bf16 v[176:191], v[252:255], v[24:27], v[176:191]
  v_mfma_f32_32x32x16_bf16 v[192:207], v[252:255], v[28:31], v[192:207]
  ds_read_b64_tr_b16 v[216:217], v7 offset:28672
  ds_read_b64_tr_b16 v[218:219], v7 offset:29696
  ds_read_b64_tr_b16 v[220:221], v7 offset:30720
  ds_read_b64_tr_b16 v[222:223], v7 offset:31744
  s_setprio 2
  v_add_u32 v7, s72, v1
  s_nop 7
  s_cmp_eq_u32 s52, 0
  s_cbranch_scc1 g_sk0
  ds_write_b128 v7, v[144:147] offset:0
  ds_write_b128 v7, v[148:151] offset:1024
  ds_write_b128 v7, v[152:155] offset:2048
  ds_write_b128 v7, v[156:159] offset:3072
g_sk0:
  s_cmp_eq_u32 s52, 1
  s_cbranch_scc1 g_sk1
  ds_write_b128 v7, v[160:163] offset:4096
  ds_write_b128 v7, v[164:167] offset:5120
  ds_write_b128 v7, v[168:171] offset:6144
  ds_write_b128 v7, v[172:175] offset:7168
g_sk1:
  s_cmp_eq_u32 s52, 2
  s_cbranch_scc1 g_sk2
  ds_write_b128 v7, v[176:179] offset:32768
  ds_write_b128 v7, v[180:183] offset:33792
  ds_write_b128 v7, v[184:187] offset:34816
  ds_write_b128 v7, v[188:191] offset:35840
g_sk2:
  s_cmp_eq_u32 s52, 3
  s_cbranch_scc1 g_sk3
  ds_write_b128 v7, v[192:195] offset:36864
  ds_write_b128 v7, v[196:199] offset:37888
  ds_write_b128 v7, v[200:203] offset:38912
  ds_write_b128 v7, v[204:207] offset:39936
g_sk3:
  s_and_b32 s58, s52, 1
  s_lshl_b32 s58, s58, 12
  s_lshr_b32 s59, s52, 1
  s_lshl_b32 s59, s59, 15
  s_add_u32 s58, s58, s59
  v_add_u32 v9, s58, v1
  s_waitcnt lgkmcnt(0)
  s_mov_b64 exec, 1
  ds_add_u32 v2, v3 offset:0
  s_mov_b64 exec, -1
  ds_read_b32 v7, v2 offset:0
  s_waitcnt lgkmcnt(0)
  v_cmp_gt_u32 vcc, 84, v7
  s_cbranch_vccnz gs21_spin
gs21_ok:
  s_cmp_lg_u32 s52, 0
  s_cbranch_scc1 g_rv1
  ds_read_b128 v[160:163], v9 offset:8192
  ds_read_b128 v[164:167], v9 offset:9216
  ds_read_b128 v[168:171], v9 offset:10240
  ds_read_b128 v[172:175], v9 offset:11264
  ds_read_b128 v[176:179], v9 offset:16384
  ds_read_b128 v[180:183], v9 offset:17408
  ds_read_b128 v[184:187], v9 offset:18432
  ds_read_b128 v[188:191], v9 offset:19456
  ds_read_b128 v[192:195], v9 offset:24576
  ds_read_b128 v[196:199], v9 offset:25600
  ds_read_b128 v[200:203], v9 offset:26624
  ds_read_b128 v[204:207], v9 offset:27648
  s_waitcnt lgkmcnt(0)
  s_branch g_rvj
g_rv1:
  s_cmp_lg_u32 s52, 1
  s_cbranch_scc1 g_rv2
  ds_read_b128 v[144:147], v9 offset:0
  ds_read_b128 v[148:151], v9 offset:1024
  ds_read_b128 v[152:155], v9 offset:2048
  ds_read_b128 v[156:159], v9 offset:3072
  ds_read_b128 v[176:179], v9 offset:16384
  ds_read_b128 v[180:183], v9 offset:17408
  ds_read_b128 v[184:187], v9 offset:18432
  ds_read_b128 v[188:191], v9 offset:19456
  ds_read_b128 v[192:195], v9 offset:24576
  ds_read_b128 v[196:199], v9 offset:25600
  ds_read_b128 v[200:203], v9 offset:26624
  ds_read_b128 v[204:207], v9 offset:27648
  s_waitcnt lgkmcnt(0)
  s_branch g_rvj
g_rv2:
  s_cmp_lg_u32 s52, 2
  s_cbranch_scc1 g_rv3
  ds_read_b128 v[144:147], v9 offset:0
  ds_read_b128 v[148:151], v9 offset:1024
  ds_read_b128 v[152:155], v9 offset:2048
  ds_read_b128 v[156:159], v9 offset:3072
  ds_read_b128 v[160:163], v9 offset:8192
  ds_read_b128 v[164:167], v9 offset:9216
  ds_read_b128 v[168:171], v9 offset:10240
  ds_read_b128 v[172:175], v9 offset:11264
  ds_read_b128 v[192:195], v9 offset:24576
  ds_read_b128 v[196:199], v9 offset:25600
  ds_read_b128 v[200:203], v9 offset:26624
  ds_read_b128 v[204:207], v9 offset:27648
  s_waitcnt lgkmcnt(0)
  s_branch g_rvj
g_rv3:
  ds_read_b128 v[144:147], v9 offset:0
  ds_read_b128 v[148:151], v9 offset:1024
  ds_read_b128 v[152:155], v9 offset:2048
  ds_read_b128 v[156:159], v9 offset:3072
  ds_read_b128 v[160:163], v9 offset:8192
  ds_read_b128 v[164:167], v9 offset:9216
  ds_read_b128 v[168:171], v9 offset:10240
  ds_read_b128 v[172:175], v9 offset:11264
  ds_read_b128 v[176:179], v9 offset:16384
  ds_read_b128 v[180:183], v9 offset:17408
  ds_read_b128 v[184:187], v9 offset:18432
  ds_read_b128 v[188:191], v9 offset:19456
  s_waitcnt lgkmcnt(0)
g_rvj:
  v_mul_f32 v10, v122, v122
  s_lshl_b32 s71, s55, 16
  s_and_b32 s58, s52, 1
  s_lshl_b32 s58, s58, 15
  s_add_u32 s71, s71, s58
  s_add_u32 s71, s71, 4194304
  v_and_b32 v7, 15, v0
  v_lshlrev_b32 v7, 10, v7
  v_lshrrev_b32 v8, 5, v0
  v_lshl_add_u32 v7, v8, 4, v7
  v_and_b32 v8, 16, v0
  v_lshl_add_u32 v7, v8, 1, v7
  s_waitcnt lgkmcnt(0)
  s_and_b32 s58, s52, 1
  s_lshl_b32 s58, s58, 6
  s_add_u32 s58, s58, s68
  s_load_dwordx16 s[12:27], s[32:33], s58 glc
  s_mov_b32 s28, s61
  s_mov_b32 s29, s61
  v_pk_add_f32 v[144:145], v[144:145], v[160:161]
  v_pk_add_f32 v[176:177], v[176:177], v[192:193]
  v_pk_add_f32 v[146:147], v[146:147], v[162:163]
  v_pk_add_f32 v[178:179], v[178:179], v[194:195]
  v_pk_add_f32 v[148:149], v[148:149], v[164:165]
  v_pk_add_f32 v[180:181], v[180:181], v[196:197]
  v_pk_add_f32 v[150:151], v[150:151], v[166:167]
  v_pk_add_f32 v[182:183], v[182:183], v[198:199]
  v_pk_add_f32 v[152:153], v[152:153], v[168:169]
  v_pk_add_f32 v[184:185], v[184:185], v[200:201]
  v_pk_add_f32 v[154:155], v[154:155], v[170:171]
  v_pk_add_f32 v[186:187], v[186:187], v[202:203]
  v_pk_add_f32 v[156:157], v[156:157], v[172:173]
  v_pk_add_f32 v[188:189], v[188:189], v[204:205]
  v_pk_add_f32 v[158:159], v[158:159], v[174:175]
  v_pk_add_f32 v[190:191], v[190:191], v[206:207]
  v_pk_add_f32 v[144:145], v[144:145], v[176:177]
  v_pk_add_f32 v[146:147], v[146:147], v[178:179]
  v_pk_add_f32 v[148:149], v[148:149], v[180:181]
  v_pk_add_f32 v[150:151], v[150:151], v[182:183]
  v_pk_add_f32 v[152:153], v[152:153], v[184:185]
  v_pk_add_f32 v[154:155], v[154:155], v[186:187]
  v_pk_add_f32 v[156:157], v[156:157], v[188:189]
  v_pk_add_f32 v[158:159], v[158:159], v[190:191]
  v_lshlrev_b32 v9, 16, v112
  v_and_b32 v8, s64, v112
  v_fma_f32 v144, v144, v10, v9
  v_fma_f32 v145, v145, v10, v8
  v_lshlrev_b32 v9, 16, v113
  v_and_b32 v8, s64, v113
  v_fma_f32 v146, v146, v10, v9
  v_fma_f32 v147, v147, v10, v8
  v_lshlrev_b32 v9, 16, v114
  v_and_b32 v8, s64, v114
  v_fma_f32 v148, v148, v10, v9
  v_fma_f32 v149, v149, v10, v8
  v_lshlrev_b32 v9, 16, v115
  v_and_b32 v8, s64, v115
  v_fma_f32 v150, v150, v10, v9
  v_fma_f32 v151, v151, v10, v8
  v_lshlrev_b32 v9, 16, v116
  v_and_b32 v8, s64, v116
  v_fma_f32 v152, v152, v10, v9
  v_fma_f32 v153, v153, v10, v8
  v_lshlrev_b32 v9, 16, v117
  v_and_b32 v8, s64, v117
  v_fma_f32 v154, v154, v10, v9
  v_fma_f32 v155, v155, v10, v8
  v_lshlrev_b32 v9, 16, v118
  v_and_b32 v8, s64, v118
  v_fma_f32 v156, v156, v10, v9
  v_fma_f32 v157, v157, v10, v8
  v_lshlrev_b32 v9, 16, v119
  v_and_b32 v8, s64, v119
  v_fma_f32 v158, v158, v10, v9
  v_fma_f32 v159, v159, v10, v8
  s_and_b32 s58, s52, 1
  s_lshl_b32 s58, s58, 6
  s_add_u32 s58, s58, s68
  s_waitcnt lgkmcnt(0)
  s_xor_b64 s[12:13], s[12:13], s[28:29]
  s_xor_b64 s[14:15], s[14:15], s[28:29]
  s_xor_b64 s[16:17], s[16:17], s[28:29]
  s_xor_b64 s[18:19], s[18:19], s[28:29]
  s_xor_b64 s[20:21], s[20:21], s[28:29]
  s_xor_b64 s[22:23], s[22:23], s[28:29]
  s_xor_b64 s[24:25], s[24:25], s[28:29]
  s_xor_b64 s[26:27], s[26:27], s[28:29]
  s_or_b64 s[12:13], s[12:13], s[14:15]
  s_or_b64 s[12:13], s[12:13], s[16:17]
  s_or_b64 s[12:13], s[12:13], s[18:19]
  s_or_b64 s[12:13], s[12:13], s[20:21]
  s_or_b64 s[12:13], s[12:13], s[22:23]
  s_or_b64 s[12:13], s[12:13], s[24:25]
  s_or_b64 s[12:13], s[12:13], s[26:27]
  s_cbranch_scc0 po1_d
  s_mov_b32 s28, s61
  s_mov_b32 s29, s61
  s_mov_b32 s62, 200000
po1_l:
  s_load_dwordx16 s[12:27], s[32:33], s58 glc
  s_waitcnt lgkmcnt(0)
  s_xor_b64 s[12:13], s[12:13], s[28:29]
  s_xor_b64 s[14:15], s[14:15], s[28:29]
  s_xor_b64 s[16:17], s[16:17], s[28:29]
  s_xor_b64 s[18:19], s[18:19], s[28:29]
  s_xor_b64 s[20:21], s[20:21], s[28:29]
  s_xor_b64 s[22:23], s[22:23], s[28:29]
  s_xor_b64 s[24:25], s[24:25], s[28:29]
  s_xor_b64 s[26:27], s[26:27], s[28:29]
  s_or_b64 s[12:13], s[12:13], s[14:15]
  s_or_b64 s[12:13], s[12:13], s[16:17]
  s_or_b64 s[12:13], s[12:13], s[18:19]
  s_or_b64 s[12:13], s[12:13], s[20:21]
  s_or_b64 s[12:13], s[12:13], s[22:23]
  s_or_b64 s[12:13], s[12:13], s[24:25]
  s_or_b64 s[12:13], s[12:13], s[26:27]
  s_cbranch_scc0 po1_d
  s_sleep 1
  s_sub_u32 s62, s62, 1
  s_cmp_lg_u32 s62, 0
  s_cbranch_scc1 po1_l
po1_d:
  s_add_u32 s57, s71, 0
  buffer_load_dwordx4 v[16:19], v1, s[32:35], s57 offen offset:1024
  buffer_load_dwordx4 v[20:23], v1, s[32:35], s57 offen offset:3072
  s_add_u32 s57, s71, 4096
  buffer_load_dwordx4 v[24:27], v1, s[32:35], s57 offen offset:1024
  buffer_load_dwordx4 v[28:31], v1, s[32:35], s57 offen offset:3072
  s_add_u32 s57, s71, 8192
  buffer_load_dwordx4 v[32:35], v1, s[32:35], s57 offen offset:1024
  buffer_load_dwordx4 v[36:39], v1, s[32:35], s57 offen offset:3072
  s_add_u32 s57, s71, 12288
  buffer_load_dwordx4 v[40:43], v1, s[32:35], s57 offen offset:1024
  buffer_load_dwordx4 v[44:47], v1, s[32:35], s57 offen offset:3072
  s_add_u32 s57, s71, 16384
  buffer_load_dwordx4 v[48:51], v1, s[32:35], s57 offen offset:1024
  buffer_load_dwordx4 v[52:55], v1, s[32:35], s57 offen offset:3072
  s_add_u32 s57, s71, 20480
  buffer_load_dwordx4 v[56:59], v1, s[32:35], s57 offen offset:1024
  buffer_load_dwordx4 v[60:63], v1, s[32:35], s57 offen offset:3072
  s_add_u32 s57, s71, 24576
  buffer_load_dwordx4 v[176:179], v1, s[32:35], s57 offen offset:1024
  buffer_load_dwordx4 v[180:183], v1, s[32:35], s57 offen offset:3072
  s_add_u32 s57, s71, 28672
  buffer_load_dwordx4 v[184:187], v1, s[32:35], s57 offen offset:1024
  buffer_load_dwordx4 v[188:191], v1, s[32:35], s57 offen offset:3072
  s_waitcnt vmcnt(15)
  v_mfma_f32_32x32x16_bf16 v[144:159], v[64:67], v[16:19], v[144:159]
  s_waitcnt vmcnt(14)
  v_mfma_f32_32x32x16_bf16 v[144:159], v[68:71], v[20:23], v[144:159]
  s_waitcnt vmcnt(13)
  v_mfma_f32_32x32x16_bf16 v[144:159], v[72:75], v[24:27], v[144:159]
  s_waitcnt vmcnt(12)
  v_mfma_f32_32x32x16_bf16 v[144:159], v[76:79], v[28:31], v[144:159]
  s_waitcnt vmcnt(11)
  v_mfma_f32_32x32x16_bf16 v[144:159], v[80:83], v[32:35], v[144:159]
  s_waitcnt vmcnt(10)
  v_mfma_f32_32x32x16_bf16 v[144:159], v[84:87], v[36:39], v[144:159]
  s_waitcnt vmcnt(9)
  v_mfma_f32_32x32x16_bf16 v[144:159], v[88:91], v[40:43], v[144:159]
  s_waitcnt vmcnt(8)
  v_mfma_f32_32x32x16_bf16 v[144:159], v[92:95], v[44:47], v[144:159]
  s_waitcnt vmcnt(7)
  v_mfma_f32_32x32x16_bf16 v[144:159], v[96:99], v[48:51], v[144:159]
  s_waitcnt vmcnt(6)
  v_mfma_f32_32x32x16_bf16 v[144:159], v[100:103], v[52:55], v[144:159]
  s_waitcnt vmcnt(5)
  v_mfma_f32_32x32x16_bf16 v[144:159], v[104:107], v[56:59], v[144:159]
  s_waitcnt vmcnt(4)
  v_mfma_f32_32x32x16_bf16 v[144:159], v[108:111], v[60:63], v[144:159]
  s_waitcnt vmcnt(3)
  v_mfma_f32_32x32x16_bf16 v[144:159], v[208:211], v[176:179], v[144:159]
  s_waitcnt vmcnt(2)
  v_mfma_f32_32x32x16_bf16 v[144:159], v[212:215], v[180:183], v[144:159]
  s_waitcnt vmcnt(1)
  v_mfma_f32_32x32x16_bf16 v[144:159], v[216:219], v[184:187], v[144:159]
  s_waitcnt vmcnt(0)
  v_mfma_f32_32x32x16_bf16 v[144:159], v[220:223], v[188:191], v[144:159]
  s_nop 13
  v_cvt_pk_bf16_f32 v160, v144, v145
  v_cvt_pk_bf16_f32 v161, v146, v147
  v_cvt_pk_bf16_f32 v162, v148, v149
  v_cvt_pk_bf16_f32 v163, v150, v151
  v_cvt_pk_bf16_f32 v164, v152, v153
  v_cvt_pk_bf16_f32 v165, v154, v155
  v_cvt_pk_bf16_f32 v166, v156, v157
  v_cvt_pk_bf16_f32 v167, v158, v159
  s_nop 0
  v_permlane32_swap_b32 v160, v162
  v_permlane32_swap_b32 v161, v163
  v_permlane32_swap_b32 v164, v166
  v_permlane32_swap_b32 v165, v167
  s_nop 1
  v_permlane16_swap_b32 v160, v164
  v_permlane16_swap_b32 v161, v165
  v_permlane16_swap_b32 v162, v166
  v_permlane16_swap_b32 v163, v167
  s_add_u32 s57, s75, 16384
  s_nop 1
  buffer_store_dwordx4 v[160:163], v7, s[44:47], s75 offen sc1
  buffer_store_dwordx4 v[164:167], v7, s[44:47], s57 offen sc1
  s_endpgm
acs_spin:
  s_mov_b32 s62, 1600000
acs_loop:
  s_sleep 2
  ds_read_b32 v24, v2 offset:0
  s_waitcnt lgkmcnt(0)
  v_cmp_gt_u32 vcc, 4, v24
  s_cbranch_vccz acs_ok
  s_sub_u32 s62, s62, 1
  s_cmp_lg_u32 s62, 0
  s_cbranch_scc1 acs_loop
  s_branch acs_ok
axn_spin:
  s_mov_b32 s62, 1600000
axn_loop:
  s_sleep 2
  ds_read_b32 v24, v2 offset:96
  s_waitcnt lgkmcnt(0)
  v_cmp_gt_u32 vcc, 4, v24
  s_cbranch_vccz axn_ok
  s_sub_u32 s62, s62, 1
  s_cmp_lg_u32 s62, 0
  s_cbranch_scc1 axn_loop
  s_branch axn_ok
kvv_spin:
  s_mov_b32 s62, 1600000
kvv_loop:
  s_sleep 2
  ds_read_b32 v149, v2 offset:80
  s_waitcnt lgkmcnt(0)
  v_cmp_gt_u32 vcc, 1, v149
  s_cbranch_vccz kvv_ok
  s_sub_u32 s62, s62, 1
  s_cmp_lg_u32 s62, 0
  s_cbranch_scc1 kvv_loop
  s_branch kvv_ok
akf_spin:
  s_mov_b32 s62, 1600000
akf_loop:
  s_sleep 2
  ds_read_b32 v6, v2 offset:144
  s_waitcnt lgkmcnt(0)
  v_cmp_gt_u32 vcc, 1, v6
  s_cbranch_vccz akf_ok
  s_sub_u32 s62, s62, 1
  s_cmp_lg_u32 s62, 0
  s_cbranch_scc1 akf_loop
  s_branch akf_ok
aq_spin:
  s_mov_b32 s62, 1600000
aq_loop:
  s_sleep 2
  ds_read_b32 v6, v2 offset:16
  s_waitcnt lgkmcnt(0)
  v_cmp_gt_u32 vcc, 4, v6
  s_cbranch_vccz aq_ok
  s_sub_u32 s62, s62, 1
  s_cmp_lg_u32 s62, 0
  s_cbranch_scc1 aq_loop
  s_branch aq_ok
skr2_spin:
  s_mov_b32 s62, 200000
skr2_loop:
  s_sleep 1
  s_load_dwordx16 s[8:23], s[32:33], s74 glc
  s_waitcnt lgkmcnt(0)
  s_xor_b64 s[8:9], s[8:9], s[24:25]
  s_xor_b64 s[10:11], s[10:11], s[24:25]
  s_xor_b64 s[12:13], s[12:13], s[24:25]
  s_xor_b64 s[14:15], s[14:15], s[24:25]
  s_xor_b64 s[16:17], s[16:17], s[24:25]
  s_xor_b64 s[18:19], s[18:19], s[24:25]
  s_xor_b64 s[20:21], s[20:21], s[24:25]
  s_xor_b64 s[22:23], s[22:23], s[24:25]
  s_or_b64 s[8:9], s[8:9], s[10:11]
  s_or_b64 s[12:13], s[12:13], s[14:15]
  s_or_b64 s[16:17], s[16:17], s[18:19]
  s_or_b64 s[20:21], s[20:21], s[22:23]
  s_or_b64 s[8:9], s[8:9], s[12:13]
  s_or_b64 s[16:17], s[16:17], s[20:21]
  s_or_b64 s[8:9], s[8:9], s[16:17]
  s_cbranch_scc0 skr2_ok
  s_sub_u32 s62, s62, 1
  s_cmp_lg_u32 s62, 0
  s_cbranch_scc1 skr2_loop
  s_branch skr2_ok
skr3_spin:
  s_mov_b32 s62, 200000
skr3_loop:
  s_sleep 1
  s_load_dwordx16 s[8:23], s[32:33], s75 glc
  s_waitcnt lgkmcnt(0)
  s_xor_b64 s[8:9], s[8:9], s[24:25]
  s_xor_b64 s[10:11], s[10:11], s[24:25]
  s_xor_b64 s[12:13], s[12:13], s[24:25]
  s_xor_b64 s[14:15], s[14:15], s[24:25]
  s_xor_b64 s[16:17], s[16:17], s[24:25]
  s_xor_b64 s[18:19], s[18:19], s[24:25]
  s_xor_b64 s[20:21], s[20:21], s[24:25]
  s_xor_b64 s[22:23], s[22:23], s[24:25]
  s_or_b64 s[8:9], s[8:9], s[10:11]
  s_or_b64 s[12:13], s[12:13], s[14:15]
  s_or_b64 s[16:17], s[16:17], s[18:19]
  s_or_b64 s[20:21], s[20:21], s[22:23]
  s_or_b64 s[8:9], s[8:9], s[12:13]
  s_or_b64 s[16:17], s[16:17], s[20:21]
  s_or_b64 s[8:9], s[8:9], s[16:17]
  s_cbranch_scc0 skr3_ok
  s_sub_u32 s62, s62, 1
  s_cmp_lg_u32 s62, 0
  s_cbranch_scc1 skr3_loop
  s_branch skr3_ok
la_spin:
  s_mov_b32 s62, 1600000
la_loop:
  s_sleep 2
  ds_read_b32 v6, v2 offset:64
  s_waitcnt lgkmcnt(0)
  v_cmp_gt_u32 vcc, 4, v6
  s_cbranch_vccz la_ok
  s_sub_u32 s62, s62, 1
  s_cmp_lg_u32 s62, 0
  s_cbranch_scc1 la_loop
  s_branch la_ok
ry_slow:
  s_lshl_b32 s57, s63, 10
  s_add_u32 s57, s57, 143360
  v_add_u32 v176, s57, v1
  ds_read_b128 v[176:179], v176
  s_waitcnt lgkmcnt(0)
  v_lshrrev_b32 v234, 1, v1
  v_xor_b32 v234, v234, v1
  v_and_b32 v234, 64, v234
  v_lshl_or_b32 v234, v234, 1, v234
  v_xor_b32 v235, v1, v234
  v_mov_b32 v232, 0xff800000
  s_mov_b32 s57, 262144
  s_mov_b32 s58, 64
ry_l1:
  buffer_load_dwordx4 v[180:183], v235, s[32:35], s57 offen sc1
  s_waitcnt vmcnt(0)
  v_mfma_f32_32x32x16_bf16 v[192:207], v[180:183], v[176:179], 0
  s_nop 13
  v_max3_f32 v232, v192, v193, v232
  v_max3_f32 v232, v194, v195, v232
  v_max3_f32 v232, v196, v197, v232
  v_max3_f32 v232, v198, v199, v232
  v_max3_f32 v232, v200, v201, v232
  v_max3_f32 v232, v202, v203, v232
  v_max3_f32 v232, v204, v205, v232
  v_max3_f32 v232, v206, v207, v232
  s_add_u32 s57, s57, 1024
  s_sub_u32 s58, s58, 1
  s_cmp_lg_u32 s58, 0
  s_cbranch_scc1 ry_l1
  v_mov_b32 v233, v232
  s_nop 1
  v_permlane32_swap_b32 v232, v233
  s_nop 1
  v_max_f32 v232, v232, v233
  v_sub_f32 v140, 0, v232
  v_mov_b32 v216, 0
  v_sub_f32 v141, 0, v232
  v_mov_b32 v217, 0
  v_sub_f32 v142, 0, v232
  v_mov_b32 v218, 0
  v_sub_f32 v143, 0, v232
  v_mov_b32 v219, 0
  v_sub_f32 v144, 0, v232
  v_mov_b32 v220, 0
  v_sub_f32 v145, 0, v232
  v_mov_b32 v221, 0
  v_sub_f32 v146, 0, v232
  v_mov_b32 v222, 0
  v_sub_f32 v147, 0, v232
  v_mov_b32 v223, 0
  v_sub_f32 v148, 0, v232
  v_mov_b32 v224, 0
  v_sub_f32 v149, 0, v232
  v_mov_b32 v225, 0
  v_sub_f32 v150, 0, v232
  v_mov_b32 v226, 0
  v_sub_f32 v151, 0, v232
  v_mov_b32 v227, 0
  v_sub_f32 v152, 0, v232
  v_mov_b32 v228, 0
  v_sub_f32 v153, 0, v232
  v_mov_b32 v229, 0
  v_sub_f32 v154, 0, v232
  v_mov_b32 v230, 0
  v_sub_f32 v155, 0, v232
  v_mov_b32 v231, 0
  v_and_b32 v234, 27, v0
  v_cmp_eq_u32 vcc, 16, v234
  v_mov_b32 v234, s65
  s_nop 0
  v_cndmask_b32 v184, 0, v234, vcc
  v_mov_b32 v185, v184
  v_mov_b32 v186, v184
  v_mov_b32 v187, v184
  v_mov_b32 v188, v184
  v_mov_b32 v189, v184
  v_mov_b32 v190, v184
  v_mov_b32 v191, v184
  s_mov_b32 s57, 262144
  s_mov_b32 s59, 327680
  s_mov_b32 s58, 64
ry_l2:
  buffer_load_dwordx4 v[180:183], v235, s[32:35], s57 offen sc1
  s_mov_b32 exec_lo, 0xffff
  s_mov_b32 exec_hi, 0xffff
  buffer_load_dwordx4 v[184:187], v1, s[32:35], s59 offen sc1
  buffer_load_dwordx4 v[188:191], v1, s[32:35], s59 offen offset:1024 sc1
  s_mov_b64 exec, -1
  s_waitcnt vmcnt(0)
  v_mfma_f32_32x32x16_bf16 v[192:207], v[180:183], v[176:179], v[140:155]
  s_nop 13
  v_exp_f32 v192, v192
  v_exp_f32 v193, v193
  v_exp_f32 v194, v194
  v_exp_f32 v195, v195
  v_exp_f32 v196, v196
  v_exp_f32 v197, v197
  v_exp_f32 v198, v198
  v_exp_f32 v199, v199
  v_exp_f32 v200, v200
  v_exp_f32 v201, v201
  v_exp_f32 v202, v202
  v_exp_f32 v203, v203
  v_exp_f32 v204, v204
  v_exp_f32 v205, v205
  v_exp_f32 v206, v206
  v_exp_f32 v207, v207
  s_nop 0
  v_cvt_pk_bf16_f32 v208, v192, v193
  v_cvt_pk_bf16_f32 v209, v194, v195
  v_cvt_pk_bf16_f32 v210, v196, v197
  v_cvt_pk_bf16_f32 v211, v198, v199
  v_cvt_pk_bf16_f32 v212, v200, v201
  v_cvt_pk_bf16_f32 v213, v202, v203
  v_cvt_pk_bf16_f32 v214, v204, v205
  v_cvt_pk_bf16_f32 v215, v206, v207
  s_nop 1
  v_mfma_f32_32x32x16_bf16 v[216:231], v[184:187], v[208:211], v[216:231]
  v_mfma_f32_32x32x16_bf16 v[216:231], v[188:191], v[212:215], v[216:231]
  s_add_u32 s57, s57, 1024
  s_add_u32 s59, s59, 2048
  s_sub_u32 s58, s58, 1
  s_cmp_lg_u32 s58, 0
  s_nop 9
  s_cbranch_scc1 ry_l2
  s_nop 13
  v_mov_b32 v128, v216
  v_mov_b32 v129, v217
  v_mov_b32 v130, v218
  v_mov_b32 v131, v219
  v_mov_b32 v132, v220
  v_mov_b32 v133, v221
  v_mov_b32 v134, v222
  v_mov_b32 v135, v223
  v_mov_b32 v136, v224
  s_branch ry_norm
gwq_spin:
  s_mov_b32 s62, 1600000
gwq_loop:
  s_sleep 2
  ds_read_b32 v14, v2 offset:0
  s_waitcnt lgkmcnt(0)
  v_cmp_gt_u32 vcc, 4, v14
  s_cbranch_vccz gwq_ok
  s_sub_u32 s62, s62, 1
  s_cmp_lg_u32 s62, 0
  s_cbranch_scc1 gwq_loop
  s_branch gwq_ok
gkv_spin:
  s_mov_b32 s62, 1600000
gkv_loop:
  s_sleep 2
  ds_read_b32 v14, v2 offset:32
  s_waitcnt lgkmcnt(0)
  v_cmp_gt_u32 vcc, 2, v14
  s_cbranch_vccz gkv_ok
  s_sub_u32 s62, s62, 1
  s_cmp_lg_u32 s62, 0
  s_cbranch_scc1 gkv_loop
  s_branch gkv_ok
gst_spin:
  s_mov_b32 s62, 200000
gst_loop:
  s_sleep 4
  buffer_load_dwordx4 v[248:251], v15, s[32:35], 0 offen sc1
  s_waitcnt vmcnt(0)
  v_xor_b32 v208, s61, v249
  v_xor_b32 v251, s61, v251
  v_or_b32 v208, v208, v251
  v_cmp_ne_u32 vcc, 0, v208
  s_cbranch_vccz gst_ok
  s_sub_u32 s62, s62, 1
  s_cmp_lg_u32 s62, 0
  s_cbranch_scc1 gst_loop
  s_branch gst_ok
gq2_spin:
  s_mov_b32 s62, 1600000
gq2_loop:
  s_sleep 2
  ds_read_b32 v14, v2 offset:0
  s_waitcnt lgkmcnt(0)
  v_cmp_gt_u32 vcc, 8, v14
  s_cbranch_vccz gq2_ok
  s_sub_u32 s62, s62, 1
  s_cmp_lg_u32 s62, 0
  s_cbranch_scc1 gq2_loop
  s_branch gq2_ok
gs0_spin:
  s_mov_b32 s62, 1600000
gs0_loop:
  s_sleep 2
  ds_read_b32 v14, v2 offset:0
  s_waitcnt lgkmcnt(0)
  s_setprio 2
  v_cmp_gt_u32 vcc, 12, v14
  s_setprio 0
  s_cbranch_vccz gs0_ok
  s_sub_u32 s62, s62, 1
  s_cmp_lg_u32 s62, 0
  s_cbranch_scc1 gs0_loop
  s_branch gs0_ok
gs1_spin:
  s_mov_b32 s62, 1600000
gs1_loop:
  s_sleep 2
  ds_read_b32 v14, v2 offset:0
  s_waitcnt lgkmcnt(0)
  s_setprio 2
  v_cmp_gt_u32 vcc, 16, v14
  s_setprio 0
  s_cbranch_vccz gs1_ok
  s_sub_u32 s62, s62, 1
  s_cmp_lg_u32 s62, 0
  s_cbranch_scc1 gs1_loop
  s_branch gs1_ok
gs2_spin:
  s_mov_b32 s62, 1600000
gs2_loop:
  s_sleep 2
  ds_read_b32 v14, v2 offset:0
  s_waitcnt lgkmcnt(0)
  s_setprio 2
  v_cmp_gt_u32 vcc, 20, v14
  s_setprio 0
  s_cbranch_vccz gs2_ok
  s_sub_u32 s62, s62, 1
  s_cmp_lg_u32 s62, 0
  s_cbranch_scc1 gs2_loop
  s_branch gs2_ok
gs3_spin:
  s_mov_b32 s62, 1600000
gs3_loop:
  s_sleep 2
  ds_read_b32 v14, v2 offset:0
  s_waitcnt lgkmcnt(0)
  s_setprio 2
  v_cmp_gt_u32 vcc, 24, v14
  s_setprio 0
  s_cbranch_vccz gs3_ok
  s_sub_u32 s62, s62, 1
  s_cmp_lg_u32 s62, 0
  s_cbranch_scc1 gs3_loop
  s_branch gs3_ok
gcs_spin:
  s_mov_b32 s62, 200000
gcs_loop:
  s_sleep 4
  buffer_load_dwordx4 v[244:247], v5, s[32:35], s74 offen sc1
  buffer_load_dwordx4 v[248:251], v6, s[32:35], s74 offen sc1
  s_waitcnt vmcnt(0)
  v_xor_b32 v7, s61, v245
  v_xor_b32 v247, s61, v247
  v_or_b32 v7, v7, v247
  v_xor_b32 v249, s61, v249
  v_or_b32 v7, v7, v249
  v_xor_b32 v251, s61, v251
  v_or_b32 v7, v7, v251
  v_cmp_ne_u32 vcc, 0, v7
  s_cbranch_vccz gcs_ok
  s_sub_u32 s62, s62, 1
  s_cmp_lg_u32 s62, 0
  s_cbranch_scc1 gcs_loop
  s_branch gcs_ok
gs4_spin:
  s_mov_b32 s62, 1600000
gs4_loop:
  s_sleep 2
  ds_read_b32 v14, v2 offset:0
  s_waitcnt lgkmcnt(0)
  s_setprio 2
  v_cmp_gt_u32 vcc, 28, v14
  s_setprio 0
  s_cbranch_vccz gs4_ok
  s_sub_u32 s62, s62, 1
  s_cmp_lg_u32 s62, 0
  s_cbranch_scc1 gs4_loop
  s_branch gs4_ok
gs5_spin:
  s_mov_b32 s62, 1600000
gs5_loop:
  s_sleep 2
  ds_read_b32 v14, v2 offset:0
  s_waitcnt lgkmcnt(0)
  s_setprio 2
  v_cmp_gt_u32 vcc, 32, v14
  s_setprio 0
  s_cbranch_vccz gs5_ok
  s_sub_u32 s62, s62, 1
  s_cmp_lg_u32 s62, 0
  s_cbranch_scc1 gs5_loop
  s_branch gs5_ok
gs6_spin:
  s_mov_b32 s62, 1600000
gs6_loop:
  s_sleep 2
  ds_read_b32 v14, v2 offset:0
  s_waitcnt lgkmcnt(0)
  s_setprio 2
  v_cmp_gt_u32 vcc, 36, v14
  s_setprio 0
  s_cbranch_vccz gs6_ok
  s_sub_u32 s62, s62, 1
  s_cmp_lg_u32 s62, 0
  s_cbranch_scc1 gs6_loop
  s_branch gs6_ok
gs7_spin:
  s_mov_b32 s62, 1600000
gs7_loop:
  s_sleep 2
  ds_read_b32 v14, v2 offset:0
  s_waitcnt lgkmcnt(0)
  s_setprio 2
  v_cmp_gt_u32 vcc, 40, v14
  s_setprio 0
  s_cbranch_vccz gs7_ok
  s_sub_u32 s62, s62, 1
  s_cmp_lg_u32 s62, 0
  s_cbranch_scc1 gs7_loop
  s_branch gs7_ok
gs8_spin:
  s_mov_b32 s62, 1600000
gs8_loop:
  s_sleep 2
  ds_read_b32 v14, v2 offset:0
  s_waitcnt lgkmcnt(0)
  s_setprio 2
  v_cmp_gt_u32 vcc, 44, v14
  s_setprio 0
  s_cbranch_vccz gs8_ok
  s_sub_u32 s62, s62, 1
  s_cmp_lg_u32 s62, 0
  s_cbranch_scc1 gs8_loop
  s_branch gs8_ok
gs9_spin:
  s_mov_b32 s62, 1600000
gs9_loop:
  s_sleep 2
  ds_read_b32 v14, v2 offset:0
  s_waitcnt lgkmcnt(0)
  s_setprio 2
  v_cmp_gt_u32 vcc, 48, v14
  s_setprio 0
  s_cbranch_vccz gs9_ok
  s_sub_u32 s62, s62, 1
  s_cmp_lg_u32 s62, 0
  s_cbranch_scc1 gs9_loop
  s_branch gs9_ok
gs10_spin:
  s_mov_b32 s62, 1600000
gs10_loop:
  s_sleep 2
  ds_read_b32 v14, v2 offset:0
  s_waitcnt lgkmcnt(0)
  s_setprio 2
  v_cmp_gt_u32 vcc, 52, v14
  s_setprio 0
  s_cbranch_vccz gs10_ok
  s_sub_u32 s62, s62, 1
  s_cmp_lg_u32 s62, 0
  s_cbranch_scc1 gs10_loop
  s_branch gs10_ok
gs11_spin:
  s_mov_b32 s62, 1600000
gs11_loop:
  s_sleep 2
  ds_read_b32 v14, v2 offset:0
  s_waitcnt lgkmcnt(0)
  s_setprio 2
  v_cmp_gt_u32 vcc, 56, v14
  s_setprio 0
  s_cbranch_vccz gs11_ok
  s_sub_u32 s62, s62, 1
  s_cmp_lg_u32 s62, 0
  s_cbranch_scc1 gs11_loop
  s_branch gs11_ok
gs12_spin:
  s_mov_b32 s62, 1600000
gs12_loop:
  s_sleep 2
  ds_read_b32 v14, v2 offset:0
  s_waitcnt lgkmcnt(0)
  s_setprio 2
  v_cmp_gt_u32 vcc, 60, v14
  s_setprio 0
  s_cbranch_vccz gs12_ok
  s_sub_u32 s62, s62, 1
  s_cmp_lg_u32 s62, 0
  s_cbranch_scc1 gs12_loop
  s_branch gs12_ok
gs13_spin:
  s_mov_b32 s62, 1600000
gs13_loop:
  s_sleep 2
  ds_read_b32 v14, v2 offset:0
  s_waitcnt lgkmcnt(0)
  s_setprio 2
  v_cmp_gt_u32 vcc, 64, v14
  s_setprio 0
  s_cbranch_vccz gs13_ok
  s_sub_u32 s62, s62, 1
  s_cmp_lg_u32 s62, 0
  s_cbranch_scc1 gs13_loop
  s_branch gs13_ok
gs14_spin:
  s_mov_b32 s62, 1600000
gs14_loop:
  s_sleep 2
  ds_read_b32 v14, v2 offset:0
  s_waitcnt lgkmcnt(0)
  s_setprio 2
  v_cmp_gt_u32 vcc, 68, v14
  s_setprio 0
  s_cbranch_vccz gs14_ok
  s_sub_u32 s62, s62, 1
  s_cmp_lg_u32 s62, 0
  s_cbranch_scc1 gs14_loop
  s_branch gs14_ok
pha_spin:
  s_mov_b32 s62, 200000
pha_loop:
  s_sleep 4
  buffer_load_dword v245, v13, s[32:35], s73 offen offset:0 sc1
  s_waitcnt vmcnt(0)
  v_cmp_ne_u32 vcc, s61, v245
  s_cbranch_vccz pha_ok
  s_sub_u32 s62, s62, 1
  s_cmp_lg_u32 s62, 0
  s_cbranch_scc1 pha_loop
  s_branch pha_ok
gs15_spin:
  s_mov_b32 s62, 1600000
gs15_loop:
  s_sleep 2
  ds_read_b32 v14, v2 offset:0
  s_waitcnt lgkmcnt(0)
  s_setprio 2
  v_cmp_gt_u32 vcc, 72, v14
  s_setprio 0
  s_cbranch_vccz gs15_ok
  s_sub_u32 s62, s62, 1
  s_cmp_lg_u32 s62, 0
  s_cbranch_scc1 gs15_loop
  s_branch gs15_ok
phb_spin:
  s_mov_b32 s62, 200000
phb_loop:
  s_sleep 4
  buffer_load_dword v14, v13, s[32:35], s76 offen offset:0 sc1
  s_waitcnt vmcnt(0)
  v_cmp_ne_u32 vcc, s61, v14
  s_cbranch_vccz phb_ok
  s_sub_u32 s62, s62, 1
  s_cmp_lg_u32 s62, 0
  s_cbranch_scc1 phb_loop
  s_branch phb_ok
gp0_spin:
  s_mov_b32 s62, 1600000
gp0_loop:
  s_sleep 2
  ds_read_b32 v14, v2 offset:48
  s_waitcnt lgkmcnt(0)
  s_setprio 2
  v_cmp_gt_u32 vcc, 4, v14
  s_setprio 0
  s_cbranch_vccz gp0_ok
  s_sub_u32 s62, s62, 1
  s_cmp_lg_u32 s62, 0
  s_cbranch_scc1 gp0_loop
  s_branch gp0_ok
ro_slow:
  s_lshl_b32 s57, s63, 10
  s_add_u32 s57, s57, 139264
  v_add_u32 v92, s57, v1
  ds_read_b128 v[92:95], v92
  s_waitcnt lgkmcnt(0)
  v_lshrrev_b32 v134, 1, v1
  v_xor_b32 v134, v134, v1
  v_and_b32 v134, 64, v134
  v_lshl_or_b32 v134, v134, 1, v134
  v_xor_b32 v135, v1, v134
  v_mov_b32 v132, 0xff800000
  s_mov_b32 s57, 262144
  s_mov_b32 s58, 64
ro_l1:
  buffer_load_dwordx4 v[96:99], v135, s[32:35], s57 offen sc1
  s_waitcnt vmcnt(0)
  v_mfma_f32_32x32x16_bf16 v[108:123], v[96:99], v[92:95], 0
  s_nop 13
  v_max3_f32 v132, v108, v109, v132
  v_max3_f32 v132, v110, v111, v132
  v_max3_f32 v132, v112, v113, v132
  v_max3_f32 v132, v114, v115, v132
  v_max3_f32 v132, v116, v117, v132
  v_max3_f32 v132, v118, v119, v132
  v_max3_f32 v132, v120, v121, v132
  v_max3_f32 v132, v122, v123, v132
  s_add_u32 s57, s57, 1024
  s_sub_u32 s58, s58, 1
  s_cmp_lg_u32 s58, 0
  s_cbranch_scc1 ro_l1
  v_mov_b32 v133, v132
  s_nop 1
  v_permlane32_swap_b32 v132, v133
  s_nop 1
  v_max_f32 v132, v132, v133
  v_sub_f32 v76, 0, v132
  v_mov_b32 v208, 0
  v_sub_f32 v77, 0, v132
  v_mov_b32 v209, 0
  v_sub_f32 v78, 0, v132
  v_mov_b32 v210, 0
  v_sub_f32 v79, 0, v132
  v_mov_b32 v211, 0
  v_sub_f32 v80, 0, v132
  v_mov_b32 v212, 0
  v_sub_f32 v81, 0, v132
  v_mov_b32 v213, 0
  v_sub_f32 v82, 0, v132
  v_mov_b32 v214, 0
  v_sub_f32 v83, 0, v132
  v_mov_b32 v215, 0
  v_sub_f32 v84, 0, v132
  v_mov_b32 v216, 0
  v_sub_f32 v85, 0, v132
  v_mov_b32 v217, 0
  v_sub_f32 v86, 0, v132
  v_mov_b32 v218, 0
  v_sub_f32 v87, 0, v132
  v_mov_b32 v219, 0
  v_sub_f32 v88, 0, v132
  v_mov_b32 v220, 0
  v_sub_f32 v89, 0, v132
  v_mov_b32 v221, 0
  v_sub_f32 v90, 0, v132
  v_mov_b32 v222, 0
  v_sub_f32 v91, 0, v132
  v_mov_b32 v223, 0
  v_and_b32 v134, 27, v0
  v_cmp_eq_u32 vcc, 16, v134
  v_mov_b32 v134, s65
  s_nop 0
  v_cndmask_b32 v100, 0, v134, vcc
  v_mov_b32 v101, v100
  v_mov_b32 v102, v100
  v_mov_b32 v103, v100
  v_mov_b32 v104, v100
  v_mov_b32 v105, v100
  v_mov_b32 v106, v100
  v_mov_b32 v107, v100
  s_mov_b32 s57, 262144
  s_mov_b32 s59, 327680
  s_mov_b32 s58, 64
ro_l2:
  buffer_load_dwordx4 v[96:99], v135, s[32:35], s57 offen sc1
  s_mov_b32 exec_lo, 0xffff
  s_mov_b32 exec_hi, 0xffff
  buffer_load_dwordx4 v[100:103], v1, s[32:35], s59 offen sc1
  buffer_load_dwordx4 v[104:107], v1, s[32:35], s59 offen offset:1024 sc1
  s_mov_b64 exec, -1
  s_waitcnt vmcnt(0)
  v_mfma_f32_32x32x16_bf16 v[108:123], v[96:99], v[92:95], v[76:91]
  s_nop 13
  v_exp_f32 v108, v108
  v_exp_f32 v109, v109
  v_exp_f32 v110, v110
  v_exp_f32 v111, v111
  v_exp_f32 v112, v112
  v_exp_f32 v113, v113
  v_exp_f32 v114, v114
  v_exp_f32 v115, v115
  v_exp_f32 v116, v116
  v_exp_f32 v117, v117
  v_exp_f32 v118, v118
  v_exp_f32 v119, v119
  v_exp_f32 v120, v120
  v_exp_f32 v121, v121
  v_exp_f32 v122, v122
  v_exp_f32 v123, v123
  s_nop 0
  v_cvt_pk_bf16_f32 v124, v108, v109
  v_cvt_pk_bf16_f32 v125, v110, v111
  v_cvt_pk_bf16_f32 v126, v112, v113
  v_cvt_pk_bf16_f32 v127, v114, v115
  v_cvt_pk_bf16_f32 v128, v116, v117
  v_cvt_pk_bf16_f32 v129, v118, v119
  v_cvt_pk_bf16_f32 v130, v120, v121
  v_cvt_pk_bf16_f32 v131, v122, v123
  s_nop 1
  v_mfma_f32_32x32x16_bf16 v[208:223], v[100:103], v[124:127], v[208:223]
  v_mfma_f32_32x32x16_bf16 v[208:223], v[104:107], v[128:131], v[208:223]
  s_add_u32 s57, s57, 1024
  s_add_u32 s59, s59, 2048
  s_sub_u32 s58, s58, 1
  s_cmp_lg_u32 s58, 0
  s_nop 9
  s_cbranch_scc1 ro_l2
  s_nop 13
  v_mov_b32 v64, v208
  v_mov_b32 v65, v209
  v_mov_b32 v66, v210
  v_mov_b32 v67, v211
  v_mov_b32 v68, v212
  v_mov_b32 v69, v213
  v_mov_b32 v70, v214
  v_mov_b32 v71, v215
  v_mov_b32 v72, v216
  s_branch ro_norm
gs19_spin:
  s_mov_b32 s62, 1600000
gs19_loop:
  s_sleep 2
  ds_read_b32 v14, v2 offset:0
  s_waitcnt lgkmcnt(0)
  s_setprio 2
  v_cmp_gt_u32 vcc, 76, v14
  s_setprio 0
  s_cbranch_vccz gs19_ok
  s_sub_u32 s62, s62, 1
  s_cmp_lg_u32 s62, 0
  s_cbranch_scc1 gs19_loop
  s_branch gs19_ok
gst2_spin:
  s_mov_b32 s62, 200000
gst2_loop:
  s_sleep 4
  buffer_load_dwordx4 v[120:123], v124, s[32:35], s76 offen sc1
  s_waitcnt vmcnt(0)
  v_xor_b32 v125, s61, v121
  v_xor_b32 v123, s61, v123
  v_or_b32 v125, v125, v123
  v_cmp_ne_u32 vcc, 0, v125
  s_cbranch_vccz gst2_ok
  s_sub_u32 s62, s62, 1
  s_cmp_lg_u32 s62, 0
  s_cbranch_scc1 gst2_loop
  s_branch gst2_ok
po0_spin:
  s_mov_b32 s62, 200000
po0_loop:
  s_sleep 4
  buffer_load_dword v14, v13, s[32:35], s73 offen offset:0 sc1
  s_waitcnt vmcnt(0)
  v_cmp_ne_u32 vcc, s61, v14
  s_cbranch_vccz po0_ok
  s_sub_u32 s62, s62, 1
  s_cmp_lg_u32 s62, 0
  s_cbranch_scc1 po0_loop
  s_branch po0_ok
gsw_spin:
  s_mov_b32 s62, 1600000
gsw_loop:
  s_sleep 2
  ds_read_b32 v14, v2 offset:0
  s_waitcnt lgkmcnt(0)
  s_setprio 2
  v_cmp_gt_u32 vcc, 80, v14
  s_setprio 0
  s_cbranch_vccz gsw_ok
  s_sub_u32 s62, s62, 1
  s_cmp_lg_u32 s62, 0
  s_cbranch_scc1 gsw_loop
  s_branch gsw_ok
gs21_spin:
  s_mov_b32 s62, 1600000
gs21_loop:
  s_sleep 2
  ds_read_b32 v7, v2 offset:0
  s_waitcnt lgkmcnt(0)
  v_cmp_gt_u32 vcc, 84, v7
  s_cbranch_vccz gs21_ok
  s_sub_u32 s62, s62, 1
  s_cmp_lg_u32 s62, 0
  s_cbranch_scc1 gs21_loop
  s_branch gs21_ok
kend:
  s_endpgm
.section .rodata,"a"
.p2align 6
.amdhsa_kernel parallel_sum__grouped_kv_mqa__glu_gated_reglu__prompt_kernel
  .amdhsa_next_free_vgpr 256
  .amdhsa_next_free_sgpr 102
  .amdhsa_accum_offset 256
  .amdhsa_group_segment_fixed_size 0
  .amdhsa_kernarg_size 96
  .amdhsa_user_sgpr_count 2
  .amdhsa_user_sgpr_kernarg_segment_ptr 1
  .amdhsa_system_sgpr_workgroup_id_x 1
.end_amdhsa_kernel
.text
```
